```python
import torch

def _softmax(x, axis=-1):
    return torch.softmax(x, dim=axis)

def _gelu(x):
    return torch.nn.functional.gelu(x, approximate='tanh')

def _silu(x):
    return torch.nn.functional.silu(x)

def _sigmoid(x):
    return torch.sigmoid(x)

def _layernorm(x, axis=-1, eps=1e-05):
    m = x.mean(dim=axis, keepdim=True)
    v = x.var(dim=axis, keepdim=True, unbiased=False)
    return (x - m) / torch.sqrt(v + eps)

def _scatter_add(tgt, idx, src, axis=0):
    return tgt.clone().index_add_(axis, idx, src)

def _segment_sum(src, seg, n):
    out = torch.zeros((n,) + src.shape[1:], dtype=src.dtype)
    return out.index_add_(0, seg, src)

def _pad(x, pw):
    flat = tuple((v for pair in reversed(pw) for v in pair))
    return torch.nn.functional.pad(x, flat)
kernel_name = 'concat_heads__memory_aug_recurrent_mem_tr__ssm_conv_s5__prompt'

def setup_inputs():

    _w = lambda a: (lambda t: t.to(torch.bfloat16) if t.is_floating_point() else t)(torch.as_tensor(a))

    def _A_setup():
        B, S, Dm = (1, 2048, 640)
        H, Dh = (32, 128)
        M, seg = (8, 32)
        seg = min(seg, S)
        S = S // seg * seg
        return {'x': _w((lambda *s: torch.randn(*s, dtype=torch.bfloat16) * 0.05)(B, S, Dm)), 'mem0': _w((lambda *s: torch.randn(*s, dtype=torch.bfloat16) * 0.8)(B, M, Dm)), 'Wq': _w((lambda *s: torch.randn(*s, dtype=torch.bfloat16) * 1.6)(Dm, H, Dh) * Dm ** (-0.5)), 'Wk': _w((lambda *s: torch.randn(*s, dtype=torch.bfloat16) * 1.6)(Dm, H, Dh) * Dm ** (-0.5)), 'Wv': _w((lambda *s: torch.randn(*s, dtype=torch.bfloat16) * 0.8)(Dm, H, Dh) * Dm ** (-0.5)), 'Wo': _w((lambda *s: torch.randn(*s, dtype=torch.bfloat16) * 0.8)(H, Dh, Dm) * (H * Dh) ** (-0.5)), 'seg_len': seg}
    _A_in = _A_setup()

    def _B_setup():
        B, S, D = (1, 2048, 640)
        P = D
        Lambda_re = -0.5 * (lambda _x: torch.exp(torch.as_tensor(_x)))((lambda *s: torch.randn(*s, dtype=torch.bfloat16) * 0.8)(P))
        Lambda_im = (lambda *s: torch.randn(*s, dtype=torch.bfloat16) * 0.8)(P) * 1.0
        B_re = (lambda *s: torch.randn(*s, dtype=torch.bfloat16) * 0.8)(P, D) * D ** (-0.5)
        B_im = (lambda *s: torch.randn(*s, dtype=torch.bfloat16) * 0.8)(P, D) * D ** (-0.5)
        C_re = (lambda *s: torch.randn(*s, dtype=torch.bfloat16) * 0.8)(D, P) * P ** (-0.5)
        C_im = (lambda *s: torch.randn(*s, dtype=torch.bfloat16) * 0.8)(D, P) * P ** (-0.5)
        log_dt = (lambda *s: torch.randn(*s, dtype=torch.bfloat16) * 0.8)(P) * 0.3 - 2.0
        Dskip = (lambda *s: torch.randn(*s, dtype=torch.bfloat16) * 0.8)(D)
        return {'x': _w((lambda *s: torch.randn(*s, dtype=torch.bfloat16) * 0.05)(B, S, D)), 'Lambda_re': _w(Lambda_re), 'Lambda_im': _w(Lambda_im), 'B_re': _w(B_re), 'B_im': _w(B_im), 'C_re': _w(C_re), 'C_im': _w(C_im), 'log_dt': _w(log_dt), 'Dskip': _w(Dskip)}
    _B_in = _B_setup()
    return {'A_x': _A_in['x'], 'A_mem0': _A_in['mem0'], 'A_Wq': _A_in['Wq'], 'A_Wk': _A_in['Wk'], 'A_Wv': _A_in['Wv'], 'A_Wo': _A_in['Wo'], 'A_seg_len': _A_in['seg_len'], 'B_x': _B_in['x'], 'B_Lambda_re': _B_in['Lambda_re'], 'B_Lambda_im': _B_in['Lambda_im'], 'B_B_re': _B_in['B_re'], 'B_B_im': _B_in['B_im'], 'B_C_re': _B_in['C_re'], 'B_C_im': _B_in['C_im'], 'B_log_dt': _B_in['log_dt'], 'B_Dskip': _B_in['Dskip']}

def reference(A_x, A_mem0, A_Wq, A_Wk, A_Wv, A_Wo, A_seg_len, B_x, B_Lambda_re, B_Lambda_im, B_B_re, B_B_im, B_C_re, B_C_im, B_log_dt, B_Dskip):

    def _A_ref(x, mem0, Wq, Wk, Wv, Wo, seg_len):
        B, S, Dm = x.shape
        H, Dh = (Wq.shape[1], Wq.shape[2])
        M = mem0.shape[1]
        scale = Dh ** (-0.5)
        n_seg = S // seg_len
        L = M + seg_len
        idx = torch.arange(L)
        mask = (idx[:, None] < M) | (idx[:, None] >= idx[None, :])
        mem = mem0
        outs = []
        for s in range(n_seg):
            xs = x[:, s * seg_len:(s + 1) * seg_len, :].clone()
            h = torch.concatenate([mem, xs], axis=1)
            q = torch.einsum('btd,dhe->bhte', h, Wq)
            k = torch.einsum('btd,dhe->bhte', h, Wk)
            v = torch.einsum('btd,dhe->bhte', h, Wv)
            scores = torch.einsum('bhqe,bhke->bhqk', q, k) * scale
            scores = torch.where(mask[None, None], scores, -1000000000.0)
            p = _softmax(scores, axis=-1)
            o = torch.einsum('bhqk,bhke->bhqe', p, v)
            o = torch.einsum('bhte,hed->btd', o, Wo)
            mem = o[:, :M, :].clone()
            outs.append(o[:, M:, :])
        return torch.concatenate(outs, axis=1)

    def _B_ref(x, Lambda_re, Lambda_im, B_re, B_im, C_re, C_im, log_dt, Dskip):
        Bsz, L, H = x.shape
        Lam = Lambda_re + 1j * Lambda_im
        Bmat = B_re + 1j * B_im
        Cmat = C_re + 1j * C_im
        dt = torch.exp(log_dt)
        Lam_bar = torch.exp(dt * Lam)
        B_bar = ((Lam_bar - 1.0) / Lam)[:, None] * Bmat
        Bu = torch.einsum('bld,pd->blp', x + 0j, B_bar)
        h = torch.zeros_like(Bu[:, 0, :])
        hs = []
        for t in range(L):
            h = Lam_bar[None, :] * h + Bu[:, t, :]
            hs.append(h)
        hseq = torch.stack(hs, 1)
        y = 2.0 * torch.einsum('blp,dp->bld', hseq, Cmat).real + x * Dskip[None, None, :]
        return y
    a = _A_ref(A_x, A_mem0, A_Wq, A_Wk, A_Wv, A_Wo, A_seg_len)
    b = _B_ref(B_x, B_Lambda_re, B_Lambda_im, B_B_re, B_B_im, B_C_re, B_C_im, B_log_dt, B_Dskip)
    return torch.concatenate([a, b], axis=-1)
```

```asm
; @launch grid=(256,1,1) block=(256,1,1) lds=163840
.amdgcn_target "amdgcn-amd-amdhsa--gfx950"
.text
.globl concat_heads__memory_aug_recurrent_mem_tr__ssm_conv_s5__prompt_kernel
.p2align 8
.type concat_heads__memory_aug_recurrent_mem_tr__ssm_conv_s5__prompt_kernel,@function
concat_heads__memory_aug_recurrent_mem_tr__ssm_conv_s5__prompt_kernel:
    s_cmp_ge_u32 s2, 256
    s_cbranch_scc1 L_exit
    s_load_dwordx2 s[4:5], s[0:1], 144
    s_load_dwordx2 s[6:7], s[0:1], 136
    s_waitcnt lgkmcnt(0)
    s_mov_b32 s8, s4
    s_mov_b32 s9, s5
    s_mov_b32 s10, 268435456
    s_mov_b32 s11, 0x20000
    s_mov_b32 s20, s6
    s_mov_b32 s21, s7
    s_mov_b32 s22, 256
    s_mov_b32 s23, 0x20000
    s_getreg_b32 s18, hwreg(HW_REG_XCC_ID, 0, 4)
    v_lshrrev_b32 v1, 6, v0
    s_nop 0
    v_readfirstlane_b32 s3, v1
    s_cmp_lg_u32 s3, 0
    s_cbranch_scc1 L_role_wait
    s_lshl_b32 s3, s2, 6
    s_add_u32 s3, s3, 102760448
    v_lshlrev_b32 v2, 2, v0
    v_mov_b32 v3, 0
    s_mov_b64 exec, 0xffff
    buffer_store_dword v3, v2, s[8:11], s3 offen sc1
    s_mov_b64 exec, 1
    s_lshl_b32 s3, s18, 2
    v_mov_b32 v2, s3
    v_mov_b32 v3, 1
    buffer_atomic_add v3, v2, s[20:23], 0 offen sc0
    s_waitcnt vmcnt(0)
    v_mov_b32 v2, 40
    v_mov_b32 v4, 1
    buffer_atomic_add v4, v2, s[20:23], 0 offen
    v_readfirstlane_b32 s17, v3
    s_cmp_ge_u32 s18, 2
    s_cbranch_scc1 L_role_nc
    s_cmp_lt_u32 s17, 32
    s_cbranch_scc1 L_role_put
L_role_nc:
    v_add_u32 v3, 1000, v3
    s_cmp_lt_u32 s18, 4
    s_cbranch_scc1 L_role_put
    s_cmp_ge_u32 s17, 16
    s_cbranch_scc1 L_role_put
    v_mov_b32 v2, 44
    v_mov_b32 v3, 1
    buffer_atomic_add v3, v2, s[20:23], 0 offen sc0
    s_waitcnt vmcnt(0)
    v_add_u32 v3, 64, v3
L_role_put:
    v_mov_b32 v2, 0
    ds_write_b32 v2, v3
    s_waitcnt lgkmcnt(0)
    s_mov_b64 exec, -1
L_role_wait:
    s_barrier
    v_mov_b32 v2, 0
    ds_read_b32 v3, v2
    s_waitcnt lgkmcnt(0)
    v_readfirstlane_b32 s17, v3
    s_barrier
    s_cmp_lt_u32 s17, 64
    s_cbranch_scc1 L_chain
    s_sub_u32 s17, s17, 64
    s_mov_b32 s38, 300000
    s_mov_b32 s58, 0
    s_add_u32 s3, s18, 4
    s_sub_u32 s3, s3, 6
    s_cmp_ge_u32 s18, 2
    s_cselect_b32 s3, s3, s18
    s_sub_u32 s59, s18, 2
    s_cmp_ge_u32 s18, 2
    s_cselect_b32 s59, s59, s18
    s_cmp_ge_u32 s17, 500
    s_cbranch_scc1 L_generic
    s_cmp_ge_u32 s17, 40
    s_cbranch_scc1 L_att
    s_mul_i32 s36, s17, 3277
    s_lshr_b32 s36, s36, 16
    s_mul_i32 s3, s36, 20
    s_sub_u32 s37, s17, s3
    v_and_b32 v4, 63, v0
    v_lshlrev_b32 v1, 4, v4
    v_and_b32 v2, 15, v4
    v_lshrrev_b32 v3, 4, v4
    v_lshrrev_b32 v5, 6, v0
    s_nop 0
    v_readfirstlane_b32 s24, v5
    s_load_dwordx2 s[4:5], s[0:1], 40
    s_waitcnt lgkmcnt(0)
    s_mov_b32 s12, s4
    s_mov_b32 s13, s5
    s_mov_b32 s14, 5242880
    s_mov_b32 s15, 0x20000
    s_load_dwordx2 s[4:5], s[0:1], 128
    s_waitcnt lgkmcnt(0)
    s_mov_b32 s44, s4
    s_mov_b32 s45, s5
    s_mov_b32 s46, 10485760
    s_mov_b32 s47, 0x20000
    s_lshl_b32 s32, s24, 15
    v_lshrrev_b32 v5, 2, v4
    v_mul_u32_u24 v5, 1280, v5
    v_and_b32 v6, 3, v4
    v_lshl_add_u32 v12, v6, 4, v5
    s_mul_i32 s30, s24, 1310720
    s_lshl_b32 s26, s37, 6
    s_add_u32 s30, s30, s26
    v_lshrrev_b32 v5, 2, v2
    v_lshl_add_u32 v5, v3, 2, v5
    v_lshlrev_b32 v5, 6, v5
    v_and_b32 v6, 3, v2
    v_lshl_add_u32 v5, v6, 3, v5
    v_add_u32 v20, s32, v5
    s_add_u32 m0, s32, 0
    s_add_u32 s27, s30, 0
    buffer_load_dwordx4 v12, s[12:15], s27 offen lds
    s_add_u32 m0, s32, 1024
    s_add_u32 s27, s30, 20480
    buffer_load_dwordx4 v12, s[12:15], s27 offen lds
    s_add_u32 m0, s32, 2048
    s_add_u32 s27, s30, 40960
    buffer_load_dwordx4 v12, s[12:15], s27 offen lds
    s_add_u32 m0, s32, 3072
    s_add_u32 s27, s30, 61440
    buffer_load_dwordx4 v12, s[12:15], s27 offen lds
    s_add_u32 m0, s32, 4096
    s_add_u32 s27, s30, 81920
    buffer_load_dwordx4 v12, s[12:15], s27 offen lds
    s_add_u32 m0, s32, 5120
    s_add_u32 s27, s30, 102400
    buffer_load_dwordx4 v12, s[12:15], s27 offen lds
    s_add_u32 m0, s32, 6144
    s_add_u32 s27, s30, 122880
    buffer_load_dwordx4 v12, s[12:15], s27 offen lds
    s_add_u32 m0, s32, 7168
    s_add_u32 s27, s30, 143360
    buffer_load_dwordx4 v12, s[12:15], s27 offen lds
    s_add_u32 m0, s32, 8192
    s_add_u32 s27, s30, 163840
    buffer_load_dwordx4 v12, s[12:15], s27 offen lds
    s_add_u32 m0, s32, 9216
    s_add_u32 s27, s30, 184320
    buffer_load_dwordx4 v12, s[12:15], s27 offen lds
    s_add_u32 m0, s32, 10240
    s_add_u32 s27, s30, 204800
    buffer_load_dwordx4 v12, s[12:15], s27 offen lds
    s_add_u32 m0, s32, 11264
    s_add_u32 s27, s30, 225280
    buffer_load_dwordx4 v12, s[12:15], s27 offen lds
    s_add_u32 m0, s32, 12288
    s_add_u32 s27, s30, 245760
    buffer_load_dwordx4 v12, s[12:15], s27 offen lds
    s_add_u32 m0, s32, 13312
    s_add_u32 s27, s30, 266240
    buffer_load_dwordx4 v12, s[12:15], s27 offen lds
    s_add_u32 m0, s32, 14336
    s_add_u32 s27, s30, 286720
    buffer_load_dwordx4 v12, s[12:15], s27 offen lds
    s_add_u32 m0, s32, 15360
    s_add_u32 s27, s30, 307200
    buffer_load_dwordx4 v12, s[12:15], s27 offen lds
    s_add_u32 m0, s32, 16384
    s_add_u32 s27, s30, 327680
    buffer_load_dwordx4 v12, s[12:15], s27 offen lds
    s_add_u32 m0, s32, 17408
    s_add_u32 s27, s30, 348160
    buffer_load_dwordx4 v12, s[12:15], s27 offen lds
    s_add_u32 m0, s32, 18432
    s_add_u32 s27, s30, 368640
    buffer_load_dwordx4 v12, s[12:15], s27 offen lds
    s_add_u32 m0, s32, 19456
    s_add_u32 s27, s30, 389120
    buffer_load_dwordx4 v12, s[12:15], s27 offen lds
    s_add_u32 m0, s32, 20480
    s_add_u32 s27, s30, 409600
    buffer_load_dwordx4 v12, s[12:15], s27 offen lds
    s_add_u32 m0, s32, 21504
    s_add_u32 s27, s30, 430080
    buffer_load_dwordx4 v12, s[12:15], s27 offen lds
    s_add_u32 m0, s32, 22528
    s_add_u32 s27, s30, 450560
    buffer_load_dwordx4 v12, s[12:15], s27 offen lds
    s_add_u32 m0, s32, 23552
    s_add_u32 s27, s30, 471040
    buffer_load_dwordx4 v12, s[12:15], s27 offen lds
    s_add_u32 m0, s32, 24576
    s_add_u32 s27, s30, 491520
    buffer_load_dwordx4 v12, s[12:15], s27 offen lds
    s_add_u32 m0, s32, 25600
    s_add_u32 s27, s30, 512000
    buffer_load_dwordx4 v12, s[12:15], s27 offen lds
    s_add_u32 m0, s32, 26624
    s_add_u32 s27, s30, 532480
    buffer_load_dwordx4 v12, s[12:15], s27 offen lds
    s_add_u32 m0, s32, 27648
    s_add_u32 s27, s30, 552960
    buffer_load_dwordx4 v12, s[12:15], s27 offen lds
    s_add_u32 m0, s32, 28672
    s_add_u32 s27, s30, 573440
    buffer_load_dwordx4 v12, s[12:15], s27 offen lds
    s_add_u32 m0, s32, 29696
    s_add_u32 s27, s30, 593920
    buffer_load_dwordx4 v12, s[12:15], s27 offen lds
    s_add_u32 m0, s32, 30720
    s_add_u32 s27, s30, 614400
    buffer_load_dwordx4 v12, s[12:15], s27 offen lds
    s_add_u32 m0, s32, 31744
    s_add_u32 s27, s30, 634880
    buffer_load_dwordx4 v12, s[12:15], s27 offen lds
    s_waitcnt vmcnt(0)
    ds_read_b64_tr_b16 a[0:1], v20 offset:0
    ds_read_b64_tr_b16 a[2:3], v20 offset:1024
    ds_read_b64_tr_b16 a[4:5], v20 offset:32
    ds_read_b64_tr_b16 a[6:7], v20 offset:1056
    ds_read_b64_tr_b16 a[8:9], v20 offset:2048
    ds_read_b64_tr_b16 a[10:11], v20 offset:3072
    ds_read_b64_tr_b16 a[12:13], v20 offset:2080
    ds_read_b64_tr_b16 a[14:15], v20 offset:3104
    ds_read_b64_tr_b16 a[16:17], v20 offset:4096
    ds_read_b64_tr_b16 a[18:19], v20 offset:5120
    ds_read_b64_tr_b16 a[20:21], v20 offset:4128
    ds_read_b64_tr_b16 a[22:23], v20 offset:5152
    ds_read_b64_tr_b16 a[24:25], v20 offset:6144
    ds_read_b64_tr_b16 a[26:27], v20 offset:7168
    ds_read_b64_tr_b16 a[28:29], v20 offset:6176
    ds_read_b64_tr_b16 a[30:31], v20 offset:7200
    ds_read_b64_tr_b16 a[32:33], v20 offset:8192
    ds_read_b64_tr_b16 a[34:35], v20 offset:9216
    ds_read_b64_tr_b16 a[36:37], v20 offset:8224
    ds_read_b64_tr_b16 a[38:39], v20 offset:9248
    ds_read_b64_tr_b16 a[40:41], v20 offset:10240
    ds_read_b64_tr_b16 a[42:43], v20 offset:11264
    ds_read_b64_tr_b16 a[44:45], v20 offset:10272
    ds_read_b64_tr_b16 a[46:47], v20 offset:11296
    ds_read_b64_tr_b16 a[48:49], v20 offset:12288
    ds_read_b64_tr_b16 a[50:51], v20 offset:13312
    ds_read_b64_tr_b16 a[52:53], v20 offset:12320
    ds_read_b64_tr_b16 a[54:55], v20 offset:13344
    ds_read_b64_tr_b16 a[56:57], v20 offset:14336
    ds_read_b64_tr_b16 a[58:59], v20 offset:15360
    ds_read_b64_tr_b16 a[60:61], v20 offset:14368
    ds_read_b64_tr_b16 a[62:63], v20 offset:15392
    ds_read_b64_tr_b16 a[64:65], v20 offset:16384
    ds_read_b64_tr_b16 a[66:67], v20 offset:17408
    ds_read_b64_tr_b16 a[68:69], v20 offset:16416
    ds_read_b64_tr_b16 a[70:71], v20 offset:17440
    ds_read_b64_tr_b16 a[72:73], v20 offset:18432
    ds_read_b64_tr_b16 a[74:75], v20 offset:19456
    ds_read_b64_tr_b16 a[76:77], v20 offset:18464
    ds_read_b64_tr_b16 a[78:79], v20 offset:19488
    ds_read_b64_tr_b16 a[80:81], v20 offset:20480
    ds_read_b64_tr_b16 a[82:83], v20 offset:21504
    ds_read_b64_tr_b16 a[84:85], v20 offset:20512
    ds_read_b64_tr_b16 a[86:87], v20 offset:21536
    ds_read_b64_tr_b16 a[88:89], v20 offset:22528
    ds_read_b64_tr_b16 a[90:91], v20 offset:23552
    ds_read_b64_tr_b16 a[92:93], v20 offset:22560
    ds_read_b64_tr_b16 a[94:95], v20 offset:23584
    ds_read_b64_tr_b16 a[96:97], v20 offset:24576
    ds_read_b64_tr_b16 a[98:99], v20 offset:25600
    ds_read_b64_tr_b16 a[100:101], v20 offset:24608
    ds_read_b64_tr_b16 a[102:103], v20 offset:25632
    ds_read_b64_tr_b16 a[104:105], v20 offset:26624
    ds_read_b64_tr_b16 a[106:107], v20 offset:27648
    ds_read_b64_tr_b16 a[108:109], v20 offset:26656
    ds_read_b64_tr_b16 a[110:111], v20 offset:27680
    ds_read_b64_tr_b16 a[112:113], v20 offset:28672
    ds_read_b64_tr_b16 a[114:115], v20 offset:29696
    ds_read_b64_tr_b16 a[116:117], v20 offset:28704
    ds_read_b64_tr_b16 a[118:119], v20 offset:29728
    ds_read_b64_tr_b16 a[120:121], v20 offset:30720
    ds_read_b64_tr_b16 a[122:123], v20 offset:31744
    ds_read_b64_tr_b16 a[124:125], v20 offset:30752
    ds_read_b64_tr_b16 a[126:127], v20 offset:31776
    s_waitcnt lgkmcnt(0)
    s_add_u32 m0, s32, 0
    s_add_u32 s27, s30, 655360
    buffer_load_dwordx4 v12, s[12:15], s27 offen lds
    s_add_u32 m0, s32, 1024
    s_add_u32 s27, s30, 675840
    buffer_load_dwordx4 v12, s[12:15], s27 offen lds
    s_add_u32 m0, s32, 2048
    s_add_u32 s27, s30, 696320
    buffer_load_dwordx4 v12, s[12:15], s27 offen lds
    s_add_u32 m0, s32, 3072
    s_add_u32 s27, s30, 716800
    buffer_load_dwordx4 v12, s[12:15], s27 offen lds
    s_add_u32 m0, s32, 4096
    s_add_u32 s27, s30, 737280
    buffer_load_dwordx4 v12, s[12:15], s27 offen lds
    s_add_u32 m0, s32, 5120
    s_add_u32 s27, s30, 757760
    buffer_load_dwordx4 v12, s[12:15], s27 offen lds
    s_add_u32 m0, s32, 6144
    s_add_u32 s27, s30, 778240
    buffer_load_dwordx4 v12, s[12:15], s27 offen lds
    s_add_u32 m0, s32, 7168
    s_add_u32 s27, s30, 798720
    buffer_load_dwordx4 v12, s[12:15], s27 offen lds
    s_add_u32 m0, s32, 8192
    s_add_u32 s27, s30, 819200
    buffer_load_dwordx4 v12, s[12:15], s27 offen lds
    s_add_u32 m0, s32, 9216
    s_add_u32 s27, s30, 839680
    buffer_load_dwordx4 v12, s[12:15], s27 offen lds
    s_add_u32 m0, s32, 10240
    s_add_u32 s27, s30, 860160
    buffer_load_dwordx4 v12, s[12:15], s27 offen lds
    s_add_u32 m0, s32, 11264
    s_add_u32 s27, s30, 880640
    buffer_load_dwordx4 v12, s[12:15], s27 offen lds
    s_add_u32 m0, s32, 12288
    s_add_u32 s27, s30, 901120
    buffer_load_dwordx4 v12, s[12:15], s27 offen lds
    s_add_u32 m0, s32, 13312
    s_add_u32 s27, s30, 921600
    buffer_load_dwordx4 v12, s[12:15], s27 offen lds
    s_add_u32 m0, s32, 14336
    s_add_u32 s27, s30, 942080
    buffer_load_dwordx4 v12, s[12:15], s27 offen lds
    s_add_u32 m0, s32, 15360
    s_add_u32 s27, s30, 962560
    buffer_load_dwordx4 v12, s[12:15], s27 offen lds
    s_add_u32 m0, s32, 16384
    s_add_u32 s27, s30, 983040
    buffer_load_dwordx4 v12, s[12:15], s27 offen lds
    s_add_u32 m0, s32, 17408
    s_add_u32 s27, s30, 1003520
    buffer_load_dwordx4 v12, s[12:15], s27 offen lds
    s_add_u32 m0, s32, 18432
    s_add_u32 s27, s30, 1024000
    buffer_load_dwordx4 v12, s[12:15], s27 offen lds
    s_add_u32 m0, s32, 19456
    s_add_u32 s27, s30, 1044480
    buffer_load_dwordx4 v12, s[12:15], s27 offen lds
    s_add_u32 m0, s32, 20480
    s_add_u32 s27, s30, 1064960
    buffer_load_dwordx4 v12, s[12:15], s27 offen lds
    s_add_u32 m0, s32, 21504
    s_add_u32 s27, s30, 1085440
    buffer_load_dwordx4 v12, s[12:15], s27 offen lds
    s_add_u32 m0, s32, 22528
    s_add_u32 s27, s30, 1105920
    buffer_load_dwordx4 v12, s[12:15], s27 offen lds
    s_add_u32 m0, s32, 23552
    s_add_u32 s27, s30, 1126400
    buffer_load_dwordx4 v12, s[12:15], s27 offen lds
    s_add_u32 m0, s32, 24576
    s_add_u32 s27, s30, 1146880
    buffer_load_dwordx4 v12, s[12:15], s27 offen lds
    s_add_u32 m0, s32, 25600
    s_add_u32 s27, s30, 1167360
    buffer_load_dwordx4 v12, s[12:15], s27 offen lds
    s_add_u32 m0, s32, 26624
    s_add_u32 s27, s30, 1187840
    buffer_load_dwordx4 v12, s[12:15], s27 offen lds
    s_add_u32 m0, s32, 27648
    s_add_u32 s27, s30, 1208320
    buffer_load_dwordx4 v12, s[12:15], s27 offen lds
    s_add_u32 m0, s32, 28672
    s_add_u32 s27, s30, 1228800
    buffer_load_dwordx4 v12, s[12:15], s27 offen lds
    s_add_u32 m0, s32, 29696
    s_add_u32 s27, s30, 1249280
    buffer_load_dwordx4 v12, s[12:15], s27 offen lds
    s_add_u32 m0, s32, 30720
    s_add_u32 s27, s30, 1269760
    buffer_load_dwordx4 v12, s[12:15], s27 offen lds
    s_add_u32 m0, s32, 31744
    s_add_u32 s27, s30, 1290240
    buffer_load_dwordx4 v12, s[12:15], s27 offen lds
    s_waitcnt vmcnt(0)
    ds_read_b64_tr_b16 a[128:129], v20 offset:0
    ds_read_b64_tr_b16 a[130:131], v20 offset:1024
    ds_read_b64_tr_b16 a[132:133], v20 offset:32
    ds_read_b64_tr_b16 a[134:135], v20 offset:1056
    ds_read_b64_tr_b16 a[136:137], v20 offset:2048
    ds_read_b64_tr_b16 a[138:139], v20 offset:3072
    ds_read_b64_tr_b16 a[140:141], v20 offset:2080
    ds_read_b64_tr_b16 a[142:143], v20 offset:3104
    ds_read_b64_tr_b16 a[144:145], v20 offset:4096
    ds_read_b64_tr_b16 a[146:147], v20 offset:5120
    ds_read_b64_tr_b16 a[148:149], v20 offset:4128
    ds_read_b64_tr_b16 a[150:151], v20 offset:5152
    ds_read_b64_tr_b16 a[152:153], v20 offset:6144
    ds_read_b64_tr_b16 a[154:155], v20 offset:7168
    ds_read_b64_tr_b16 a[156:157], v20 offset:6176
    ds_read_b64_tr_b16 a[158:159], v20 offset:7200
    ds_read_b64_tr_b16 a[160:161], v20 offset:8192
    ds_read_b64_tr_b16 a[162:163], v20 offset:9216
    ds_read_b64_tr_b16 a[164:165], v20 offset:8224
    ds_read_b64_tr_b16 a[166:167], v20 offset:9248
    ds_read_b64_tr_b16 a[168:169], v20 offset:10240
    ds_read_b64_tr_b16 a[170:171], v20 offset:11264
    ds_read_b64_tr_b16 a[172:173], v20 offset:10272
    ds_read_b64_tr_b16 a[174:175], v20 offset:11296
    ds_read_b64_tr_b16 a[176:177], v20 offset:12288
    ds_read_b64_tr_b16 a[178:179], v20 offset:13312
    ds_read_b64_tr_b16 a[180:181], v20 offset:12320
    ds_read_b64_tr_b16 a[182:183], v20 offset:13344
    ds_read_b64_tr_b16 a[184:185], v20 offset:14336
    ds_read_b64_tr_b16 a[186:187], v20 offset:15360
    ds_read_b64_tr_b16 a[188:189], v20 offset:14368
    ds_read_b64_tr_b16 a[190:191], v20 offset:15392
    ds_read_b64_tr_b16 a[192:193], v20 offset:16384
    ds_read_b64_tr_b16 a[194:195], v20 offset:17408
    ds_read_b64_tr_b16 a[196:197], v20 offset:16416
    ds_read_b64_tr_b16 a[198:199], v20 offset:17440
    ds_read_b64_tr_b16 a[200:201], v20 offset:18432
    ds_read_b64_tr_b16 a[202:203], v20 offset:19456
    ds_read_b64_tr_b16 a[204:205], v20 offset:18464
    ds_read_b64_tr_b16 a[206:207], v20 offset:19488
    ds_read_b64_tr_b16 a[208:209], v20 offset:20480
    ds_read_b64_tr_b16 a[210:211], v20 offset:21504
    ds_read_b64_tr_b16 a[212:213], v20 offset:20512
    ds_read_b64_tr_b16 a[214:215], v20 offset:21536
    ds_read_b64_tr_b16 a[216:217], v20 offset:22528
    ds_read_b64_tr_b16 a[218:219], v20 offset:23552
    ds_read_b64_tr_b16 a[220:221], v20 offset:22560
    ds_read_b64_tr_b16 a[222:223], v20 offset:23584
    ds_read_b64_tr_b16 a[224:225], v20 offset:24576
    ds_read_b64_tr_b16 a[226:227], v20 offset:25600
    ds_read_b64_tr_b16 a[228:229], v20 offset:24608
    ds_read_b64_tr_b16 a[230:231], v20 offset:25632
    ds_read_b64_tr_b16 a[232:233], v20 offset:26624
    ds_read_b64_tr_b16 a[234:235], v20 offset:27648
    ds_read_b64_tr_b16 a[236:237], v20 offset:26656
    ds_read_b64_tr_b16 a[238:239], v20 offset:27680
    ds_read_b64_tr_b16 a[240:241], v20 offset:28672
    ds_read_b64_tr_b16 a[242:243], v20 offset:29696
    ds_read_b64_tr_b16 a[244:245], v20 offset:28704
    ds_read_b64_tr_b16 a[246:247], v20 offset:29728
    ds_read_b64_tr_b16 a[248:249], v20 offset:30720
    ds_read_b64_tr_b16 a[250:251], v20 offset:31744
    ds_read_b64_tr_b16 a[252:253], v20 offset:30752
    ds_read_b64_tr_b16 a[254:255], v20 offset:31776
    s_waitcnt lgkmcnt(0)
    s_barrier
    s_lshr_b32 s39, s24, 1
    s_and_b32 s40, s24, 1
    s_lshl_b32 s26, s39, 4
    v_add_u32 v5, s26, v2
    v_mul_u32_u24 v5, 5120, v5
    s_lshl_b32 s26, s37, 5
    s_lshl_b32 s27, s40, 4
    s_add_u32 s26, s26, s27
    v_lshlrev_b32 v6, 2, v3
    v_add_u32 v6, s26, v6
    v_lshl_add_u32 v16, v6, 2, v5
    s_lshl_b32 s26, s24, 12
    v_add_u32 v17, s26, v1
    s_lshl_b32 s26, s24, 10
    v_add_u32 v18, s26, v1
    s_mov_b32 s34, s36
    s_cmp_eq_u32 s58, 1
    s_cbranch_scc1 L_zok_1
    v_mov_b32 v10, 40
L_wsp_2:
    buffer_load_dword v11, v10, s[20:23], 0 offen sc1
    s_waitcnt vmcnt(0)
    v_readfirstlane_b32 s29, v11
    s_cmp_ge_u32 s29, 256
    s_cbranch_scc1 L_wsp_2_ok
    s_sleep 2
    s_sub_u32 s38, s38, 1
    s_cbranch_scc0 L_wsp_2
    s_branch L_w_abort
L_wsp_2_ok:
    s_mov_b32 s58, 1
L_zok_1:
L_proj_3:
    s_lshl_b32 s26, s34, 2
    s_add_u32 s26, s26, 102770176
    v_mov_b32 v6, s26
L_wsp_4:
    buffer_load_dword v11, v6, s[8:11], 0 offen sc1
    s_waitcnt vmcnt(0)
    v_readfirstlane_b32 s29, v11
    s_cmp_ge_u32 s29, 8
    s_cbranch_scc1 L_wsp_4_ok
    s_sleep 8
    s_sub_u32 s38, s38, 1
    s_cbranch_scc0 L_wsp_4
    s_branch L_w_abort
L_wsp_4_ok:
    s_lshl_b32 s26, s34, 8
    s_lshl_b32 s27, s24, 5
    s_add_u32 s26, s26, s27
    s_lshl_b32 s26, s26, 10
    s_add_u32 s41, s26, 67108864
    s_add_u32 s42, s41, 131072
    s_add_u32 s26, s41, 0
    buffer_load_dwordx4 v[64:67], v1, s[8:11], s26 offen offset:0 sc1
    s_add_u32 s26, s42, 0
    buffer_load_dwordx4 v[68:71], v1, s[8:11], s26 offen offset:0 sc1
    s_add_u32 s26, s41, 0
    buffer_load_dwordx4 v[72:75], v1, s[8:11], s26 offen offset:1024 sc1
    s_add_u32 s26, s42, 0
    buffer_load_dwordx4 v[76:79], v1, s[8:11], s26 offen offset:1024 sc1
    s_add_u32 s26, s41, 0
    buffer_load_dwordx4 v[80:83], v1, s[8:11], s26 offen offset:2048 sc1
    s_add_u32 s26, s42, 0
    buffer_load_dwordx4 v[84:87], v1, s[8:11], s26 offen offset:2048 sc1
    s_add_u32 s26, s41, 0
    buffer_load_dwordx4 v[88:91], v1, s[8:11], s26 offen offset:3072 sc1
    s_add_u32 s26, s42, 0
    buffer_load_dwordx4 v[92:95], v1, s[8:11], s26 offen offset:3072 sc1
    s_add_u32 s26, s41, 4096
    buffer_load_dwordx4 v[96:99], v1, s[8:11], s26 offen offset:0 sc1
    s_add_u32 s26, s42, 4096
    buffer_load_dwordx4 v[100:103], v1, s[8:11], s26 offen offset:0 sc1
    s_add_u32 s26, s41, 4096
    buffer_load_dwordx4 v[104:107], v1, s[8:11], s26 offen offset:1024 sc1
    s_add_u32 s26, s42, 4096
    buffer_load_dwordx4 v[108:111], v1, s[8:11], s26 offen offset:1024 sc1
    s_add_u32 s26, s41, 4096
    buffer_load_dwordx4 v[112:115], v1, s[8:11], s26 offen offset:2048 sc1
    s_add_u32 s26, s42, 4096
    buffer_load_dwordx4 v[116:119], v1, s[8:11], s26 offen offset:2048 sc1
    s_add_u32 s26, s41, 4096
    buffer_load_dwordx4 v[120:123], v1, s[8:11], s26 offen offset:3072 sc1
    s_add_u32 s26, s42, 4096
    buffer_load_dwordx4 v[124:127], v1, s[8:11], s26 offen offset:3072 sc1
    s_waitcnt vmcnt(14)
    v_mfma_f32_16x16x32_bf16 v[32:35], a[0:3], v[64:67], 0
    v_mfma_f32_16x16x32_bf16 v[36:39], a[4:7], v[64:67], 0
    v_mfma_f32_16x16x32_bf16 v[40:43], a[0:3], v[68:71], 0
    v_mfma_f32_16x16x32_bf16 v[44:47], a[4:7], v[68:71], 0
    s_add_u32 s26, s41, 8192
    buffer_load_dwordx4 v[64:67], v1, s[8:11], s26 offen offset:0 sc1
    s_add_u32 s26, s42, 8192
    buffer_load_dwordx4 v[68:71], v1, s[8:11], s26 offen offset:0 sc1
    s_waitcnt vmcnt(14)
    v_mfma_f32_16x16x32_bf16 v[32:35], a[8:11], v[72:75], v[32:35]
    v_mfma_f32_16x16x32_bf16 v[36:39], a[12:15], v[72:75], v[36:39]
    v_mfma_f32_16x16x32_bf16 v[40:43], a[8:11], v[76:79], v[40:43]
    v_mfma_f32_16x16x32_bf16 v[44:47], a[12:15], v[76:79], v[44:47]
    s_add_u32 s26, s41, 8192
    buffer_load_dwordx4 v[72:75], v1, s[8:11], s26 offen offset:1024 sc1
    s_add_u32 s26, s42, 8192
    buffer_load_dwordx4 v[76:79], v1, s[8:11], s26 offen offset:1024 sc1
    s_waitcnt vmcnt(14)
    v_mfma_f32_16x16x32_bf16 v[32:35], a[16:19], v[80:83], v[32:35]
    v_mfma_f32_16x16x32_bf16 v[36:39], a[20:23], v[80:83], v[36:39]
    v_mfma_f32_16x16x32_bf16 v[40:43], a[16:19], v[84:87], v[40:43]
    v_mfma_f32_16x16x32_bf16 v[44:47], a[20:23], v[84:87], v[44:47]
    s_add_u32 s26, s41, 8192
    buffer_load_dwordx4 v[80:83], v1, s[8:11], s26 offen offset:2048 sc1
    s_add_u32 s26, s42, 8192
    buffer_load_dwordx4 v[84:87], v1, s[8:11], s26 offen offset:2048 sc1
    s_waitcnt vmcnt(14)
    v_mfma_f32_16x16x32_bf16 v[32:35], a[24:27], v[88:91], v[32:35]
    v_mfma_f32_16x16x32_bf16 v[36:39], a[28:31], v[88:91], v[36:39]
    v_mfma_f32_16x16x32_bf16 v[40:43], a[24:27], v[92:95], v[40:43]
    v_mfma_f32_16x16x32_bf16 v[44:47], a[28:31], v[92:95], v[44:47]
    s_add_u32 s26, s41, 8192
    buffer_load_dwordx4 v[88:91], v1, s[8:11], s26 offen offset:3072 sc1
    s_add_u32 s26, s42, 8192
    buffer_load_dwordx4 v[92:95], v1, s[8:11], s26 offen offset:3072 sc1
    s_waitcnt vmcnt(14)
    v_mfma_f32_16x16x32_bf16 v[32:35], a[32:35], v[96:99], v[32:35]
    v_mfma_f32_16x16x32_bf16 v[36:39], a[36:39], v[96:99], v[36:39]
    v_mfma_f32_16x16x32_bf16 v[40:43], a[32:35], v[100:103], v[40:43]
    v_mfma_f32_16x16x32_bf16 v[44:47], a[36:39], v[100:103], v[44:47]
    s_add_u32 s26, s41, 12288
    buffer_load_dwordx4 v[96:99], v1, s[8:11], s26 offen offset:0 sc1
    s_add_u32 s26, s42, 12288
    buffer_load_dwordx4 v[100:103], v1, s[8:11], s26 offen offset:0 sc1
    s_waitcnt vmcnt(14)
    v_mfma_f32_16x16x32_bf16 v[32:35], a[40:43], v[104:107], v[32:35]
    v_mfma_f32_16x16x32_bf16 v[36:39], a[44:47], v[104:107], v[36:39]
    v_mfma_f32_16x16x32_bf16 v[40:43], a[40:43], v[108:111], v[40:43]
    v_mfma_f32_16x16x32_bf16 v[44:47], a[44:47], v[108:111], v[44:47]
    s_add_u32 s26, s41, 12288
    buffer_load_dwordx4 v[104:107], v1, s[8:11], s26 offen offset:1024 sc1
    s_add_u32 s26, s42, 12288
    buffer_load_dwordx4 v[108:111], v1, s[8:11], s26 offen offset:1024 sc1
    s_waitcnt vmcnt(14)
    v_mfma_f32_16x16x32_bf16 v[32:35], a[48:51], v[112:115], v[32:35]
    v_mfma_f32_16x16x32_bf16 v[36:39], a[52:55], v[112:115], v[36:39]
    v_mfma_f32_16x16x32_bf16 v[40:43], a[48:51], v[116:119], v[40:43]
    v_mfma_f32_16x16x32_bf16 v[44:47], a[52:55], v[116:119], v[44:47]
    s_add_u32 s26, s41, 12288
    buffer_load_dwordx4 v[112:115], v1, s[8:11], s26 offen offset:2048 sc1
    s_add_u32 s26, s42, 12288
    buffer_load_dwordx4 v[116:119], v1, s[8:11], s26 offen offset:2048 sc1
    s_waitcnt vmcnt(14)
    v_mfma_f32_16x16x32_bf16 v[32:35], a[56:59], v[120:123], v[32:35]
    v_mfma_f32_16x16x32_bf16 v[36:39], a[60:63], v[120:123], v[36:39]
    v_mfma_f32_16x16x32_bf16 v[40:43], a[56:59], v[124:127], v[40:43]
    v_mfma_f32_16x16x32_bf16 v[44:47], a[60:63], v[124:127], v[44:47]
    s_add_u32 s26, s41, 12288
    buffer_load_dwordx4 v[120:123], v1, s[8:11], s26 offen offset:3072 sc1
    s_add_u32 s26, s42, 12288
    buffer_load_dwordx4 v[124:127], v1, s[8:11], s26 offen offset:3072 sc1
    s_waitcnt vmcnt(14)
    v_mfma_f32_16x16x32_bf16 v[32:35], a[64:67], v[64:67], v[32:35]
    v_mfma_f32_16x16x32_bf16 v[36:39], a[68:71], v[64:67], v[36:39]
    v_mfma_f32_16x16x32_bf16 v[40:43], a[64:67], v[68:71], v[40:43]
    v_mfma_f32_16x16x32_bf16 v[44:47], a[68:71], v[68:71], v[44:47]
    s_add_u32 s26, s41, 16384
    buffer_load_dwordx4 v[64:67], v1, s[8:11], s26 offen offset:0 sc1
    s_add_u32 s26, s42, 16384
    buffer_load_dwordx4 v[68:71], v1, s[8:11], s26 offen offset:0 sc1
    s_waitcnt vmcnt(14)
    v_mfma_f32_16x16x32_bf16 v[32:35], a[72:75], v[72:75], v[32:35]
    v_mfma_f32_16x16x32_bf16 v[36:39], a[76:79], v[72:75], v[36:39]
    v_mfma_f32_16x16x32_bf16 v[40:43], a[72:75], v[76:79], v[40:43]
    v_mfma_f32_16x16x32_bf16 v[44:47], a[76:79], v[76:79], v[44:47]
    s_add_u32 s26, s41, 16384
    buffer_load_dwordx4 v[72:75], v1, s[8:11], s26 offen offset:1024 sc1
    s_add_u32 s26, s42, 16384
    buffer_load_dwordx4 v[76:79], v1, s[8:11], s26 offen offset:1024 sc1
    s_waitcnt vmcnt(14)
    v_mfma_f32_16x16x32_bf16 v[32:35], a[80:83], v[80:83], v[32:35]
    v_mfma_f32_16x16x32_bf16 v[36:39], a[84:87], v[80:83], v[36:39]
    v_mfma_f32_16x16x32_bf16 v[40:43], a[80:83], v[84:87], v[40:43]
    v_mfma_f32_16x16x32_bf16 v[44:47], a[84:87], v[84:87], v[44:47]
    s_add_u32 s26, s41, 16384
    buffer_load_dwordx4 v[80:83], v1, s[8:11], s26 offen offset:2048 sc1
    s_add_u32 s26, s42, 16384
    buffer_load_dwordx4 v[84:87], v1, s[8:11], s26 offen offset:2048 sc1
    s_waitcnt vmcnt(14)
    v_mfma_f32_16x16x32_bf16 v[32:35], a[88:91], v[88:91], v[32:35]
    v_mfma_f32_16x16x32_bf16 v[36:39], a[92:95], v[88:91], v[36:39]
    v_mfma_f32_16x16x32_bf16 v[40:43], a[88:91], v[92:95], v[40:43]
    v_mfma_f32_16x16x32_bf16 v[44:47], a[92:95], v[92:95], v[44:47]
    s_add_u32 s26, s41, 16384
    buffer_load_dwordx4 v[88:91], v1, s[8:11], s26 offen offset:3072 sc1
    s_add_u32 s26, s42, 16384
    buffer_load_dwordx4 v[92:95], v1, s[8:11], s26 offen offset:3072 sc1
    s_waitcnt vmcnt(14)
    v_mfma_f32_16x16x32_bf16 v[32:35], a[96:99], v[96:99], v[32:35]
    v_mfma_f32_16x16x32_bf16 v[36:39], a[100:103], v[96:99], v[36:39]
    v_mfma_f32_16x16x32_bf16 v[40:43], a[96:99], v[100:103], v[40:43]
    v_mfma_f32_16x16x32_bf16 v[44:47], a[100:103], v[100:103], v[44:47]
    s_add_u32 s26, s41, 20480
    buffer_load_dwordx4 v[96:99], v1, s[8:11], s26 offen offset:0 sc1
    s_add_u32 s26, s42, 20480
    buffer_load_dwordx4 v[100:103], v1, s[8:11], s26 offen offset:0 sc1
    s_waitcnt vmcnt(14)
    v_mfma_f32_16x16x32_bf16 v[32:35], a[104:107], v[104:107], v[32:35]
    v_mfma_f32_16x16x32_bf16 v[36:39], a[108:111], v[104:107], v[36:39]
    v_mfma_f32_16x16x32_bf16 v[40:43], a[104:107], v[108:111], v[40:43]
    v_mfma_f32_16x16x32_bf16 v[44:47], a[108:111], v[108:111], v[44:47]
    s_add_u32 s26, s41, 20480
    buffer_load_dwordx4 v[104:107], v1, s[8:11], s26 offen offset:1024 sc1
    s_add_u32 s26, s42, 20480
    buffer_load_dwordx4 v[108:111], v1, s[8:11], s26 offen offset:1024 sc1
    s_waitcnt vmcnt(14)
    v_mfma_f32_16x16x32_bf16 v[32:35], a[112:115], v[112:115], v[32:35]
    v_mfma_f32_16x16x32_bf16 v[36:39], a[116:119], v[112:115], v[36:39]
    v_mfma_f32_16x16x32_bf16 v[40:43], a[112:115], v[116:119], v[40:43]
    v_mfma_f32_16x16x32_bf16 v[44:47], a[116:119], v[116:119], v[44:47]
    s_add_u32 s26, s41, 20480
    buffer_load_dwordx4 v[112:115], v1, s[8:11], s26 offen offset:2048 sc1
    s_add_u32 s26, s42, 20480
    buffer_load_dwordx4 v[116:119], v1, s[8:11], s26 offen offset:2048 sc1
    s_waitcnt vmcnt(14)
    v_mfma_f32_16x16x32_bf16 v[32:35], a[120:123], v[120:123], v[32:35]
    v_mfma_f32_16x16x32_bf16 v[36:39], a[124:127], v[120:123], v[36:39]
    v_mfma_f32_16x16x32_bf16 v[40:43], a[120:123], v[124:127], v[40:43]
    v_mfma_f32_16x16x32_bf16 v[44:47], a[124:127], v[124:127], v[44:47]
    s_add_u32 s26, s41, 20480
    buffer_load_dwordx4 v[120:123], v1, s[8:11], s26 offen offset:3072 sc1
    s_add_u32 s26, s42, 20480
    buffer_load_dwordx4 v[124:127], v1, s[8:11], s26 offen offset:3072 sc1
    s_waitcnt vmcnt(14)
    v_mfma_f32_16x16x32_bf16 v[32:35], a[128:131], v[64:67], v[32:35]
    v_mfma_f32_16x16x32_bf16 v[36:39], a[132:135], v[64:67], v[36:39]
    v_mfma_f32_16x16x32_bf16 v[40:43], a[128:131], v[68:71], v[40:43]
    v_mfma_f32_16x16x32_bf16 v[44:47], a[132:135], v[68:71], v[44:47]
    s_add_u32 s26, s41, 24576
    buffer_load_dwordx4 v[64:67], v1, s[8:11], s26 offen offset:0 sc1
    s_add_u32 s26, s42, 24576
    buffer_load_dwordx4 v[68:71], v1, s[8:11], s26 offen offset:0 sc1
    s_waitcnt vmcnt(14)
    v_mfma_f32_16x16x32_bf16 v[32:35], a[136:139], v[72:75], v[32:35]
    v_mfma_f32_16x16x32_bf16 v[36:39], a[140:143], v[72:75], v[36:39]
    v_mfma_f32_16x16x32_bf16 v[40:43], a[136:139], v[76:79], v[40:43]
    v_mfma_f32_16x16x32_bf16 v[44:47], a[140:143], v[76:79], v[44:47]
    s_add_u32 s26, s41, 24576
    buffer_load_dwordx4 v[72:75], v1, s[8:11], s26 offen offset:1024 sc1
    s_add_u32 s26, s42, 24576
    buffer_load_dwordx4 v[76:79], v1, s[8:11], s26 offen offset:1024 sc1
    s_waitcnt vmcnt(14)
    v_mfma_f32_16x16x32_bf16 v[32:35], a[144:147], v[80:83], v[32:35]
    v_mfma_f32_16x16x32_bf16 v[36:39], a[148:151], v[80:83], v[36:39]
    v_mfma_f32_16x16x32_bf16 v[40:43], a[144:147], v[84:87], v[40:43]
    v_mfma_f32_16x16x32_bf16 v[44:47], a[148:151], v[84:87], v[44:47]
    s_add_u32 s26, s41, 24576
    buffer_load_dwordx4 v[80:83], v1, s[8:11], s26 offen offset:2048 sc1
    s_add_u32 s26, s42, 24576
    buffer_load_dwordx4 v[84:87], v1, s[8:11], s26 offen offset:2048 sc1
    s_waitcnt vmcnt(14)
    v_mfma_f32_16x16x32_bf16 v[32:35], a[152:155], v[88:91], v[32:35]
    v_mfma_f32_16x16x32_bf16 v[36:39], a[156:159], v[88:91], v[36:39]
    v_mfma_f32_16x16x32_bf16 v[40:43], a[152:155], v[92:95], v[40:43]
    v_mfma_f32_16x16x32_bf16 v[44:47], a[156:159], v[92:95], v[44:47]
    s_add_u32 s26, s41, 24576
    buffer_load_dwordx4 v[88:91], v1, s[8:11], s26 offen offset:3072 sc1
    s_add_u32 s26, s42, 24576
    buffer_load_dwordx4 v[92:95], v1, s[8:11], s26 offen offset:3072 sc1
    s_waitcnt vmcnt(14)
    v_mfma_f32_16x16x32_bf16 v[32:35], a[160:163], v[96:99], v[32:35]
    v_mfma_f32_16x16x32_bf16 v[36:39], a[164:167], v[96:99], v[36:39]
    v_mfma_f32_16x16x32_bf16 v[40:43], a[160:163], v[100:103], v[40:43]
    v_mfma_f32_16x16x32_bf16 v[44:47], a[164:167], v[100:103], v[44:47]
    s_add_u32 s26, s41, 28672
    buffer_load_dwordx4 v[96:99], v1, s[8:11], s26 offen offset:0 sc1
    s_add_u32 s26, s42, 28672
    buffer_load_dwordx4 v[100:103], v1, s[8:11], s26 offen offset:0 sc1
    s_waitcnt vmcnt(14)
    v_mfma_f32_16x16x32_bf16 v[32:35], a[168:171], v[104:107], v[32:35]
    v_mfma_f32_16x16x32_bf16 v[36:39], a[172:175], v[104:107], v[36:39]
    v_mfma_f32_16x16x32_bf16 v[40:43], a[168:171], v[108:111], v[40:43]
    v_mfma_f32_16x16x32_bf16 v[44:47], a[172:175], v[108:111], v[44:47]
    s_add_u32 s26, s41, 28672
    buffer_load_dwordx4 v[104:107], v1, s[8:11], s26 offen offset:1024 sc1
    s_add_u32 s26, s42, 28672
    buffer_load_dwordx4 v[108:111], v1, s[8:11], s26 offen offset:1024 sc1
    s_waitcnt vmcnt(14)
    v_mfma_f32_16x16x32_bf16 v[32:35], a[176:179], v[112:115], v[32:35]
    v_mfma_f32_16x16x32_bf16 v[36:39], a[180:183], v[112:115], v[36:39]
    v_mfma_f32_16x16x32_bf16 v[40:43], a[176:179], v[116:119], v[40:43]
    v_mfma_f32_16x16x32_bf16 v[44:47], a[180:183], v[116:119], v[44:47]
    s_add_u32 s26, s41, 28672
    buffer_load_dwordx4 v[112:115], v1, s[8:11], s26 offen offset:2048 sc1
    s_add_u32 s26, s42, 28672
    buffer_load_dwordx4 v[116:119], v1, s[8:11], s26 offen offset:2048 sc1
    s_waitcnt vmcnt(14)
    v_mfma_f32_16x16x32_bf16 v[32:35], a[184:187], v[120:123], v[32:35]
    v_mfma_f32_16x16x32_bf16 v[36:39], a[188:191], v[120:123], v[36:39]
    v_mfma_f32_16x16x32_bf16 v[40:43], a[184:187], v[124:127], v[40:43]
    v_mfma_f32_16x16x32_bf16 v[44:47], a[188:191], v[124:127], v[44:47]
    s_add_u32 s26, s41, 28672
    buffer_load_dwordx4 v[120:123], v1, s[8:11], s26 offen offset:3072 sc1
    s_add_u32 s26, s42, 28672
    buffer_load_dwordx4 v[124:127], v1, s[8:11], s26 offen offset:3072 sc1
    s_waitcnt vmcnt(14)
    v_mfma_f32_16x16x32_bf16 v[32:35], a[192:195], v[64:67], v[32:35]
    v_mfma_f32_16x16x32_bf16 v[36:39], a[196:199], v[64:67], v[36:39]
    v_mfma_f32_16x16x32_bf16 v[40:43], a[192:195], v[68:71], v[40:43]
    v_mfma_f32_16x16x32_bf16 v[44:47], a[196:199], v[68:71], v[44:47]
    s_waitcnt vmcnt(12)
    v_mfma_f32_16x16x32_bf16 v[32:35], a[200:203], v[72:75], v[32:35]
    v_mfma_f32_16x16x32_bf16 v[36:39], a[204:207], v[72:75], v[36:39]
    v_mfma_f32_16x16x32_bf16 v[40:43], a[200:203], v[76:79], v[40:43]
    v_mfma_f32_16x16x32_bf16 v[44:47], a[204:207], v[76:79], v[44:47]
    s_waitcnt vmcnt(10)
    v_mfma_f32_16x16x32_bf16 v[32:35], a[208:211], v[80:83], v[32:35]
    v_mfma_f32_16x16x32_bf16 v[36:39], a[212:215], v[80:83], v[36:39]
    v_mfma_f32_16x16x32_bf16 v[40:43], a[208:211], v[84:87], v[40:43]
    v_mfma_f32_16x16x32_bf16 v[44:47], a[212:215], v[84:87], v[44:47]
    s_waitcnt vmcnt(8)
    v_mfma_f32_16x16x32_bf16 v[32:35], a[216:219], v[88:91], v[32:35]
    v_mfma_f32_16x16x32_bf16 v[36:39], a[220:223], v[88:91], v[36:39]
    v_mfma_f32_16x16x32_bf16 v[40:43], a[216:219], v[92:95], v[40:43]
    v_mfma_f32_16x16x32_bf16 v[44:47], a[220:223], v[92:95], v[44:47]
    s_waitcnt vmcnt(6)
    v_mfma_f32_16x16x32_bf16 v[32:35], a[224:227], v[96:99], v[32:35]
    v_mfma_f32_16x16x32_bf16 v[36:39], a[228:231], v[96:99], v[36:39]
    v_mfma_f32_16x16x32_bf16 v[40:43], a[224:227], v[100:103], v[40:43]
    v_mfma_f32_16x16x32_bf16 v[44:47], a[228:231], v[100:103], v[44:47]
    s_waitcnt vmcnt(4)
    v_mfma_f32_16x16x32_bf16 v[32:35], a[232:235], v[104:107], v[32:35]
    v_mfma_f32_16x16x32_bf16 v[36:39], a[236:239], v[104:107], v[36:39]
    v_mfma_f32_16x16x32_bf16 v[40:43], a[232:235], v[108:111], v[40:43]
    v_mfma_f32_16x16x32_bf16 v[44:47], a[236:239], v[108:111], v[44:47]
    s_waitcnt vmcnt(2)
    v_mfma_f32_16x16x32_bf16 v[32:35], a[240:243], v[112:115], v[32:35]
    v_mfma_f32_16x16x32_bf16 v[36:39], a[244:247], v[112:115], v[36:39]
    v_mfma_f32_16x16x32_bf16 v[40:43], a[240:243], v[116:119], v[40:43]
    v_mfma_f32_16x16x32_bf16 v[44:47], a[244:247], v[116:119], v[44:47]
    s_waitcnt vmcnt(0)
    v_mfma_f32_16x16x32_bf16 v[32:35], a[248:251], v[120:123], v[32:35]
    v_mfma_f32_16x16x32_bf16 v[36:39], a[252:255], v[120:123], v[36:39]
    v_mfma_f32_16x16x32_bf16 v[40:43], a[248:251], v[124:127], v[40:43]
    v_mfma_f32_16x16x32_bf16 v[44:47], a[252:255], v[124:127], v[44:47]
    ds_write_b128 v17, v[32:35] offset:0
    ds_write_b128 v17, v[36:39] offset:1024
    s_nop 1
    ds_write_b128 v17, v[40:43] offset:2048
    s_nop 2
    ds_write_b128 v17, v[44:47] offset:3072
    s_waitcnt lgkmcnt(0)
    s_barrier
    ds_read_b128 v[64:67], v18 offset:0
    ds_read_b128 v[68:71], v18 offset:4096
    ds_read_b128 v[72:75], v18 offset:8192
    ds_read_b128 v[76:79], v18 offset:12288
    s_waitcnt lgkmcnt(0)
    v_pk_add_f32 v[64:65], v[64:65], v[68:69]
    v_pk_add_f32 v[72:73], v[72:73], v[76:77]
    v_pk_add_f32 v[64:65], v[64:65], v[72:73]
    v_pk_add_f32 v[66:67], v[66:67], v[70:71]
    v_pk_add_f32 v[74:75], v[74:75], v[78:79]
    v_pk_add_f32 v[66:67], v[66:67], v[74:75]
    s_mul_i32 s26, s34, 163840
    buffer_store_dwordx4 v[64:67], v16, s[44:47], s26 offen
    s_barrier
    s_add_u32 s34, s34, 2
    s_cmp_lt_u32 s34, 64
    s_cbranch_scc1 L_proj_3
    s_waitcnt vmcnt(0)
    s_branch L_exit
L_att:
    v_and_b32 v4, 63, v0
    v_lshlrev_b32 v1, 4, v4
    v_and_b32 v2, 15, v4
    v_lshrrev_b32 v3, 4, v4
    v_lshrrev_b32 v5, 6, v0
    s_nop 0
    v_readfirstlane_b32 s24, v5
    s_mov_b32 s61, 120
L_ATT2_next_5:
    s_mov_b32 s61, 120
    s_barrier
    s_cmp_lg_u32 s24, 0
    s_cbranch_scc1 L_fetch_7
    v_mov_b32 v5, s61
    v_mov_b32 v6, 1
    s_mov_b64 exec, 1
    buffer_atomic_add v6, v5, s[20:23], 0 offen sc0
    s_waitcnt vmcnt(0)
    v_mov_b32 v5, 163836
    ds_write_b32 v5, v6
    s_waitcnt lgkmcnt(0)
    s_mov_b64 exec, -1
L_fetch_7:
    s_barrier
    v_mov_b32 v5, 163836
    ds_read_b32 v6, v5
    s_waitcnt lgkmcnt(0)
    v_readfirstlane_b32 s25, v6
    s_cmp_ge_u32 s25, 512
    s_cbranch_scc1 L_ATT2_done_6
    s_lshr_b32 s36, s25, 3
    s_and_b32 s37, s25, 7
    s_cmp_eq_u32 s58, 1
    s_cbranch_scc1 L_zok_8
    v_mov_b32 v10, 40
L_wsp_9:
    buffer_load_dword v11, v10, s[20:23], 0 offen sc1
    s_waitcnt vmcnt(0)
    v_readfirstlane_b32 s29, v11
    s_cmp_ge_u32 s29, 256
    s_cbranch_scc1 L_wsp_9_ok
    s_sleep 2
    s_sub_u32 s38, s38, 1
    s_cbranch_scc0 L_wsp_9
    s_branch L_w_abort
L_wsp_9_ok:
    s_mov_b32 s58, 1
L_zok_8:
    s_lshl_b32 s39, s37, 2
    s_add_u32 s39, s39, s24
    s_lshr_b32 s26, s36, 2
    s_lshl_b32 s26, s26, 5
    s_add_u32 s26, s26, s39
    s_lshl_b32 s40, s26, 2
    s_add_u32 s26, s40, 102762496
    v_mov_b32 v6, s26
L_wsp_10:
    buffer_load_dword v11, v6, s[8:11], 0 offen sc1
    s_waitcnt vmcnt(0)
    v_readfirstlane_b32 s29, v11
    s_cmp_ge_u32 s29, 1
    s_cbranch_scc1 L_wsp_10_ok
    s_sleep 8
    s_sub_u32 s38, s38, 1
    s_cbranch_scc0 L_wsp_10
    s_branch L_w_abort
L_wsp_10_ok:
    s_add_u32 s26, s40, 102760448
    v_mov_b32 v6, s26
L_wsp_11:
    buffer_load_dword v11, v6, s[8:11], 0 offen sc1
    s_waitcnt vmcnt(0)
    v_readfirstlane_b32 s29, v11
    s_cmp_ge_u32 s29, 2
    s_cbranch_scc1 L_wsp_11_ok
    s_sleep 8
    s_sub_u32 s38, s38, 1
    s_cbranch_scc0 L_wsp_11
    s_branch L_w_abort
L_wsp_11_ok:
    s_lshl_b32 s26, s36, 5
    s_add_u32 s26, s26, s39
    s_lshl_b32 s40, s26, 13
    s_add_u32 s41, s40, 33554432
    s_add_u32 s42, s41, 4096
    buffer_load_dwordx4 v[32:35], v1, s[8:11], s41 offen offset:0 sc1
    buffer_load_dwordx4 v[36:39], v1, s[8:11], s41 offen offset:1024 sc1
    buffer_load_dwordx4 v[40:43], v1, s[8:11], s41 offen offset:2048 sc1
    buffer_load_dwordx4 v[44:47], v1, s[8:11], s41 offen offset:3072 sc1
    buffer_load_dwordx4 v[48:51], v1, s[8:11], s42 offen offset:0 sc1
    buffer_load_dwordx4 v[52:55], v1, s[8:11], s42 offen offset:1024 sc1
    buffer_load_dwordx4 v[56:59], v1, s[8:11], s42 offen offset:2048 sc1
    buffer_load_dwordx4 v[60:63], v1, s[8:11], s42 offen offset:3072 sc1
    s_add_u32 s41, s40, 0
    s_add_u32 s42, s41, 4096
    buffer_load_dwordx4 v[64:67], v1, s[8:11], s41 offen offset:0 sc1
    buffer_load_dwordx4 v[68:71], v1, s[8:11], s41 offen offset:1024 sc1
    buffer_load_dwordx4 v[72:75], v1, s[8:11], s41 offen offset:2048 sc1
    buffer_load_dwordx4 v[76:79], v1, s[8:11], s41 offen offset:3072 sc1
    buffer_load_dwordx4 v[80:83], v1, s[8:11], s42 offen offset:0 sc1
    buffer_load_dwordx4 v[84:87], v1, s[8:11], s42 offen offset:1024 sc1
    buffer_load_dwordx4 v[88:91], v1, s[8:11], s42 offen offset:2048 sc1
    buffer_load_dwordx4 v[92:95], v1, s[8:11], s42 offen offset:3072 sc1
    s_add_u32 s41, s40, 16777216
    s_add_u32 s42, s41, 4096
    buffer_load_dwordx4 v[112:115], v1, s[8:11], s41 offen offset:0 sc1
    buffer_load_dwordx4 v[116:119], v1, s[8:11], s41 offen offset:1024 sc1
    buffer_load_dwordx4 v[120:123], v1, s[8:11], s41 offen offset:2048 sc1
    buffer_load_dwordx4 v[124:127], v1, s[8:11], s41 offen offset:3072 sc1
    buffer_load_dwordx4 v[128:131], v1, s[8:11], s42 offen offset:0 sc1
    buffer_load_dwordx4 v[132:135], v1, s[8:11], s42 offen offset:1024 sc1
    buffer_load_dwordx4 v[136:139], v1, s[8:11], s42 offen offset:2048 sc1
    buffer_load_dwordx4 v[140:143], v1, s[8:11], s42 offen offset:3072 sc1
    s_add_u32 s34, s36, 1
    s_lshl_b32 s26, s39, 7
    s_add_u32 s26, s26, 102764544
    v_mov_b32 v6, s26
L_wsp_12:
    buffer_load_dword v11, v6, s[8:11], 0 offen sc1
    s_waitcnt vmcnt(0)
    v_readfirstlane_b32 s29, v11
    s_cmp_ge_u32 s29, s34
    s_cbranch_scc1 L_wsp_12_ok
    s_sleep 16
    s_sub_u32 s38, s38, 1
    s_cbranch_scc0 L_wsp_12
    s_branch L_w_abort
L_wsp_12_ok:
    s_lshl_b32 s26, s39, 7
    s_add_u32 s26, s26, 102764608
    v_mov_b32 v6, s26
L_wsp_13:
    buffer_load_dword v11, v6, s[8:11], 0 offen sc1
    s_waitcnt vmcnt(0)
    v_readfirstlane_b32 s29, v11
    s_cmp_ge_u32 s29, s34
    s_cbranch_scc1 L_wsp_13_ok
    s_sleep 16
    s_sub_u32 s38, s38, 1
    s_cbranch_scc0 L_wsp_13
    s_branch L_w_abort
L_wsp_13_ok:
    s_lshl_b32 s26, s36, 5
    s_add_u32 s26, s26, s39
    s_lshl_b32 s27, s26, 12
    s_add_u32 s41, s27, 50331648
    s_lshl_b32 s27, s26, 11
    s_add_u32 s42, s27, 58720256
    v_lshlrev_b32 v5, 3, v4
    buffer_load_dwordx4 v[96:99], v1, s[8:11], s41 offen offset:0 sc1
    buffer_load_dwordx4 v[100:103], v1, s[8:11], s41 offen offset:1024 sc1
    buffer_load_dwordx4 v[104:107], v1, s[8:11], s41 offen offset:2048 sc1
    buffer_load_dwordx4 v[108:111], v1, s[8:11], s41 offen offset:3072 sc1
    buffer_load_dwordx2 v[144:145], v5, s[8:11], s42 offen offset:0 sc1
    buffer_load_dwordx2 v[146:147], v5, s[8:11], s42 offen offset:512 sc1
    buffer_load_dwordx2 v[148:149], v5, s[8:11], s42 offen offset:1024 sc1
    buffer_load_dwordx2 v[150:151], v5, s[8:11], s42 offen offset:1536 sc1
    s_mov_b32 s54, 0x3e0293ee
    s_mov_b32 s55, 0x3e0293ee
    v_mov_b32 v169, 0
    v_mov_b32 v213, 0
    v_lshlrev_b32 v7, 2, v3
    v_sub_u32 v7, v2, v7
    v_mov_b32 v8, 0xf149f2ca
    s_waitcnt vmcnt(0)
    v_mfma_f32_16x16x32_bf16 v[156:159], v[64:67], v[32:35], 0
    v_mfma_f32_16x16x32_bf16 v[152:155], v[96:99], v[32:35], 0
    v_mfma_f32_16x16x32_bf16 v[156:159], v[68:71], v[36:39], v[156:159]
    v_mfma_f32_16x16x32_bf16 v[152:155], v[100:103], v[36:39], v[152:155]
    v_mfma_f32_16x16x32_bf16 v[156:159], v[72:75], v[40:43], v[156:159]
    v_mfma_f32_16x16x32_bf16 v[152:155], v[104:107], v[40:43], v[152:155]
    v_mfma_f32_16x16x32_bf16 v[156:159], v[76:79], v[44:47], v[156:159]
    v_mfma_f32_16x16x32_bf16 v[152:155], v[108:111], v[44:47], v[152:155]
    v_cmp_le_i32 vcc, 0, v7
    s_nop 2
    v_cndmask_b32 v156, v8, v156, vcc
    v_cmp_le_i32 vcc, 1, v7
    s_nop 1
    v_cndmask_b32 v157, v8, v157, vcc
    v_cmp_le_i32 vcc, 2, v7
    s_nop 1
    v_cndmask_b32 v158, v8, v158, vcc
    v_cmp_le_i32 vcc, 3, v7
    s_nop 1
    v_cndmask_b32 v159, v8, v159, vcc
    v_max_f32 v170, v152, v153
    v_max_f32 v170, v170, v156
    v_max_f32 v170, v170, v157
    v_max_f32 v170, v170, v158
    v_max_f32 v170, v170, v159
    v_mov_b32 v9, v170
    s_nop 1
    v_permlane16_swap_b32 v170, v9
    v_max_f32 v170, v170, v9
    v_mov_b32 v9, v170
    s_nop 1
    v_permlane32_swap_b32 v170, v9
    v_max_f32 v170, v170, v9
    v_mul_f32 v170, s54, v170
    v_fma_f32 v156, v156, s54, -v170
    v_fma_f32 v157, v157, s54, -v170
    v_fma_f32 v158, v158, s54, -v170
    v_fma_f32 v159, v159, s54, -v170
    v_fma_f32 v152, v152, s54, -v170
    v_fma_f32 v153, v153, s54, -v170
    v_exp_f32 v156, v156
    v_exp_f32 v157, v157
    v_exp_f32 v158, v158
    v_exp_f32 v159, v159
    v_exp_f32 v152, v152
    v_exp_f32 v153, v153
    v_cvt_pk_bf16_f32 v164, v156, v157
    v_cvt_pk_bf16_f32 v165, v158, v159
    v_mov_b32 v166, 0
    v_mov_b32 v167, 0
    v_cvt_pk_bf16_f32 v168, v152, v153
    v_add_f32 v171, v156, v157
    v_add_f32 v171, v171, v158
    v_add_f32 v171, v171, v159
    v_add_f32 v171, v171, v152
    v_add_f32 v171, v171, v153
    v_mov_b32 v9, v171
    s_nop 1
    v_permlane16_swap_b32 v171, v9
    v_add_f32 v171, v171, v9
    v_mov_b32 v9, v171
    s_nop 1
    v_permlane32_swap_b32 v171, v9
    v_add_f32 v171, v171, v9
    v_rcp_f32 v171, v171
    v_mfma_f32_16x16x32_bf16 v[172:175], v[112:115], v[164:167], 0
    v_mfma_f32_16x16x32_bf16 v[176:179], v[116:119], v[164:167], 0
    v_mfma_f32_16x16x32_bf16 v[180:183], v[120:123], v[164:167], 0
    v_mfma_f32_16x16x32_bf16 v[184:187], v[124:127], v[164:167], 0
    v_mfma_f32_16x16x32_bf16 v[188:191], v[128:131], v[164:167], 0
    v_mfma_f32_16x16x32_bf16 v[192:195], v[132:135], v[164:167], 0
    v_mfma_f32_16x16x32_bf16 v[196:199], v[136:139], v[164:167], 0
    v_mfma_f32_16x16x32_bf16 v[200:203], v[140:143], v[164:167], 0
    v_mov_b32 v212, v144
    s_nop 1
    v_mfma_f32_16x16x16_bf16 v[172:175], v[212:213], v[168:169], v[172:175]
    v_mov_b32 v212, v145
    s_nop 1
    v_mfma_f32_16x16x16_bf16 v[176:179], v[212:213], v[168:169], v[176:179]
    v_mov_b32 v212, v146
    s_nop 1
    v_mfma_f32_16x16x16_bf16 v[180:183], v[212:213], v[168:169], v[180:183]
    v_mov_b32 v212, v147
    s_nop 1
    v_mfma_f32_16x16x16_bf16 v[184:187], v[212:213], v[168:169], v[184:187]
    v_mov_b32 v212, v148
    s_nop 1
    v_mfma_f32_16x16x16_bf16 v[188:191], v[212:213], v[168:169], v[188:191]
    v_mov_b32 v212, v149
    s_nop 1
    v_mfma_f32_16x16x16_bf16 v[192:195], v[212:213], v[168:169], v[192:195]
    v_mov_b32 v212, v150
    s_nop 1
    v_mfma_f32_16x16x16_bf16 v[196:199], v[212:213], v[168:169], v[196:199]
    v_mov_b32 v212, v151
    s_nop 1
    v_mfma_f32_16x16x16_bf16 v[200:203], v[212:213], v[168:169], v[200:203]
    s_lshl_b32 s26, s36, 1
    s_add_u32 s26, s26, 0
    s_lshl_b32 s26, s26, 7
    s_lshl_b32 s27, s39, 2
    s_add_u32 s26, s26, s27
    s_lshl_b32 s26, s26, 10
    s_add_u32 s26, s26, 67108864
    v_mul_f32 v172, v172, v171
    v_mul_f32 v173, v173, v171
    v_mul_f32 v174, v174, v171
    v_mul_f32 v175, v175, v171
    v_cvt_pk_bf16_f32 v204, v172, v173
    v_cvt_pk_bf16_f32 v205, v174, v175
    v_mul_f32 v176, v176, v171
    v_mul_f32 v177, v177, v171
    v_mul_f32 v178, v178, v171
    v_mul_f32 v179, v179, v171
    v_cvt_pk_bf16_f32 v206, v176, v177
    v_cvt_pk_bf16_f32 v207, v178, v179
    buffer_store_dwordx4 v[204:207], v1, s[8:11], s26 offen offset:0 sc1
    v_mul_f32 v180, v180, v171
    v_mul_f32 v181, v181, v171
    v_mul_f32 v182, v182, v171
    v_mul_f32 v183, v183, v171
    v_cvt_pk_bf16_f32 v208, v180, v181
    v_cvt_pk_bf16_f32 v209, v182, v183
    v_mul_f32 v184, v184, v171
    v_mul_f32 v185, v185, v171
    v_mul_f32 v186, v186, v171
    v_mul_f32 v187, v187, v171
    v_cvt_pk_bf16_f32 v210, v184, v185
    v_cvt_pk_bf16_f32 v211, v186, v187
    buffer_store_dwordx4 v[208:211], v1, s[8:11], s26 offen offset:1024 sc1
    v_mul_f32 v188, v188, v171
    v_mul_f32 v189, v189, v171
    v_mul_f32 v190, v190, v171
    v_mul_f32 v191, v191, v171
    v_cvt_pk_bf16_f32 v204, v188, v189
    v_cvt_pk_bf16_f32 v205, v190, v191
    v_mul_f32 v192, v192, v171
    v_mul_f32 v193, v193, v171
    v_mul_f32 v194, v194, v171
    v_mul_f32 v195, v195, v171
    v_cvt_pk_bf16_f32 v206, v192, v193
    v_cvt_pk_bf16_f32 v207, v194, v195
    buffer_store_dwordx4 v[204:207], v1, s[8:11], s26 offen offset:2048 sc1
    v_mul_f32 v196, v196, v171
    v_mul_f32 v197, v197, v171
    v_mul_f32 v198, v198, v171
    v_mul_f32 v199, v199, v171
    v_cvt_pk_bf16_f32 v208, v196, v197
    v_cvt_pk_bf16_f32 v209, v198, v199
    v_mul_f32 v200, v200, v171
    v_mul_f32 v201, v201, v171
    v_mul_f32 v202, v202, v171
    v_mul_f32 v203, v203, v171
    v_cvt_pk_bf16_f32 v210, v200, v201
    v_cvt_pk_bf16_f32 v211, v202, v203
    buffer_store_dwordx4 v[208:211], v1, s[8:11], s26 offen offset:3072 sc1
    v_mfma_f32_16x16x32_bf16 v[156:159], v[64:67], v[48:51], 0
    v_mfma_f32_16x16x32_bf16 v[160:163], v[80:83], v[48:51], 0
    v_mfma_f32_16x16x32_bf16 v[152:155], v[96:99], v[48:51], 0
    v_mfma_f32_16x16x32_bf16 v[156:159], v[68:71], v[52:55], v[156:159]
    v_mfma_f32_16x16x32_bf16 v[160:163], v[84:87], v[52:55], v[160:163]
    v_mfma_f32_16x16x32_bf16 v[152:155], v[100:103], v[52:55], v[152:155]
    v_mfma_f32_16x16x32_bf16 v[156:159], v[72:75], v[56:59], v[156:159]
    v_mfma_f32_16x16x32_bf16 v[160:163], v[88:91], v[56:59], v[160:163]
    v_mfma_f32_16x16x32_bf16 v[152:155], v[104:107], v[56:59], v[152:155]
    v_mfma_f32_16x16x32_bf16 v[156:159], v[76:79], v[60:63], v[156:159]
    v_mfma_f32_16x16x32_bf16 v[160:163], v[92:95], v[60:63], v[160:163]
    v_mfma_f32_16x16x32_bf16 v[152:155], v[108:111], v[60:63], v[152:155]
    v_cmp_le_i32 vcc, 0, v7
    s_nop 2
    v_cndmask_b32 v160, v8, v160, vcc
    v_cmp_le_i32 vcc, 1, v7
    s_nop 1
    v_cndmask_b32 v161, v8, v161, vcc
    v_cmp_le_i32 vcc, 2, v7
    s_nop 1
    v_cndmask_b32 v162, v8, v162, vcc
    v_cmp_le_i32 vcc, 3, v7
    s_nop 1
    v_cndmask_b32 v163, v8, v163, vcc
    v_max_f32 v170, v152, v153
    v_max_f32 v170, v170, v156
    v_max_f32 v170, v170, v157
    v_max_f32 v170, v170, v158
    v_max_f32 v170, v170, v159
    v_max_f32 v170, v170, v160
    v_max_f32 v170, v170, v161
    v_max_f32 v170, v170, v162
    v_max_f32 v170, v170, v163
    v_mov_b32 v9, v170
    s_nop 1
    v_permlane16_swap_b32 v170, v9
    v_max_f32 v170, v170, v9
    v_mov_b32 v9, v170
    s_nop 1
    v_permlane32_swap_b32 v170, v9
    v_max_f32 v170, v170, v9
    v_mul_f32 v170, s54, v170
    v_fma_f32 v156, v156, s54, -v170
    v_fma_f32 v157, v157, s54, -v170
    v_fma_f32 v158, v158, s54, -v170
    v_fma_f32 v159, v159, s54, -v170
    v_fma_f32 v160, v160, s54, -v170
    v_fma_f32 v161, v161, s54, -v170
    v_fma_f32 v162, v162, s54, -v170
    v_fma_f32 v163, v163, s54, -v170
    v_fma_f32 v152, v152, s54, -v170
    v_fma_f32 v153, v153, s54, -v170
    v_exp_f32 v156, v156
    v_exp_f32 v157, v157
    v_exp_f32 v158, v158
    v_exp_f32 v159, v159
    v_exp_f32 v160, v160
    v_exp_f32 v161, v161
    v_exp_f32 v162, v162
    v_exp_f32 v163, v163
    v_exp_f32 v152, v152
    v_exp_f32 v153, v153
    v_cvt_pk_bf16_f32 v164, v156, v157
    v_cvt_pk_bf16_f32 v165, v158, v159
    v_cvt_pk_bf16_f32 v166, v160, v161
    v_cvt_pk_bf16_f32 v167, v162, v163
    v_cvt_pk_bf16_f32 v168, v152, v153
    v_add_f32 v171, v156, v157
    v_add_f32 v171, v171, v158
    v_add_f32 v171, v171, v159
    v_add_f32 v171, v171, v160
    v_add_f32 v171, v171, v161
    v_add_f32 v171, v171, v162
    v_add_f32 v171, v171, v163
    v_add_f32 v171, v171, v152
    v_add_f32 v171, v171, v153
    v_mov_b32 v9, v171
    s_nop 1
    v_permlane16_swap_b32 v171, v9
    v_add_f32 v171, v171, v9
    v_mov_b32 v9, v171
    s_nop 1
    v_permlane32_swap_b32 v171, v9
    v_add_f32 v171, v171, v9
    v_rcp_f32 v171, v171
    v_mfma_f32_16x16x32_bf16 v[172:175], v[112:115], v[164:167], 0
    v_mfma_f32_16x16x32_bf16 v[176:179], v[116:119], v[164:167], 0
    v_mfma_f32_16x16x32_bf16 v[180:183], v[120:123], v[164:167], 0
    v_mfma_f32_16x16x32_bf16 v[184:187], v[124:127], v[164:167], 0
    v_mfma_f32_16x16x32_bf16 v[188:191], v[128:131], v[164:167], 0
    v_mfma_f32_16x16x32_bf16 v[192:195], v[132:135], v[164:167], 0
    v_mfma_f32_16x16x32_bf16 v[196:199], v[136:139], v[164:167], 0
    v_mfma_f32_16x16x32_bf16 v[200:203], v[140:143], v[164:167], 0
    v_mov_b32 v212, v144
    s_nop 1
    v_mfma_f32_16x16x16_bf16 v[172:175], v[212:213], v[168:169], v[172:175]
    v_mov_b32 v212, v145
    s_nop 1
    v_mfma_f32_16x16x16_bf16 v[176:179], v[212:213], v[168:169], v[176:179]
    v_mov_b32 v212, v146
    s_nop 1
    v_mfma_f32_16x16x16_bf16 v[180:183], v[212:213], v[168:169], v[180:183]
    v_mov_b32 v212, v147
    s_nop 1
    v_mfma_f32_16x16x16_bf16 v[184:187], v[212:213], v[168:169], v[184:187]
    v_mov_b32 v212, v148
    s_nop 1
    v_mfma_f32_16x16x16_bf16 v[188:191], v[212:213], v[168:169], v[188:191]
    v_mov_b32 v212, v149
    s_nop 1
    v_mfma_f32_16x16x16_bf16 v[192:195], v[212:213], v[168:169], v[192:195]
    v_mov_b32 v212, v150
    s_nop 1
    v_mfma_f32_16x16x16_bf16 v[196:199], v[212:213], v[168:169], v[196:199]
    v_mov_b32 v212, v151
    s_nop 1
    v_mfma_f32_16x16x16_bf16 v[200:203], v[212:213], v[168:169], v[200:203]
    s_lshl_b32 s26, s36, 1
    s_add_u32 s26, s26, 1
    s_lshl_b32 s26, s26, 7
    s_lshl_b32 s27, s39, 2
    s_add_u32 s26, s26, s27
    s_lshl_b32 s26, s26, 10
    s_add_u32 s26, s26, 67108864
    v_mul_f32 v172, v172, v171
    v_mul_f32 v173, v173, v171
    v_mul_f32 v174, v174, v171
    v_mul_f32 v175, v175, v171
    v_cvt_pk_bf16_f32 v204, v172, v173
    v_cvt_pk_bf16_f32 v205, v174, v175
    v_mul_f32 v176, v176, v171
    v_mul_f32 v177, v177, v171
    v_mul_f32 v178, v178, v171
    v_mul_f32 v179, v179, v171
    v_cvt_pk_bf16_f32 v206, v176, v177
    v_cvt_pk_bf16_f32 v207, v178, v179
    buffer_store_dwordx4 v[204:207], v1, s[8:11], s26 offen offset:0 sc1
    v_mul_f32 v180, v180, v171
    v_mul_f32 v181, v181, v171
    v_mul_f32 v182, v182, v171
    v_mul_f32 v183, v183, v171
    v_cvt_pk_bf16_f32 v208, v180, v181
    v_cvt_pk_bf16_f32 v209, v182, v183
    v_mul_f32 v184, v184, v171
    v_mul_f32 v185, v185, v171
    v_mul_f32 v186, v186, v171
    v_mul_f32 v187, v187, v171
    v_cvt_pk_bf16_f32 v210, v184, v185
    v_cvt_pk_bf16_f32 v211, v186, v187
    buffer_store_dwordx4 v[208:211], v1, s[8:11], s26 offen offset:1024 sc1
    v_mul_f32 v188, v188, v171
    v_mul_f32 v189, v189, v171
    v_mul_f32 v190, v190, v171
    v_mul_f32 v191, v191, v171
    v_cvt_pk_bf16_f32 v204, v188, v189
    v_cvt_pk_bf16_f32 v205, v190, v191
    v_mul_f32 v192, v192, v171
    v_mul_f32 v193, v193, v171
    v_mul_f32 v194, v194, v171
    v_mul_f32 v195, v195, v171
    v_cvt_pk_bf16_f32 v206, v192, v193
    v_cvt_pk_bf16_f32 v207, v194, v195
    buffer_store_dwordx4 v[204:207], v1, s[8:11], s26 offen offset:2048 sc1
    v_mul_f32 v196, v196, v171
    v_mul_f32 v197, v197, v171
    v_mul_f32 v198, v198, v171
    v_mul_f32 v199, v199, v171
    v_cvt_pk_bf16_f32 v208, v196, v197
    v_cvt_pk_bf16_f32 v209, v198, v199
    v_mul_f32 v200, v200, v171
    v_mul_f32 v201, v201, v171
    v_mul_f32 v202, v202, v171
    v_mul_f32 v203, v203, v171
    v_cvt_pk_bf16_f32 v210, v200, v201
    v_cvt_pk_bf16_f32 v211, v202, v203
    buffer_store_dwordx4 v[208:211], v1, s[8:11], s26 offen offset:3072 sc1
    s_lshl_b32 s26, s36, 2
    s_add_u32 s39, s26, 102770176
    s_cmp_eq_u32 s58, 1
    s_cbranch_scc1 L_zok_14
    v_mov_b32 v10, 40
L_wsp_15:
    buffer_load_dword v11, v10, s[20:23], 0 offen sc1
    s_waitcnt vmcnt(0)
    v_readfirstlane_b32 s29, v11
    s_cmp_ge_u32 s29, 256
    s_cbranch_scc1 L_wsp_15_ok
    s_sleep 2
    s_sub_u32 s38, s38, 1
    s_cbranch_scc0 L_wsp_15
    s_branch L_w_abort
L_wsp_15_ok:
    s_mov_b32 s58, 1
L_zok_14:
    s_waitcnt vmcnt(0)
    s_barrier
    s_cmp_lg_u32 s24, 0
    s_cbranch_scc1 L_sig_16
    v_mov_b32 v5, s39
    v_mov_b32 v6, 1
    s_mov_b64 exec, 1
    buffer_atomic_add v6, v5, s[8:11], 0 offen sc1
    s_mov_b64 exec, -1
L_sig_16:
    s_branch L_ATT2_next_5
L_ATT2_done_6:
    s_branch L_exit
L_generic:
    s_cmp_lg_u32 s18, 2
    s_cbranch_scc1 L_generic2
    s_cmp_lg_u32 s17, 936+0
    s_cbranch_scc1 L_generic2
    v_and_b32 v4, 63, v0
    v_lshlrev_b32 v1, 4, v4
    v_and_b32 v2, 15, v4
    v_lshrrev_b32 v3, 4, v4
    v_lshrrev_b32 v5, 6, v0
    s_nop 0
    v_readfirstlane_b32 s24, v5
    s_cmp_lg_u32 s24, 0
    s_cbranch_scc1 L_noprobe_17
    s_sub_u32 s26, 0, s8
    s_and_b32 s26, s26, 0x1fffff
    s_add_u32 s39, s26, 104861440
    s_mov_b32 s40, -1
    s_mov_b32 s41, -1
    s_mov_b32 s34, 0
    v_mov_b32 v5, 0
    v_mov_b32 v6, 0
    s_mov_b64 exec, 1
L_probe_18:
    s_add_u32 s26, s39, 0
    s_memtime s[64:65]
    s_waitcnt lgkmcnt(0)
    buffer_store_dword v6, v5, s[8:11], s26 offen sc1
    s_waitcnt vmcnt(0)
    s_memtime s[66:67]
    s_waitcnt lgkmcnt(0)
    s_sub_u32 s27, s66, s64
    s_min_u32 s40, s40, s27
    s_add_u32 s26, s39, 8192
    s_memtime s[64:65]
    s_waitcnt lgkmcnt(0)
    buffer_store_dword v6, v5, s[8:11], s26 offen sc1
    s_waitcnt vmcnt(0)
    s_memtime s[66:67]
    s_waitcnt lgkmcnt(0)
    s_sub_u32 s27, s66, s64
    s_min_u32 s41, s41, s27
    s_add_u32 s39, s39, 32768
    s_add_u32 s34, s34, 1
    s_cmp_lt_u32 s34, 4
    s_cbranch_scc1 L_probe_18
    s_mov_b64 exec, -1
    s_cmp_le_u32 s40, s41
    s_cselect_b32 s42, 1, 2
    s_cmp_eq_u32 s58, 1
    s_cbranch_scc1 L_zok_19
    v_mov_b32 v10, 40
L_wsp_20:
    buffer_load_dword v11, v10, s[20:23], 0 offen sc1
    s_waitcnt vmcnt(0)
    v_readfirstlane_b32 s29, v11
    s_cmp_ge_u32 s29, 256
    s_cbranch_scc1 L_wsp_20_ok
    s_sleep 2
    s_sub_u32 s38, s38, 1
    s_cbranch_scc0 L_wsp_20
    s_branch L_w_abort
L_wsp_20_ok:
    s_mov_b32 s58, 1
L_zok_19:
    v_mov_b32 v5, 102770688
    v_mov_b32 v6, s42
    s_mov_b64 exec, 1
    buffer_store_dword v6, v5, s[8:11], 0 offen sc1
    s_mov_b64 exec, -1
    s_waitcnt vmcnt(0)
L_noprobe_17:
L_generic2:
    v_and_b32 v4, 63, v0
    v_lshlrev_b32 v1, 4, v4
    v_and_b32 v2, 15, v4
    v_lshrrev_b32 v3, 4, v4
    v_lshrrev_b32 v5, 6, v0
    s_nop 0
    v_readfirstlane_b32 s24, v5
    s_mov_b32 s60, 0
L_kvq_q_22:
    s_add_u32 s63, s59, s60
    s_sub_u32 s26, s63, 6
    s_cmp_ge_u32 s63, 6
    s_cselect_b32 s63, s26, s63
    s_lshl_b32 s26, s63, 3
    s_lshl_b32 s27, s63, 2
    s_add_u32 s27, s27, 8
    s_cmp_lt_u32 s63, 2
    s_cselect_b32 s62, 3, 2
    s_cselect_b32 s57, s26, s27
    s_lshl_b32 s61, s63, 2
    s_add_u32 s61, s61, 64
L_kvq_next_21:
    s_barrier
    s_cmp_lg_u32 s24, 0
    s_cbranch_scc1 L_fetch_23
    v_mov_b32 v5, s61
    v_mov_b32 v6, 1
    s_mov_b64 exec, 1
    buffer_atomic_add v6, v5, s[20:23], 0 offen sc0
    s_waitcnt vmcnt(0)
    v_mov_b32 v5, 163836
    ds_write_b32 v5, v6
    s_waitcnt lgkmcnt(0)
    s_mov_b64 exec, -1
L_fetch_23:
    s_barrier
    v_mov_b32 v5, 163836
    ds_read_b32 v6, v5
    s_waitcnt lgkmcnt(0)
    v_readfirstlane_b32 s25, v6
    s_lshl_b32 s26, 8, s62
    s_cmp_ge_u32 s25, s26
    s_cbranch_scc1 L_kvq_B_25
    s_add_u32 s27, s62, 1
    s_lshr_b32 s36, s25, s27
    s_lshl_b32 s26, s36, s27
    s_sub_u32 s26, s25, s26
    s_lshr_b32 s27, s26, 1
    s_add_u32 s37, s27, s57
    s_bitcmp1_b32 s26, 0
    s_cbranch_scc1 L_isV_27
    s_load_dwordx2 s[4:5], s[0:1], 0
    s_waitcnt lgkmcnt(0)
    s_mov_b32 s12, s4
    s_mov_b32 s13, s5
    s_mov_b32 s14, 2621440
    s_mov_b32 s15, 0x20000
    s_load_dwordx2 s[4:5], s[0:1], 24
    s_waitcnt lgkmcnt(0)
    s_mov_b32 s16, s4
    s_mov_b32 s17, s5
    s_mov_b32 s18, 5242880
    s_mov_b32 s19, 0x20000
    v_lshrrev_b32 v5, 3, v4
    v_and_b32 v6, 7, v4
    v_xor_b32 v6, v6, v5
    s_lshl_b32 s26, s24, 5
    v_add_u32 v5, s26, v5
    s_mov_b32 s26, 1280
    v_mul_lo_u32 v5, v5, s26
    v_lshl_add_u32 v12, v6, 4, v5
    v_add_u32 v13, 10240, v12
    v_add_u32 v14, 20480, v12
    v_add_u32 v15, 30720, v12
    v_lshrrev_b32 v5, 4, v4
    v_and_b32 v6, 15, v4
    v_lshlrev_b32 v7, 1, v5
    v_xor_b32 v6, v6, v7
    s_lshl_b32 s26, s24, 4
    v_add_u32 v5, s26, v5
    s_mov_b32 s26, 8192
    v_mul_lo_u32 v5, v5, s26
    v_lshl_add_u32 v16, v6, 4, v5
    v_xor_b32 v6, 8, v6
    v_lshl_add_u32 v18, v6, 4, v5
    v_add_u32 v17, 32768, v16
    v_add_u32 v19, 98304, v18
    v_add_u32 v18, 65536, v18
    s_mul_i32 s30, s36, 163840
    s_lshl_b32 s31, s37, 8
    s_mov_b32 s52, 128
    s_mov_b32 s53, 524288
    s_lshr_b32 s39, s24, 1
    s_and_b32 s40, s24, 1
    s_lshl_b32 s41, s40, 6
    s_lshl_b32 s42, s39, 2
    v_add_u32 v5, s41, v2
    v_lshlrev_b32 v5, 7, v5
    v_and_b32 v6, 7, v2
    v_xor_b32 v6, v6, v3
    v_lshl_add_u32 v20, v6, 4, v5
    v_add_u32 v20, 0, v20
    v_xor_b32 v21, 64, v20
    v_lshrrev_b32 v5, 2, v2
    v_and_b32 v6, 3, v2
    v_lshl_add_u32 v7, v3, 3, v5
    v_lshlrev_b32 v7, 8, v7
    v_and_b32 v8, 1, v3
    v_lshl_or_b32 v8, v8, 2, v5
    v_lshl_add_u32 v7, v8, 5, v7
    v_lshrrev_b32 v8, 1, v6
    v_lshl_add_u32 v7, v8, 4, v7
    v_and_b32 v8, 1, v6
    v_lshl_add_u32 v7, v8, 3, v7
    s_lshl_b32 s26, s42, 5
    s_add_u32 s27, s26, 0
    v_xor_b32 v22, s27, v7
    v_add_u32 v22, 16384, v22
    s_add_u32 s27, s26, 32
    v_xor_b32 v23, s27, v7
    v_add_u32 v23, 16384, v23
    s_add_u32 s27, s26, 64
    v_xor_b32 v24, s27, v7
    v_add_u32 v24, 16384, v24
    s_add_u32 s27, s26, 96
    v_xor_b32 v25, s27, v7
    v_add_u32 v25, 16384, v25
    s_lshl_b32 s33, s24, 12
    s_add_u32 m0, s33, 0
    s_nop 0
    buffer_load_dwordx4 v12, s[12:15], s30 offen lds
    s_add_u32 m0, s33, 1024
    s_nop 0
    buffer_load_dwordx4 v13, s[12:15], s30 offen lds
    s_add_u32 m0, s33, 2048
    s_nop 0
    buffer_load_dwordx4 v14, s[12:15], s30 offen lds
    s_add_u32 m0, s33, 3072
    s_nop 0
    buffer_load_dwordx4 v15, s[12:15], s30 offen lds
    s_add_u32 m0, s33, 16384
    s_nop 0
    buffer_load_dwordx4 v16, s[16:19], s31 offen lds
    s_add_u32 m0, s33, 17408
    s_nop 0
    buffer_load_dwordx4 v17, s[16:19], s31 offen lds
    s_add_u32 m0, s33, 18432
    s_nop 0
    buffer_load_dwordx4 v18, s[16:19], s31 offen lds
    s_add_u32 m0, s33, 19456
    s_nop 0
    buffer_load_dwordx4 v19, s[16:19], s31 offen lds
    s_add_u32 s30, s30, s52
    s_add_u32 s31, s31, s53
    s_add_u32 s33, s33, 32768
    s_add_u32 m0, s33, 0
    s_nop 0
    buffer_load_dwordx4 v12, s[12:15], s30 offen lds
    s_add_u32 m0, s33, 1024
    s_nop 0
    buffer_load_dwordx4 v13, s[12:15], s30 offen lds
    s_add_u32 m0, s33, 2048
    s_nop 0
    buffer_load_dwordx4 v14, s[12:15], s30 offen lds
    s_add_u32 m0, s33, 3072
    s_nop 0
    buffer_load_dwordx4 v15, s[12:15], s30 offen lds
    s_add_u32 m0, s33, 16384
    s_nop 0
    buffer_load_dwordx4 v16, s[16:19], s31 offen lds
    s_add_u32 m0, s33, 17408
    s_nop 0
    buffer_load_dwordx4 v17, s[16:19], s31 offen lds
    s_add_u32 m0, s33, 18432
    s_nop 0
    buffer_load_dwordx4 v18, s[16:19], s31 offen lds
    s_add_u32 m0, s33, 19456
    s_nop 0
    buffer_load_dwordx4 v19, s[16:19], s31 offen lds
    s_add_u32 s30, s30, s52
    s_add_u32 s31, s31, s53
    s_add_u32 s33, s33, 32768
    s_mov_b32 s32, 0
    v_mov_b32 v64, 0
    v_mov_b32 v65, 0
    v_mov_b32 v66, 0
    v_mov_b32 v67, 0
    v_mov_b32 v68, 0
    v_mov_b32 v69, 0
    v_mov_b32 v70, 0
    v_mov_b32 v71, 0
    v_mov_b32 v72, 0
    v_mov_b32 v73, 0
    v_mov_b32 v74, 0
    v_mov_b32 v75, 0
    v_mov_b32 v76, 0
    v_mov_b32 v77, 0
    v_mov_b32 v78, 0
    v_mov_b32 v79, 0
    v_mov_b32 v80, 0
    v_mov_b32 v81, 0
    v_mov_b32 v82, 0
    v_mov_b32 v83, 0
    v_mov_b32 v84, 0
    v_mov_b32 v85, 0
    v_mov_b32 v86, 0
    v_mov_b32 v87, 0
    v_mov_b32 v88, 0
    v_mov_b32 v89, 0
    v_mov_b32 v90, 0
    v_mov_b32 v91, 0
    v_mov_b32 v92, 0
    v_mov_b32 v93, 0
    v_mov_b32 v94, 0
    v_mov_b32 v95, 0
    v_mov_b32 v96, 0
    v_mov_b32 v97, 0
    v_mov_b32 v98, 0
    v_mov_b32 v99, 0
    v_mov_b32 v100, 0
    v_mov_b32 v101, 0
    v_mov_b32 v102, 0
    v_mov_b32 v103, 0
    v_mov_b32 v104, 0
    v_mov_b32 v105, 0
    v_mov_b32 v106, 0
    v_mov_b32 v107, 0
    v_mov_b32 v108, 0
    v_mov_b32 v109, 0
    v_mov_b32 v110, 0
    v_mov_b32 v111, 0
    v_mov_b32 v112, 0
    v_mov_b32 v113, 0
    v_mov_b32 v114, 0
    v_mov_b32 v115, 0
    v_mov_b32 v116, 0
    v_mov_b32 v117, 0
    v_mov_b32 v118, 0
    v_mov_b32 v119, 0
    v_mov_b32 v120, 0
    v_mov_b32 v121, 0
    v_mov_b32 v122, 0
    v_mov_b32 v123, 0
    v_mov_b32 v124, 0
    v_mov_b32 v125, 0
    v_mov_b32 v126, 0
    v_mov_b32 v127, 0
    s_mov_b32 s34, 0
L_gemm_K_28:
    s_cmp_ge_u32 s34, 9
    s_cbranch_scc1 L_gw_29_last
    s_waitcnt vmcnt(8)
    s_branch L_gw_29
L_gw_29_last:
    s_waitcnt vmcnt(0)
L_gw_29:
    s_barrier
    v_add_u32 v26, s32, v20
    v_add_u32 v27, s32, v21
    v_add_u32 v28, s32, v22
    v_add_u32 v29, s32, v23
    v_add_u32 v30, s32, v24
    v_add_u32 v31, s32, v25
    ds_read_b64_tr_b16 v[144:145], v28 offset:0
    ds_read_b64_tr_b16 v[146:147], v28 offset:1024
    ds_read_b128 v[128:131], v26 offset:0
    ds_read_b64_tr_b16 v[148:149], v29 offset:0
    ds_read_b64_tr_b16 v[150:151], v29 offset:1024
    ds_read_b128 v[132:135], v26 offset:2048
    ds_read_b64_tr_b16 v[152:153], v30 offset:0
    ds_read_b64_tr_b16 v[154:155], v30 offset:1024
    ds_read_b128 v[136:139], v26 offset:4096
    ds_read_b64_tr_b16 v[156:157], v31 offset:0
    ds_read_b64_tr_b16 v[158:159], v31 offset:1024
    ds_read_b128 v[140:143], v26 offset:6144
    s_cmp_ge_u32 s34, 8
    s_cbranch_scc1 L_gd_30
    s_add_u32 m0, s33, 0
    s_nop 0
    buffer_load_dwordx4 v12, s[12:15], s30 offen lds
    s_add_u32 m0, s33, 1024
    s_nop 0
    buffer_load_dwordx4 v13, s[12:15], s30 offen lds
    s_add_u32 m0, s33, 2048
    s_nop 0
    buffer_load_dwordx4 v14, s[12:15], s30 offen lds
    s_add_u32 m0, s33, 3072
    s_nop 0
    buffer_load_dwordx4 v15, s[12:15], s30 offen lds
    s_add_u32 m0, s33, 16384
    s_nop 0
    buffer_load_dwordx4 v16, s[16:19], s31 offen lds
    s_add_u32 m0, s33, 17408
    s_nop 0
    buffer_load_dwordx4 v17, s[16:19], s31 offen lds
    s_add_u32 m0, s33, 18432
    s_nop 0
    buffer_load_dwordx4 v18, s[16:19], s31 offen lds
    s_add_u32 m0, s33, 19456
    s_nop 0
    buffer_load_dwordx4 v19, s[16:19], s31 offen lds
    s_add_u32 s30, s30, s52
    s_add_u32 s31, s31, s53
    s_add_u32 s33, s33, 32768
    s_sub_u32 s26, s33, 98304
    s_cmp_ge_u32 s33, 98304
    s_cselect_b32 s33, s26, s33
L_gd_30:
    s_waitcnt lgkmcnt(0)
    v_mfma_f32_16x16x32_bf16 v[64:67], v[144:147], v[128:131], v[64:67]
    ds_read_b64_tr_b16 v[176:177], v28 offset:8192
    ds_read_b64_tr_b16 v[178:179], v28 offset:9216
    v_mfma_f32_16x16x32_bf16 v[68:71], v[148:151], v[128:131], v[68:71]
    ds_read_b128 v[160:163], v27 offset:0
    v_mfma_f32_16x16x32_bf16 v[72:75], v[152:155], v[128:131], v[72:75]
    ds_read_b64_tr_b16 v[180:181], v29 offset:8192
    ds_read_b64_tr_b16 v[182:183], v29 offset:9216
    v_mfma_f32_16x16x32_bf16 v[76:79], v[156:159], v[128:131], v[76:79]
    ds_read_b128 v[164:167], v27 offset:2048
    v_mfma_f32_16x16x32_bf16 v[80:83], v[144:147], v[132:135], v[80:83]
    ds_read_b64_tr_b16 v[184:185], v30 offset:8192
    ds_read_b64_tr_b16 v[186:187], v30 offset:9216
    v_mfma_f32_16x16x32_bf16 v[84:87], v[148:151], v[132:135], v[84:87]
    ds_read_b128 v[168:171], v27 offset:4096
    v_mfma_f32_16x16x32_bf16 v[88:91], v[152:155], v[132:135], v[88:91]
    ds_read_b64_tr_b16 v[188:189], v31 offset:8192
    ds_read_b64_tr_b16 v[190:191], v31 offset:9216
    v_mfma_f32_16x16x32_bf16 v[92:95], v[156:159], v[132:135], v[92:95]
    ds_read_b128 v[172:175], v27 offset:6144
    v_mfma_f32_16x16x32_bf16 v[96:99], v[144:147], v[136:139], v[96:99]
    v_mfma_f32_16x16x32_bf16 v[100:103], v[148:151], v[136:139], v[100:103]
    v_mfma_f32_16x16x32_bf16 v[104:107], v[152:155], v[136:139], v[104:107]
    v_mfma_f32_16x16x32_bf16 v[108:111], v[156:159], v[136:139], v[108:111]
    v_mfma_f32_16x16x32_bf16 v[112:115], v[144:147], v[140:143], v[112:115]
    v_mfma_f32_16x16x32_bf16 v[116:119], v[148:151], v[140:143], v[116:119]
    v_mfma_f32_16x16x32_bf16 v[120:123], v[152:155], v[140:143], v[120:123]
    v_mfma_f32_16x16x32_bf16 v[124:127], v[156:159], v[140:143], v[124:127]
    s_waitcnt lgkmcnt(0)
    v_mfma_f32_16x16x32_bf16 v[64:67], v[176:179], v[160:163], v[64:67]
    v_mfma_f32_16x16x32_bf16 v[68:71], v[180:183], v[160:163], v[68:71]
    v_mfma_f32_16x16x32_bf16 v[72:75], v[184:187], v[160:163], v[72:75]
    v_mfma_f32_16x16x32_bf16 v[76:79], v[188:191], v[160:163], v[76:79]
    v_mfma_f32_16x16x32_bf16 v[80:83], v[176:179], v[164:167], v[80:83]
    v_mfma_f32_16x16x32_bf16 v[84:87], v[180:183], v[164:167], v[84:87]
    v_mfma_f32_16x16x32_bf16 v[88:91], v[184:187], v[164:167], v[88:91]
    v_mfma_f32_16x16x32_bf16 v[92:95], v[188:191], v[164:167], v[92:95]
    v_mfma_f32_16x16x32_bf16 v[96:99], v[176:179], v[168:171], v[96:99]
    v_mfma_f32_16x16x32_bf16 v[100:103], v[180:183], v[168:171], v[100:103]
    v_mfma_f32_16x16x32_bf16 v[104:107], v[184:187], v[168:171], v[104:107]
    v_mfma_f32_16x16x32_bf16 v[108:111], v[188:191], v[168:171], v[108:111]
    v_mfma_f32_16x16x32_bf16 v[112:115], v[176:179], v[172:175], v[112:115]
    v_mfma_f32_16x16x32_bf16 v[116:119], v[180:183], v[172:175], v[116:119]
    v_mfma_f32_16x16x32_bf16 v[120:123], v[184:187], v[172:175], v[120:123]
    v_mfma_f32_16x16x32_bf16 v[124:127], v[188:191], v[172:175], v[124:127]
    s_add_u32 s32, s32, 32768
    s_cmp_ge_u32 s32, 98304
    s_cselect_b32 s32, 0, s32
    s_add_u32 s34, s34, 1
    s_cmp_lt_u32 s34, 10
    s_cbranch_scc1 L_gemm_K_28
    s_nop 7
    s_barrier
    s_lshl_b32 s26, s36, 2
    s_lshl_b32 s27, s40, 1
    s_add_u32 s26, s26, s27
    s_lshl_b32 s26, s26, 5
    s_add_u32 s26, s26, s37
    s_lshl_b32 s26, s26, 13
    s_lshl_b32 s27, s39, 11
    s_add_u32 s26, s26, s27
    s_add_u32 s26, s26, 0
    s_add_u32 s27, s26, 4096
    s_add_u32 s28, s26, 262144
    s_add_u32 s41, s28, 4096
    v_cvt_pk_bf16_f32 v32, v64, v65
    v_cvt_pk_bf16_f32 v33, v66, v67
    v_cvt_pk_bf16_f32 v34, v68, v69
    v_cvt_pk_bf16_f32 v35, v70, v71
    buffer_store_dwordx4 v[32:35], v1, s[8:11], s26 offen offset:0 sc1
    v_cvt_pk_bf16_f32 v36, v72, v73
    v_cvt_pk_bf16_f32 v37, v74, v75
    v_cvt_pk_bf16_f32 v38, v76, v77
    v_cvt_pk_bf16_f32 v39, v78, v79
    buffer_store_dwordx4 v[36:39], v1, s[8:11], s26 offen offset:1024 sc1
    v_cvt_pk_bf16_f32 v40, v80, v81
    v_cvt_pk_bf16_f32 v41, v82, v83
    v_cvt_pk_bf16_f32 v42, v84, v85
    v_cvt_pk_bf16_f32 v43, v86, v87
    buffer_store_dwordx4 v[40:43], v1, s[8:11], s27 offen offset:0 sc1
    v_cvt_pk_bf16_f32 v44, v88, v89
    v_cvt_pk_bf16_f32 v45, v90, v91
    v_cvt_pk_bf16_f32 v46, v92, v93
    v_cvt_pk_bf16_f32 v47, v94, v95
    buffer_store_dwordx4 v[44:47], v1, s[8:11], s27 offen offset:1024 sc1
    v_cvt_pk_bf16_f32 v48, v96, v97
    v_cvt_pk_bf16_f32 v49, v98, v99
    v_cvt_pk_bf16_f32 v50, v100, v101
    v_cvt_pk_bf16_f32 v51, v102, v103
    buffer_store_dwordx4 v[48:51], v1, s[8:11], s28 offen offset:0 sc1
    v_cvt_pk_bf16_f32 v52, v104, v105
    v_cvt_pk_bf16_f32 v53, v106, v107
    v_cvt_pk_bf16_f32 v54, v108, v109
    v_cvt_pk_bf16_f32 v55, v110, v111
    buffer_store_dwordx4 v[52:55], v1, s[8:11], s28 offen offset:1024 sc1
    v_cvt_pk_bf16_f32 v56, v112, v113
    v_cvt_pk_bf16_f32 v57, v114, v115
    v_cvt_pk_bf16_f32 v58, v116, v117
    v_cvt_pk_bf16_f32 v59, v118, v119
    buffer_store_dwordx4 v[56:59], v1, s[8:11], s41 offen offset:0 sc1
    v_cvt_pk_bf16_f32 v60, v120, v121
    v_cvt_pk_bf16_f32 v61, v122, v123
    v_cvt_pk_bf16_f32 v62, v124, v125
    v_cvt_pk_bf16_f32 v63, v126, v127
    buffer_store_dwordx4 v[60:63], v1, s[8:11], s41 offen offset:1024 sc1
    s_lshl_b32 s26, s36, 5
    s_add_u32 s26, s26, s37
    s_lshl_b32 s26, s26, 2
    s_add_u32 s39, s26, 102760448
    s_cmp_eq_u32 s58, 1
    s_cbranch_scc1 L_zok_31
    v_mov_b32 v10, 40
L_wsp_32:
    buffer_load_dword v11, v10, s[20:23], 0 offen sc1
    s_waitcnt vmcnt(0)
    v_readfirstlane_b32 s29, v11
    s_cmp_ge_u32 s29, 256
    s_cbranch_scc1 L_wsp_32_ok
    s_sleep 2
    s_sub_u32 s38, s38, 1
    s_cbranch_scc0 L_wsp_32
    s_branch L_w_abort
L_wsp_32_ok:
    s_mov_b32 s58, 1
L_zok_31:
    s_waitcnt vmcnt(0)
    s_barrier
    s_cmp_lg_u32 s24, 0
    s_cbranch_scc1 L_sig_33
    v_mov_b32 v5, s39
    v_mov_b32 v6, 1
    s_mov_b64 exec, 1
    buffer_atomic_add v6, v5, s[8:11], 0 offen sc1
    s_mov_b64 exec, -1
L_sig_33:
    s_branch L_kvq_next_21
L_isV_27:
    s_load_dwordx2 s[4:5], s[0:1], 0
    s_waitcnt lgkmcnt(0)
    s_mov_b32 s12, s4
    s_mov_b32 s13, s5
    s_mov_b32 s14, 2621440
    s_mov_b32 s15, 0x20000
    s_load_dwordx2 s[4:5], s[0:1], 32
    s_waitcnt lgkmcnt(0)
    s_mov_b32 s16, s4
    s_mov_b32 s17, s5
    s_mov_b32 s18, 5242880
    s_mov_b32 s19, 0x20000
    v_lshrrev_b32 v5, 3, v4
    v_and_b32 v6, 7, v4
    v_xor_b32 v6, v6, v5
    s_lshl_b32 s26, s24, 5
    v_add_u32 v5, s26, v5
    s_mov_b32 s26, 1280
    v_mul_lo_u32 v5, v5, s26
    v_lshl_add_u32 v12, v6, 4, v5
    v_add_u32 v13, 10240, v12
    v_add_u32 v14, 20480, v12
    v_add_u32 v15, 30720, v12
    v_lshrrev_b32 v5, 4, v4
    v_and_b32 v6, 15, v4
    v_lshlrev_b32 v7, 1, v5
    v_xor_b32 v6, v6, v7
    s_lshl_b32 s26, s24, 4
    v_add_u32 v5, s26, v5
    s_mov_b32 s26, 8192
    v_mul_lo_u32 v5, v5, s26
    v_lshl_add_u32 v16, v6, 4, v5
    v_xor_b32 v6, 8, v6
    v_lshl_add_u32 v18, v6, 4, v5
    v_add_u32 v17, 32768, v16
    v_add_u32 v19, 98304, v18
    v_add_u32 v18, 65536, v18
    s_mul_i32 s30, s36, 163840
    s_lshl_b32 s31, s37, 8
    s_mov_b32 s52, 128
    s_mov_b32 s53, 524288
    s_lshr_b32 s39, s24, 1
    s_and_b32 s40, s24, 1
    s_lshl_b32 s41, s39, 6
    s_lshl_b32 s42, s40, 2
    v_add_u32 v5, s41, v2
    v_lshlrev_b32 v5, 7, v5
    v_and_b32 v6, 7, v2
    v_xor_b32 v6, v6, v3
    v_lshl_add_u32 v20, v6, 4, v5
    v_add_u32 v20, 0, v20
    v_xor_b32 v21, 64, v20
    v_lshrrev_b32 v5, 2, v2
    v_and_b32 v6, 3, v2
    v_lshl_add_u32 v7, v3, 3, v5
    v_lshlrev_b32 v7, 8, v7
    v_and_b32 v8, 1, v3
    v_lshl_or_b32 v8, v8, 2, v5
    v_lshl_add_u32 v7, v8, 5, v7
    v_lshrrev_b32 v8, 1, v6
    v_lshl_add_u32 v7, v8, 4, v7
    v_and_b32 v8, 1, v6
    v_lshl_add_u32 v7, v8, 3, v7
    s_lshl_b32 s26, s42, 5
    s_add_u32 s27, s26, 0
    v_xor_b32 v22, s27, v7
    v_add_u32 v22, 16384, v22
    s_add_u32 s27, s26, 32
    v_xor_b32 v23, s27, v7
    v_add_u32 v23, 16384, v23
    s_add_u32 s27, s26, 64
    v_xor_b32 v24, s27, v7
    v_add_u32 v24, 16384, v24
    s_add_u32 s27, s26, 96
    v_xor_b32 v25, s27, v7
    v_add_u32 v25, 16384, v25
    s_lshl_b32 s33, s24, 12
    s_add_u32 m0, s33, 0
    s_nop 0
    buffer_load_dwordx4 v12, s[12:15], s30 offen lds
    s_add_u32 m0, s33, 1024
    s_nop 0
    buffer_load_dwordx4 v13, s[12:15], s30 offen lds
    s_add_u32 m0, s33, 2048
    s_nop 0
    buffer_load_dwordx4 v14, s[12:15], s30 offen lds
    s_add_u32 m0, s33, 3072
    s_nop 0
    buffer_load_dwordx4 v15, s[12:15], s30 offen lds
    s_add_u32 m0, s33, 16384
    s_nop 0
    buffer_load_dwordx4 v16, s[16:19], s31 offen lds
    s_add_u32 m0, s33, 17408
    s_nop 0
    buffer_load_dwordx4 v17, s[16:19], s31 offen lds
    s_add_u32 m0, s33, 18432
    s_nop 0
    buffer_load_dwordx4 v18, s[16:19], s31 offen lds
    s_add_u32 m0, s33, 19456
    s_nop 0
    buffer_load_dwordx4 v19, s[16:19], s31 offen lds
    s_add_u32 s30, s30, s52
    s_add_u32 s31, s31, s53
    s_add_u32 s33, s33, 32768
    s_add_u32 m0, s33, 0
    s_nop 0
    buffer_load_dwordx4 v12, s[12:15], s30 offen lds
    s_add_u32 m0, s33, 1024
    s_nop 0
    buffer_load_dwordx4 v13, s[12:15], s30 offen lds
    s_add_u32 m0, s33, 2048
    s_nop 0
    buffer_load_dwordx4 v14, s[12:15], s30 offen lds
    s_add_u32 m0, s33, 3072
    s_nop 0
    buffer_load_dwordx4 v15, s[12:15], s30 offen lds
    s_add_u32 m0, s33, 16384
    s_nop 0
    buffer_load_dwordx4 v16, s[16:19], s31 offen lds
    s_add_u32 m0, s33, 17408
    s_nop 0
    buffer_load_dwordx4 v17, s[16:19], s31 offen lds
    s_add_u32 m0, s33, 18432
    s_nop 0
    buffer_load_dwordx4 v18, s[16:19], s31 offen lds
    s_add_u32 m0, s33, 19456
    s_nop 0
    buffer_load_dwordx4 v19, s[16:19], s31 offen lds
    s_add_u32 s30, s30, s52
    s_add_u32 s31, s31, s53
    s_add_u32 s33, s33, 32768
    s_mov_b32 s32, 0
    v_mov_b32 v64, 0
    v_mov_b32 v65, 0
    v_mov_b32 v66, 0
    v_mov_b32 v67, 0
    v_mov_b32 v68, 0
    v_mov_b32 v69, 0
    v_mov_b32 v70, 0
    v_mov_b32 v71, 0
    v_mov_b32 v72, 0
    v_mov_b32 v73, 0
    v_mov_b32 v74, 0
    v_mov_b32 v75, 0
    v_mov_b32 v76, 0
    v_mov_b32 v77, 0
    v_mov_b32 v78, 0
    v_mov_b32 v79, 0
    v_mov_b32 v80, 0
    v_mov_b32 v81, 0
    v_mov_b32 v82, 0
    v_mov_b32 v83, 0
    v_mov_b32 v84, 0
    v_mov_b32 v85, 0
    v_mov_b32 v86, 0
    v_mov_b32 v87, 0
    v_mov_b32 v88, 0
    v_mov_b32 v89, 0
    v_mov_b32 v90, 0
    v_mov_b32 v91, 0
    v_mov_b32 v92, 0
    v_mov_b32 v93, 0
    v_mov_b32 v94, 0
    v_mov_b32 v95, 0
    v_mov_b32 v96, 0
    v_mov_b32 v97, 0
    v_mov_b32 v98, 0
    v_mov_b32 v99, 0
    v_mov_b32 v100, 0
    v_mov_b32 v101, 0
    v_mov_b32 v102, 0
    v_mov_b32 v103, 0
    v_mov_b32 v104, 0
    v_mov_b32 v105, 0
    v_mov_b32 v106, 0
    v_mov_b32 v107, 0
    v_mov_b32 v108, 0
    v_mov_b32 v109, 0
    v_mov_b32 v110, 0
    v_mov_b32 v111, 0
    v_mov_b32 v112, 0
    v_mov_b32 v113, 0
    v_mov_b32 v114, 0
    v_mov_b32 v115, 0
    v_mov_b32 v116, 0
    v_mov_b32 v117, 0
    v_mov_b32 v118, 0
    v_mov_b32 v119, 0
    v_mov_b32 v120, 0
    v_mov_b32 v121, 0
    v_mov_b32 v122, 0
    v_mov_b32 v123, 0
    v_mov_b32 v124, 0
    v_mov_b32 v125, 0
    v_mov_b32 v126, 0
    v_mov_b32 v127, 0
    s_mov_b32 s34, 0
L_gemm_V_34:
    s_cmp_ge_u32 s34, 9
    s_cbranch_scc1 L_gw_35_last
    s_waitcnt vmcnt(8)
    s_branch L_gw_35
L_gw_35_last:
    s_waitcnt vmcnt(0)
L_gw_35:
    s_barrier
    v_add_u32 v26, s32, v20
    v_add_u32 v27, s32, v21
    v_add_u32 v28, s32, v22
    v_add_u32 v29, s32, v23
    v_add_u32 v30, s32, v24
    v_add_u32 v31, s32, v25
    ds_read_b64_tr_b16 v[144:145], v28 offset:0
    ds_read_b64_tr_b16 v[146:147], v28 offset:1024
    ds_read_b128 v[128:131], v26 offset:0
    ds_read_b64_tr_b16 v[148:149], v29 offset:0
    ds_read_b64_tr_b16 v[150:151], v29 offset:1024
    ds_read_b128 v[132:135], v26 offset:2048
    ds_read_b64_tr_b16 v[152:153], v30 offset:0
    ds_read_b64_tr_b16 v[154:155], v30 offset:1024
    ds_read_b128 v[136:139], v26 offset:4096
    ds_read_b64_tr_b16 v[156:157], v31 offset:0
    ds_read_b64_tr_b16 v[158:159], v31 offset:1024
    ds_read_b128 v[140:143], v26 offset:6144
    s_cmp_ge_u32 s34, 8
    s_cbranch_scc1 L_gd_36
    s_add_u32 m0, s33, 0
    s_nop 0
    buffer_load_dwordx4 v12, s[12:15], s30 offen lds
    s_add_u32 m0, s33, 1024
    s_nop 0
    buffer_load_dwordx4 v13, s[12:15], s30 offen lds
    s_add_u32 m0, s33, 2048
    s_nop 0
    buffer_load_dwordx4 v14, s[12:15], s30 offen lds
    s_add_u32 m0, s33, 3072
    s_nop 0
    buffer_load_dwordx4 v15, s[12:15], s30 offen lds
    s_add_u32 m0, s33, 16384
    s_nop 0
    buffer_load_dwordx4 v16, s[16:19], s31 offen lds
    s_add_u32 m0, s33, 17408
    s_nop 0
    buffer_load_dwordx4 v17, s[16:19], s31 offen lds
    s_add_u32 m0, s33, 18432
    s_nop 0
    buffer_load_dwordx4 v18, s[16:19], s31 offen lds
    s_add_u32 m0, s33, 19456
    s_nop 0
    buffer_load_dwordx4 v19, s[16:19], s31 offen lds
    s_add_u32 s30, s30, s52
    s_add_u32 s31, s31, s53
    s_add_u32 s33, s33, 32768
    s_sub_u32 s26, s33, 98304
    s_cmp_ge_u32 s33, 98304
    s_cselect_b32 s33, s26, s33
L_gd_36:
    s_waitcnt lgkmcnt(0)
    v_mfma_f32_16x16x32_bf16 v[64:67], v[128:131], v[144:147], v[64:67]
    ds_read_b64_tr_b16 v[176:177], v28 offset:8192
    ds_read_b64_tr_b16 v[178:179], v28 offset:9216
    v_mfma_f32_16x16x32_bf16 v[68:71], v[128:131], v[148:151], v[68:71]
    ds_read_b128 v[160:163], v27 offset:0
    v_mfma_f32_16x16x32_bf16 v[72:75], v[128:131], v[152:155], v[72:75]
    ds_read_b64_tr_b16 v[180:181], v29 offset:8192
    ds_read_b64_tr_b16 v[182:183], v29 offset:9216
    v_mfma_f32_16x16x32_bf16 v[76:79], v[128:131], v[156:159], v[76:79]
    ds_read_b128 v[164:167], v27 offset:2048
    v_mfma_f32_16x16x32_bf16 v[80:83], v[132:135], v[144:147], v[80:83]
    ds_read_b64_tr_b16 v[184:185], v30 offset:8192
    ds_read_b64_tr_b16 v[186:187], v30 offset:9216
    v_mfma_f32_16x16x32_bf16 v[84:87], v[132:135], v[148:151], v[84:87]
    ds_read_b128 v[168:171], v27 offset:4096
    v_mfma_f32_16x16x32_bf16 v[88:91], v[132:135], v[152:155], v[88:91]
    ds_read_b64_tr_b16 v[188:189], v31 offset:8192
    ds_read_b64_tr_b16 v[190:191], v31 offset:9216
    v_mfma_f32_16x16x32_bf16 v[92:95], v[132:135], v[156:159], v[92:95]
    ds_read_b128 v[172:175], v27 offset:6144
    v_mfma_f32_16x16x32_bf16 v[96:99], v[136:139], v[144:147], v[96:99]
    v_mfma_f32_16x16x32_bf16 v[100:103], v[136:139], v[148:151], v[100:103]
    v_mfma_f32_16x16x32_bf16 v[104:107], v[136:139], v[152:155], v[104:107]
    v_mfma_f32_16x16x32_bf16 v[108:111], v[136:139], v[156:159], v[108:111]
    v_mfma_f32_16x16x32_bf16 v[112:115], v[140:143], v[144:147], v[112:115]
    v_mfma_f32_16x16x32_bf16 v[116:119], v[140:143], v[148:151], v[116:119]
    v_mfma_f32_16x16x32_bf16 v[120:123], v[140:143], v[152:155], v[120:123]
    v_mfma_f32_16x16x32_bf16 v[124:127], v[140:143], v[156:159], v[124:127]
    s_waitcnt lgkmcnt(0)
    v_mfma_f32_16x16x32_bf16 v[64:67], v[160:163], v[176:179], v[64:67]
    v_mfma_f32_16x16x32_bf16 v[68:71], v[160:163], v[180:183], v[68:71]
    v_mfma_f32_16x16x32_bf16 v[72:75], v[160:163], v[184:187], v[72:75]
    v_mfma_f32_16x16x32_bf16 v[76:79], v[160:163], v[188:191], v[76:79]
    v_mfma_f32_16x16x32_bf16 v[80:83], v[164:167], v[176:179], v[80:83]
    v_mfma_f32_16x16x32_bf16 v[84:87], v[164:167], v[180:183], v[84:87]
    v_mfma_f32_16x16x32_bf16 v[88:91], v[164:167], v[184:187], v[88:91]
    v_mfma_f32_16x16x32_bf16 v[92:95], v[164:167], v[188:191], v[92:95]
    v_mfma_f32_16x16x32_bf16 v[96:99], v[168:171], v[176:179], v[96:99]
    v_mfma_f32_16x16x32_bf16 v[100:103], v[168:171], v[180:183], v[100:103]
    v_mfma_f32_16x16x32_bf16 v[104:107], v[168:171], v[184:187], v[104:107]
    v_mfma_f32_16x16x32_bf16 v[108:111], v[168:171], v[188:191], v[108:111]
    v_mfma_f32_16x16x32_bf16 v[112:115], v[172:175], v[176:179], v[112:115]
    v_mfma_f32_16x16x32_bf16 v[116:119], v[172:175], v[180:183], v[116:119]
    v_mfma_f32_16x16x32_bf16 v[120:123], v[172:175], v[184:187], v[120:123]
    v_mfma_f32_16x16x32_bf16 v[124:127], v[172:175], v[188:191], v[124:127]
    s_add_u32 s32, s32, 32768
    s_cmp_ge_u32 s32, 98304
    s_cselect_b32 s32, 0, s32
    s_add_u32 s34, s34, 1
    s_cmp_lt_u32 s34, 10
    s_cbranch_scc1 L_gemm_V_34
    s_nop 7
    s_barrier
    s_lshl_b32 s26, s36, 2
    s_lshl_b32 s27, s39, 1
    s_add_u32 s26, s26, s27
    s_lshl_b32 s26, s26, 5
    s_add_u32 s26, s26, s37
    s_lshl_b32 s26, s26, 13
    s_lshl_b32 s27, s40, 12
    s_add_u32 s26, s26, s27
    s_add_u32 s26, s26, 16777216
    s_add_u32 s27, s26, 262144
    v_cvt_pk_bf16_f32 v32, v64, v65
    v_cvt_pk_bf16_f32 v33, v66, v67
    v_cvt_pk_bf16_f32 v34, v80, v81
    v_cvt_pk_bf16_f32 v35, v82, v83
    buffer_store_dwordx4 v[32:35], v1, s[8:11], s26 offen offset:0 sc1
    v_cvt_pk_bf16_f32 v36, v68, v69
    v_cvt_pk_bf16_f32 v37, v70, v71
    v_cvt_pk_bf16_f32 v38, v84, v85
    v_cvt_pk_bf16_f32 v39, v86, v87
    buffer_store_dwordx4 v[36:39], v1, s[8:11], s26 offen offset:1024 sc1
    v_cvt_pk_bf16_f32 v40, v72, v73
    v_cvt_pk_bf16_f32 v41, v74, v75
    v_cvt_pk_bf16_f32 v42, v88, v89
    v_cvt_pk_bf16_f32 v43, v90, v91
    buffer_store_dwordx4 v[40:43], v1, s[8:11], s26 offen offset:2048 sc1
    v_cvt_pk_bf16_f32 v44, v76, v77
    v_cvt_pk_bf16_f32 v45, v78, v79
    v_cvt_pk_bf16_f32 v46, v92, v93
    v_cvt_pk_bf16_f32 v47, v94, v95
    buffer_store_dwordx4 v[44:47], v1, s[8:11], s26 offen offset:3072 sc1
    v_cvt_pk_bf16_f32 v48, v96, v97
    v_cvt_pk_bf16_f32 v49, v98, v99
    v_cvt_pk_bf16_f32 v50, v112, v113
    v_cvt_pk_bf16_f32 v51, v114, v115
    buffer_store_dwordx4 v[48:51], v1, s[8:11], s27 offen offset:0 sc1
    v_cvt_pk_bf16_f32 v52, v100, v101
    v_cvt_pk_bf16_f32 v53, v102, v103
    v_cvt_pk_bf16_f32 v54, v116, v117
    v_cvt_pk_bf16_f32 v55, v118, v119
    buffer_store_dwordx4 v[52:55], v1, s[8:11], s27 offen offset:1024 sc1
    v_cvt_pk_bf16_f32 v56, v104, v105
    v_cvt_pk_bf16_f32 v57, v106, v107
    v_cvt_pk_bf16_f32 v58, v120, v121
    v_cvt_pk_bf16_f32 v59, v122, v123
    buffer_store_dwordx4 v[56:59], v1, s[8:11], s27 offen offset:2048 sc1
    v_cvt_pk_bf16_f32 v60, v108, v109
    v_cvt_pk_bf16_f32 v61, v110, v111
    v_cvt_pk_bf16_f32 v62, v124, v125
    v_cvt_pk_bf16_f32 v63, v126, v127
    buffer_store_dwordx4 v[60:63], v1, s[8:11], s27 offen offset:3072 sc1
    s_lshl_b32 s26, s36, 5
    s_add_u32 s26, s26, s37
    s_lshl_b32 s26, s26, 2
    s_add_u32 s39, s26, 102760448
    s_cmp_eq_u32 s58, 1
    s_cbranch_scc1 L_zok_37
    v_mov_b32 v10, 40
L_wsp_38:
    buffer_load_dword v11, v10, s[20:23], 0 offen sc1
    s_waitcnt vmcnt(0)
    v_readfirstlane_b32 s29, v11
    s_cmp_ge_u32 s29, 256
    s_cbranch_scc1 L_wsp_38_ok
    s_sleep 2
    s_sub_u32 s38, s38, 1
    s_cbranch_scc0 L_wsp_38
    s_branch L_w_abort
L_wsp_38_ok:
    s_mov_b32 s58, 1
L_zok_37:
    s_waitcnt vmcnt(0)
    s_barrier
    s_cmp_lg_u32 s24, 0
    s_cbranch_scc1 L_sig_39
    v_mov_b32 v5, s39
    v_mov_b32 v6, 1
    s_mov_b64 exec, 1
    buffer_atomic_add v6, v5, s[8:11], 0 offen sc1
    s_mov_b64 exec, -1
L_sig_39:
    s_branch L_kvq_next_21
L_kvq_B_25:
    s_sub_u32 s25, s25, s26
    s_lshl_b32 s26, 4, s62
    s_cmp_ge_u32 s25, s26
    s_cbranch_scc1 L_kvq_C_26
    s_add_u32 s27, s62, 0
    s_lshr_b32 s36, s25, s27
    s_lshl_b32 s26, s36, s27
    s_sub_u32 s26, s25, s26
    s_add_u32 s37, s26, s57
    s_load_dwordx2 s[4:5], s[0:1], 0
    s_waitcnt lgkmcnt(0)
    s_mov_b32 s12, s4
    s_mov_b32 s13, s5
    s_mov_b32 s14, 2621440
    s_mov_b32 s15, 0x20000
    s_load_dwordx2 s[4:5], s[0:1], 16
    s_waitcnt lgkmcnt(0)
    s_mov_b32 s16, s4
    s_mov_b32 s17, s5
    s_mov_b32 s18, 5242880
    s_mov_b32 s19, 0x20000
    v_lshrrev_b32 v5, 3, v4
    v_and_b32 v6, 7, v4
    v_xor_b32 v6, v6, v5
    s_lshl_b32 s26, s24, 5
    v_add_u32 v5, s26, v5
    s_mov_b32 s26, 1280
    v_mul_lo_u32 v5, v5, s26
    v_lshl_add_u32 v12, v6, 4, v5
    v_add_u32 v13, 10240, v12
    v_add_u32 v14, 20480, v12
    v_add_u32 v15, 30720, v12
    v_lshrrev_b32 v5, 4, v4
    v_and_b32 v6, 15, v4
    v_lshlrev_b32 v7, 1, v5
    v_xor_b32 v6, v6, v7
    s_lshl_b32 s26, s24, 4
    v_add_u32 v5, s26, v5
    s_mov_b32 s26, 8192
    v_mul_lo_u32 v5, v5, s26
    v_lshl_add_u32 v16, v6, 4, v5
    v_xor_b32 v6, 8, v6
    v_lshl_add_u32 v18, v6, 4, v5
    v_add_u32 v17, 32768, v16
    v_add_u32 v19, 98304, v18
    v_add_u32 v18, 65536, v18
    s_mul_i32 s30, s36, 163840
    s_lshl_b32 s31, s37, 8
    s_mov_b32 s52, 128
    s_mov_b32 s53, 524288
    s_lshr_b32 s39, s24, 1
    s_and_b32 s40, s24, 1
    s_lshl_b32 s41, s40, 6
    s_lshl_b32 s42, s39, 2
    v_add_u32 v5, s41, v2
    v_lshlrev_b32 v5, 7, v5
    v_and_b32 v6, 7, v2
    v_xor_b32 v6, v6, v3
    v_lshl_add_u32 v20, v6, 4, v5
    v_add_u32 v20, 0, v20
    v_xor_b32 v21, 64, v20
    v_lshrrev_b32 v5, 2, v2
    v_and_b32 v6, 3, v2
    v_lshl_add_u32 v7, v3, 3, v5
    v_lshlrev_b32 v7, 8, v7
    v_and_b32 v8, 1, v3
    v_lshl_or_b32 v8, v8, 2, v5
    v_lshl_add_u32 v7, v8, 5, v7
    v_lshrrev_b32 v8, 1, v6
    v_lshl_add_u32 v7, v8, 4, v7
    v_and_b32 v8, 1, v6
    v_lshl_add_u32 v7, v8, 3, v7
    s_lshl_b32 s26, s42, 5
    s_add_u32 s27, s26, 0
    v_xor_b32 v22, s27, v7
    v_add_u32 v22, 16384, v22
    s_add_u32 s27, s26, 32
    v_xor_b32 v23, s27, v7
    v_add_u32 v23, 16384, v23
    s_add_u32 s27, s26, 64
    v_xor_b32 v24, s27, v7
    v_add_u32 v24, 16384, v24
    s_add_u32 s27, s26, 96
    v_xor_b32 v25, s27, v7
    v_add_u32 v25, 16384, v25
    s_lshl_b32 s33, s24, 12
    s_add_u32 m0, s33, 0
    s_nop 0
    buffer_load_dwordx4 v12, s[12:15], s30 offen lds
    s_add_u32 m0, s33, 1024
    s_nop 0
    buffer_load_dwordx4 v13, s[12:15], s30 offen lds
    s_add_u32 m0, s33, 2048
    s_nop 0
    buffer_load_dwordx4 v14, s[12:15], s30 offen lds
    s_add_u32 m0, s33, 3072
    s_nop 0
    buffer_load_dwordx4 v15, s[12:15], s30 offen lds
    s_add_u32 m0, s33, 16384
    s_nop 0
    buffer_load_dwordx4 v16, s[16:19], s31 offen lds
    s_add_u32 m0, s33, 17408
    s_nop 0
    buffer_load_dwordx4 v17, s[16:19], s31 offen lds
    s_add_u32 m0, s33, 18432
    s_nop 0
    buffer_load_dwordx4 v18, s[16:19], s31 offen lds
    s_add_u32 m0, s33, 19456
    s_nop 0
    buffer_load_dwordx4 v19, s[16:19], s31 offen lds
    s_add_u32 s30, s30, s52
    s_add_u32 s31, s31, s53
    s_add_u32 s33, s33, 32768
    s_add_u32 m0, s33, 0
    s_nop 0
    buffer_load_dwordx4 v12, s[12:15], s30 offen lds
    s_add_u32 m0, s33, 1024
    s_nop 0
    buffer_load_dwordx4 v13, s[12:15], s30 offen lds
    s_add_u32 m0, s33, 2048
    s_nop 0
    buffer_load_dwordx4 v14, s[12:15], s30 offen lds
    s_add_u32 m0, s33, 3072
    s_nop 0
    buffer_load_dwordx4 v15, s[12:15], s30 offen lds
    s_add_u32 m0, s33, 16384
    s_nop 0
    buffer_load_dwordx4 v16, s[16:19], s31 offen lds
    s_add_u32 m0, s33, 17408
    s_nop 0
    buffer_load_dwordx4 v17, s[16:19], s31 offen lds
    s_add_u32 m0, s33, 18432
    s_nop 0
    buffer_load_dwordx4 v18, s[16:19], s31 offen lds
    s_add_u32 m0, s33, 19456
    s_nop 0
    buffer_load_dwordx4 v19, s[16:19], s31 offen lds
    s_add_u32 s30, s30, s52
    s_add_u32 s31, s31, s53
    s_add_u32 s33, s33, 32768
    s_mov_b32 s32, 0
    v_mov_b32 v64, 0
    v_mov_b32 v65, 0
    v_mov_b32 v66, 0
    v_mov_b32 v67, 0
    v_mov_b32 v68, 0
    v_mov_b32 v69, 0
    v_mov_b32 v70, 0
    v_mov_b32 v71, 0
    v_mov_b32 v72, 0
    v_mov_b32 v73, 0
    v_mov_b32 v74, 0
    v_mov_b32 v75, 0
    v_mov_b32 v76, 0
    v_mov_b32 v77, 0
    v_mov_b32 v78, 0
    v_mov_b32 v79, 0
    v_mov_b32 v80, 0
    v_mov_b32 v81, 0
    v_mov_b32 v82, 0
    v_mov_b32 v83, 0
    v_mov_b32 v84, 0
    v_mov_b32 v85, 0
    v_mov_b32 v86, 0
    v_mov_b32 v87, 0
    v_mov_b32 v88, 0
    v_mov_b32 v89, 0
    v_mov_b32 v90, 0
    v_mov_b32 v91, 0
    v_mov_b32 v92, 0
    v_mov_b32 v93, 0
    v_mov_b32 v94, 0
    v_mov_b32 v95, 0
    v_mov_b32 v96, 0
    v_mov_b32 v97, 0
    v_mov_b32 v98, 0
    v_mov_b32 v99, 0
    v_mov_b32 v100, 0
    v_mov_b32 v101, 0
    v_mov_b32 v102, 0
    v_mov_b32 v103, 0
    v_mov_b32 v104, 0
    v_mov_b32 v105, 0
    v_mov_b32 v106, 0
    v_mov_b32 v107, 0
    v_mov_b32 v108, 0
    v_mov_b32 v109, 0
    v_mov_b32 v110, 0
    v_mov_b32 v111, 0
    v_mov_b32 v112, 0
    v_mov_b32 v113, 0
    v_mov_b32 v114, 0
    v_mov_b32 v115, 0
    v_mov_b32 v116, 0
    v_mov_b32 v117, 0
    v_mov_b32 v118, 0
    v_mov_b32 v119, 0
    v_mov_b32 v120, 0
    v_mov_b32 v121, 0
    v_mov_b32 v122, 0
    v_mov_b32 v123, 0
    v_mov_b32 v124, 0
    v_mov_b32 v125, 0
    v_mov_b32 v126, 0
    v_mov_b32 v127, 0
    s_mov_b32 s34, 0
L_gemm_Q_40:
    s_cmp_ge_u32 s34, 9
    s_cbranch_scc1 L_gw_41_last
    s_waitcnt vmcnt(8)
    s_branch L_gw_41
L_gw_41_last:
    s_waitcnt vmcnt(0)
L_gw_41:
    s_barrier
    v_add_u32 v26, s32, v20
    v_add_u32 v27, s32, v21
    v_add_u32 v28, s32, v22
    v_add_u32 v29, s32, v23
    v_add_u32 v30, s32, v24
    v_add_u32 v31, s32, v25
    ds_read_b64_tr_b16 v[144:145], v28 offset:0
    ds_read_b64_tr_b16 v[146:147], v28 offset:1024
    ds_read_b128 v[128:131], v26 offset:0
    ds_read_b64_tr_b16 v[148:149], v29 offset:0
    ds_read_b64_tr_b16 v[150:151], v29 offset:1024
    ds_read_b128 v[132:135], v26 offset:2048
    ds_read_b64_tr_b16 v[152:153], v30 offset:0
    ds_read_b64_tr_b16 v[154:155], v30 offset:1024
    ds_read_b128 v[136:139], v26 offset:4096
    ds_read_b64_tr_b16 v[156:157], v31 offset:0
    ds_read_b64_tr_b16 v[158:159], v31 offset:1024
    ds_read_b128 v[140:143], v26 offset:6144
    s_cmp_ge_u32 s34, 8
    s_cbranch_scc1 L_gd_42
    s_add_u32 m0, s33, 0
    s_nop 0
    buffer_load_dwordx4 v12, s[12:15], s30 offen lds
    s_add_u32 m0, s33, 1024
    s_nop 0
    buffer_load_dwordx4 v13, s[12:15], s30 offen lds
    s_add_u32 m0, s33, 2048
    s_nop 0
    buffer_load_dwordx4 v14, s[12:15], s30 offen lds
    s_add_u32 m0, s33, 3072
    s_nop 0
    buffer_load_dwordx4 v15, s[12:15], s30 offen lds
    s_add_u32 m0, s33, 16384
    s_nop 0
    buffer_load_dwordx4 v16, s[16:19], s31 offen lds
    s_add_u32 m0, s33, 17408
    s_nop 0
    buffer_load_dwordx4 v17, s[16:19], s31 offen lds
    s_add_u32 m0, s33, 18432
    s_nop 0
    buffer_load_dwordx4 v18, s[16:19], s31 offen lds
    s_add_u32 m0, s33, 19456
    s_nop 0
    buffer_load_dwordx4 v19, s[16:19], s31 offen lds
    s_add_u32 s30, s30, s52
    s_add_u32 s31, s31, s53
    s_add_u32 s33, s33, 32768
    s_sub_u32 s26, s33, 98304
    s_cmp_ge_u32 s33, 98304
    s_cselect_b32 s33, s26, s33
L_gd_42:
    s_waitcnt lgkmcnt(0)
    v_mfma_f32_16x16x32_bf16 v[64:67], v[144:147], v[128:131], v[64:67]
    ds_read_b64_tr_b16 v[176:177], v28 offset:8192
    ds_read_b64_tr_b16 v[178:179], v28 offset:9216
    v_mfma_f32_16x16x32_bf16 v[68:71], v[148:151], v[128:131], v[68:71]
    ds_read_b128 v[160:163], v27 offset:0
    v_mfma_f32_16x16x32_bf16 v[72:75], v[152:155], v[128:131], v[72:75]
    ds_read_b64_tr_b16 v[180:181], v29 offset:8192
    ds_read_b64_tr_b16 v[182:183], v29 offset:9216
    v_mfma_f32_16x16x32_bf16 v[76:79], v[156:159], v[128:131], v[76:79]
    ds_read_b128 v[164:167], v27 offset:2048
    v_mfma_f32_16x16x32_bf16 v[80:83], v[144:147], v[132:135], v[80:83]
    ds_read_b64_tr_b16 v[184:185], v30 offset:8192
    ds_read_b64_tr_b16 v[186:187], v30 offset:9216
    v_mfma_f32_16x16x32_bf16 v[84:87], v[148:151], v[132:135], v[84:87]
    ds_read_b128 v[168:171], v27 offset:4096
    v_mfma_f32_16x16x32_bf16 v[88:91], v[152:155], v[132:135], v[88:91]
    ds_read_b64_tr_b16 v[188:189], v31 offset:8192
    ds_read_b64_tr_b16 v[190:191], v31 offset:9216
    v_mfma_f32_16x16x32_bf16 v[92:95], v[156:159], v[132:135], v[92:95]
    ds_read_b128 v[172:175], v27 offset:6144
    v_mfma_f32_16x16x32_bf16 v[96:99], v[144:147], v[136:139], v[96:99]
    v_mfma_f32_16x16x32_bf16 v[100:103], v[148:151], v[136:139], v[100:103]
    v_mfma_f32_16x16x32_bf16 v[104:107], v[152:155], v[136:139], v[104:107]
    v_mfma_f32_16x16x32_bf16 v[108:111], v[156:159], v[136:139], v[108:111]
    v_mfma_f32_16x16x32_bf16 v[112:115], v[144:147], v[140:143], v[112:115]
    v_mfma_f32_16x16x32_bf16 v[116:119], v[148:151], v[140:143], v[116:119]
    v_mfma_f32_16x16x32_bf16 v[120:123], v[152:155], v[140:143], v[120:123]
    v_mfma_f32_16x16x32_bf16 v[124:127], v[156:159], v[140:143], v[124:127]
    s_waitcnt lgkmcnt(0)
    v_mfma_f32_16x16x32_bf16 v[64:67], v[176:179], v[160:163], v[64:67]
    v_mfma_f32_16x16x32_bf16 v[68:71], v[180:183], v[160:163], v[68:71]
    v_mfma_f32_16x16x32_bf16 v[72:75], v[184:187], v[160:163], v[72:75]
    v_mfma_f32_16x16x32_bf16 v[76:79], v[188:191], v[160:163], v[76:79]
    v_mfma_f32_16x16x32_bf16 v[80:83], v[176:179], v[164:167], v[80:83]
    v_mfma_f32_16x16x32_bf16 v[84:87], v[180:183], v[164:167], v[84:87]
    v_mfma_f32_16x16x32_bf16 v[88:91], v[184:187], v[164:167], v[88:91]
    v_mfma_f32_16x16x32_bf16 v[92:95], v[188:191], v[164:167], v[92:95]
    v_mfma_f32_16x16x32_bf16 v[96:99], v[176:179], v[168:171], v[96:99]
    v_mfma_f32_16x16x32_bf16 v[100:103], v[180:183], v[168:171], v[100:103]
    v_mfma_f32_16x16x32_bf16 v[104:107], v[184:187], v[168:171], v[104:107]
    v_mfma_f32_16x16x32_bf16 v[108:111], v[188:191], v[168:171], v[108:111]
    v_mfma_f32_16x16x32_bf16 v[112:115], v[176:179], v[172:175], v[112:115]
    v_mfma_f32_16x16x32_bf16 v[116:119], v[180:183], v[172:175], v[116:119]
    v_mfma_f32_16x16x32_bf16 v[120:123], v[184:187], v[172:175], v[120:123]
    v_mfma_f32_16x16x32_bf16 v[124:127], v[188:191], v[172:175], v[124:127]
    s_add_u32 s32, s32, 32768
    s_cmp_ge_u32 s32, 98304
    s_cselect_b32 s32, 0, s32
    s_add_u32 s34, s34, 1
    s_cmp_lt_u32 s34, 10
    s_cbranch_scc1 L_gemm_Q_40
    s_nop 7
    s_barrier
    s_lshl_b32 s26, s36, 2
    s_lshl_b32 s27, s40, 1
    s_add_u32 s26, s26, s27
    s_lshl_b32 s26, s26, 5
    s_add_u32 s26, s26, s37
    s_lshl_b32 s26, s26, 13
    s_lshl_b32 s27, s39, 11
    s_add_u32 s26, s26, s27
    s_add_u32 s26, s26, 33554432
    s_add_u32 s27, s26, 4096
    s_add_u32 s28, s26, 262144
    s_add_u32 s41, s28, 4096
    v_cvt_pk_bf16_f32 v32, v64, v65
    v_cvt_pk_bf16_f32 v33, v66, v67
    v_cvt_pk_bf16_f32 v34, v68, v69
    v_cvt_pk_bf16_f32 v35, v70, v71
    buffer_store_dwordx4 v[32:35], v1, s[8:11], s26 offen offset:0 sc1
    v_cvt_pk_bf16_f32 v36, v72, v73
    v_cvt_pk_bf16_f32 v37, v74, v75
    v_cvt_pk_bf16_f32 v38, v76, v77
    v_cvt_pk_bf16_f32 v39, v78, v79
    buffer_store_dwordx4 v[36:39], v1, s[8:11], s26 offen offset:1024 sc1
    v_cvt_pk_bf16_f32 v40, v80, v81
    v_cvt_pk_bf16_f32 v41, v82, v83
    v_cvt_pk_bf16_f32 v42, v84, v85
    v_cvt_pk_bf16_f32 v43, v86, v87
    buffer_store_dwordx4 v[40:43], v1, s[8:11], s27 offen offset:0 sc1
    v_cvt_pk_bf16_f32 v44, v88, v89
    v_cvt_pk_bf16_f32 v45, v90, v91
    v_cvt_pk_bf16_f32 v46, v92, v93
    v_cvt_pk_bf16_f32 v47, v94, v95
    buffer_store_dwordx4 v[44:47], v1, s[8:11], s27 offen offset:1024 sc1
    v_cvt_pk_bf16_f32 v48, v96, v97
    v_cvt_pk_bf16_f32 v49, v98, v99
    v_cvt_pk_bf16_f32 v50, v100, v101
    v_cvt_pk_bf16_f32 v51, v102, v103
    buffer_store_dwordx4 v[48:51], v1, s[8:11], s28 offen offset:0 sc1
    v_cvt_pk_bf16_f32 v52, v104, v105
    v_cvt_pk_bf16_f32 v53, v106, v107
    v_cvt_pk_bf16_f32 v54, v108, v109
    v_cvt_pk_bf16_f32 v55, v110, v111
    buffer_store_dwordx4 v[52:55], v1, s[8:11], s28 offen offset:1024 sc1
    v_cvt_pk_bf16_f32 v56, v112, v113
    v_cvt_pk_bf16_f32 v57, v114, v115
    v_cvt_pk_bf16_f32 v58, v116, v117
    v_cvt_pk_bf16_f32 v59, v118, v119
    buffer_store_dwordx4 v[56:59], v1, s[8:11], s41 offen offset:0 sc1
    v_cvt_pk_bf16_f32 v60, v120, v121
    v_cvt_pk_bf16_f32 v61, v122, v123
    v_cvt_pk_bf16_f32 v62, v124, v125
    v_cvt_pk_bf16_f32 v63, v126, v127
    buffer_store_dwordx4 v[60:63], v1, s[8:11], s41 offen offset:1024 sc1
    s_lshl_b32 s26, s36, 5
    s_add_u32 s26, s26, s37
    s_lshl_b32 s26, s26, 2
    s_add_u32 s39, s26, 102762496
    s_cmp_eq_u32 s58, 1
    s_cbranch_scc1 L_zok_43
    v_mov_b32 v10, 40
L_wsp_44:
    buffer_load_dword v11, v10, s[20:23], 0 offen sc1
    s_waitcnt vmcnt(0)
    v_readfirstlane_b32 s29, v11
    s_cmp_ge_u32 s29, 256
    s_cbranch_scc1 L_wsp_44_ok
    s_sleep 2
    s_sub_u32 s38, s38, 1
    s_cbranch_scc0 L_wsp_44
    s_branch L_w_abort
L_wsp_44_ok:
    s_mov_b32 s58, 1
L_zok_43:
    s_waitcnt vmcnt(0)
    s_barrier
    s_cmp_lg_u32 s24, 0
    s_cbranch_scc1 L_sig_45
    v_mov_b32 v5, s39
    v_mov_b32 v6, 1
    s_mov_b64 exec, 1
    buffer_atomic_add v6, v5, s[8:11], 0 offen sc1
    s_mov_b64 exec, -1
L_sig_45:
    s_branch L_kvq_next_21
L_kvq_C_26:
    s_sub_u32 s25, s25, s26
    s_lshl_b32 s26, 12, s62
    s_cmp_ge_u32 s25, s26
    s_cbranch_scc1 L_kvq_qd_24
    s_add_u32 s27, s62, 0
    s_lshr_b32 s36, s25, s27
    s_lshl_b32 s26, s36, s27
    s_sub_u32 s26, s25, s26
    s_add_u32 s36, s36, 4
    s_add_u32 s37, s26, s57
    s_load_dwordx2 s[4:5], s[0:1], 0
    s_waitcnt lgkmcnt(0)
    s_mov_b32 s12, s4
    s_mov_b32 s13, s5
    s_mov_b32 s14, 2621440
    s_mov_b32 s15, 0x20000
    s_load_dwordx2 s[4:5], s[0:1], 24
    s_waitcnt lgkmcnt(0)
    s_mov_b32 s16, s4
    s_mov_b32 s17, s5
    s_mov_b32 s18, 5242880
    s_mov_b32 s19, 0x20000
    v_lshrrev_b32 v5, 3, v4
    v_and_b32 v6, 7, v4
    v_xor_b32 v6, v6, v5
    s_lshl_b32 s26, s24, 5
    v_add_u32 v5, s26, v5
    s_mov_b32 s26, 1280
    v_mul_lo_u32 v5, v5, s26
    v_lshl_add_u32 v12, v6, 4, v5
    v_add_u32 v13, 10240, v12
    v_add_u32 v14, 20480, v12
    v_add_u32 v15, 30720, v12
    v_lshrrev_b32 v5, 4, v4
    v_and_b32 v6, 15, v4
    v_lshlrev_b32 v7, 1, v5
    v_xor_b32 v6, v6, v7
    s_lshl_b32 s26, s24, 4
    v_add_u32 v5, s26, v5
    s_mov_b32 s26, 8192
    v_mul_lo_u32 v5, v5, s26
    v_lshl_add_u32 v16, v6, 4, v5
    v_xor_b32 v6, 8, v6
    v_lshl_add_u32 v18, v6, 4, v5
    v_add_u32 v17, 32768, v16
    v_add_u32 v19, 98304, v18
    v_add_u32 v18, 65536, v18
    s_mul_i32 s30, s36, 163840
    s_lshl_b32 s31, s37, 8
    s_mov_b32 s52, 128
    s_mov_b32 s53, 524288
    s_lshr_b32 s39, s24, 1
    s_and_b32 s40, s24, 1
    s_lshl_b32 s41, s40, 6
    s_lshl_b32 s42, s39, 2
    v_add_u32 v5, s41, v2
    v_lshlrev_b32 v5, 7, v5
    v_and_b32 v6, 7, v2
    v_xor_b32 v6, v6, v3
    v_lshl_add_u32 v20, v6, 4, v5
    v_add_u32 v20, 0, v20
    v_xor_b32 v21, 64, v20
    v_lshrrev_b32 v5, 2, v2
    v_and_b32 v6, 3, v2
    v_lshl_add_u32 v7, v3, 3, v5
    v_lshlrev_b32 v7, 8, v7
    v_and_b32 v8, 1, v3
    v_lshl_or_b32 v8, v8, 2, v5
    v_lshl_add_u32 v7, v8, 5, v7
    v_lshrrev_b32 v8, 1, v6
    v_lshl_add_u32 v7, v8, 4, v7
    v_and_b32 v8, 1, v6
    v_lshl_add_u32 v7, v8, 3, v7
    s_lshl_b32 s26, s42, 5
    s_add_u32 s27, s26, 0
    v_xor_b32 v22, s27, v7
    v_add_u32 v22, 16384, v22
    s_add_u32 s27, s26, 32
    v_xor_b32 v23, s27, v7
    v_add_u32 v23, 16384, v23
    s_add_u32 s27, s26, 64
    v_xor_b32 v24, s27, v7
    v_add_u32 v24, 16384, v24
    s_add_u32 s27, s26, 96
    v_xor_b32 v25, s27, v7
    v_add_u32 v25, 16384, v25
    s_lshl_b32 s33, s24, 12
    s_add_u32 m0, s33, 0
    s_nop 0
    buffer_load_dwordx4 v12, s[12:15], s30 offen lds
    s_add_u32 m0, s33, 1024
    s_nop 0
    buffer_load_dwordx4 v13, s[12:15], s30 offen lds
    s_add_u32 m0, s33, 2048
    s_nop 0
    buffer_load_dwordx4 v14, s[12:15], s30 offen lds
    s_add_u32 m0, s33, 3072
    s_nop 0
    buffer_load_dwordx4 v15, s[12:15], s30 offen lds
    s_add_u32 m0, s33, 16384
    s_nop 0
    buffer_load_dwordx4 v16, s[16:19], s31 offen lds
    s_add_u32 m0, s33, 17408
    s_nop 0
    buffer_load_dwordx4 v17, s[16:19], s31 offen lds
    s_add_u32 m0, s33, 18432
    s_nop 0
    buffer_load_dwordx4 v18, s[16:19], s31 offen lds
    s_add_u32 m0, s33, 19456
    s_nop 0
    buffer_load_dwordx4 v19, s[16:19], s31 offen lds
    s_add_u32 s30, s30, s52
    s_add_u32 s31, s31, s53
    s_add_u32 s33, s33, 32768
    s_add_u32 m0, s33, 0
    s_nop 0
    buffer_load_dwordx4 v12, s[12:15], s30 offen lds
    s_add_u32 m0, s33, 1024
    s_nop 0
    buffer_load_dwordx4 v13, s[12:15], s30 offen lds
    s_add_u32 m0, s33, 2048
    s_nop 0
    buffer_load_dwordx4 v14, s[12:15], s30 offen lds
    s_add_u32 m0, s33, 3072
    s_nop 0
    buffer_load_dwordx4 v15, s[12:15], s30 offen lds
    s_add_u32 m0, s33, 16384
    s_nop 0
    buffer_load_dwordx4 v16, s[16:19], s31 offen lds
    s_add_u32 m0, s33, 17408
    s_nop 0
    buffer_load_dwordx4 v17, s[16:19], s31 offen lds
    s_add_u32 m0, s33, 18432
    s_nop 0
    buffer_load_dwordx4 v18, s[16:19], s31 offen lds
    s_add_u32 m0, s33, 19456
    s_nop 0
    buffer_load_dwordx4 v19, s[16:19], s31 offen lds
    s_add_u32 s30, s30, s52
    s_add_u32 s31, s31, s53
    s_add_u32 s33, s33, 32768
    s_mov_b32 s32, 0
    v_mov_b32 v64, 0
    v_mov_b32 v65, 0
    v_mov_b32 v66, 0
    v_mov_b32 v67, 0
    v_mov_b32 v68, 0
    v_mov_b32 v69, 0
    v_mov_b32 v70, 0
    v_mov_b32 v71, 0
    v_mov_b32 v72, 0
    v_mov_b32 v73, 0
    v_mov_b32 v74, 0
    v_mov_b32 v75, 0
    v_mov_b32 v76, 0
    v_mov_b32 v77, 0
    v_mov_b32 v78, 0
    v_mov_b32 v79, 0
    v_mov_b32 v80, 0
    v_mov_b32 v81, 0
    v_mov_b32 v82, 0
    v_mov_b32 v83, 0
    v_mov_b32 v84, 0
    v_mov_b32 v85, 0
    v_mov_b32 v86, 0
    v_mov_b32 v87, 0
    v_mov_b32 v88, 0
    v_mov_b32 v89, 0
    v_mov_b32 v90, 0
    v_mov_b32 v91, 0
    v_mov_b32 v92, 0
    v_mov_b32 v93, 0
    v_mov_b32 v94, 0
    v_mov_b32 v95, 0
    v_mov_b32 v96, 0
    v_mov_b32 v97, 0
    v_mov_b32 v98, 0
    v_mov_b32 v99, 0
    v_mov_b32 v100, 0
    v_mov_b32 v101, 0
    v_mov_b32 v102, 0
    v_mov_b32 v103, 0
    v_mov_b32 v104, 0
    v_mov_b32 v105, 0
    v_mov_b32 v106, 0
    v_mov_b32 v107, 0
    v_mov_b32 v108, 0
    v_mov_b32 v109, 0
    v_mov_b32 v110, 0
    v_mov_b32 v111, 0
    v_mov_b32 v112, 0
    v_mov_b32 v113, 0
    v_mov_b32 v114, 0
    v_mov_b32 v115, 0
    v_mov_b32 v116, 0
    v_mov_b32 v117, 0
    v_mov_b32 v118, 0
    v_mov_b32 v119, 0
    v_mov_b32 v120, 0
    v_mov_b32 v121, 0
    v_mov_b32 v122, 0
    v_mov_b32 v123, 0
    v_mov_b32 v124, 0
    v_mov_b32 v125, 0
    v_mov_b32 v126, 0
    v_mov_b32 v127, 0
    s_mov_b32 s34, 0
L_gemm_K_46:
    s_waitcnt vmcnt(8)
    s_barrier
    v_add_u32 v26, s32, v20
    v_add_u32 v27, s32, v21
    v_add_u32 v28, s32, v22
    v_add_u32 v29, s32, v23
    v_add_u32 v30, s32, v24
    v_add_u32 v31, s32, v25
    ds_read_b64_tr_b16 v[144:145], v28 offset:0
    ds_read_b64_tr_b16 v[146:147], v28 offset:1024
    ds_read_b128 v[128:131], v26 offset:0
    ds_read_b64_tr_b16 v[148:149], v29 offset:0
    ds_read_b64_tr_b16 v[150:151], v29 offset:1024
    ds_read_b128 v[132:135], v26 offset:2048
    ds_read_b64_tr_b16 v[152:153], v30 offset:0
    ds_read_b64_tr_b16 v[154:155], v30 offset:1024
    ds_read_b128 v[136:139], v26 offset:4096
    ds_read_b64_tr_b16 v[156:157], v31 offset:0
    ds_read_b64_tr_b16 v[158:159], v31 offset:1024
    ds_read_b128 v[140:143], v26 offset:6144
    s_cmp_lg_u32 s34, 8
    s_cbranch_scc1 L_gn_48
    s_load_dwordx2 s[4:5], s[0:1], 32
    s_waitcnt lgkmcnt(0)
    s_mov_b32 s16, s4
    s_mov_b32 s17, s5
    s_mul_i32 s30, s36, 163840
    s_lshl_b32 s31, s37, 8
L_gn_48:
    s_add_u32 m0, s33, 0
    s_nop 0
    buffer_load_dwordx4 v12, s[12:15], s30 offen lds
    s_add_u32 m0, s33, 1024
    s_nop 0
    buffer_load_dwordx4 v13, s[12:15], s30 offen lds
    s_add_u32 m0, s33, 2048
    s_nop 0
    buffer_load_dwordx4 v14, s[12:15], s30 offen lds
    s_add_u32 m0, s33, 3072
    s_nop 0
    buffer_load_dwordx4 v15, s[12:15], s30 offen lds
    s_add_u32 m0, s33, 16384
    s_nop 0
    buffer_load_dwordx4 v16, s[16:19], s31 offen lds
    s_add_u32 m0, s33, 17408
    s_nop 0
    buffer_load_dwordx4 v17, s[16:19], s31 offen lds
    s_add_u32 m0, s33, 18432
    s_nop 0
    buffer_load_dwordx4 v18, s[16:19], s31 offen lds
    s_add_u32 m0, s33, 19456
    s_nop 0
    buffer_load_dwordx4 v19, s[16:19], s31 offen lds
    s_add_u32 s30, s30, s52
    s_add_u32 s31, s31, s53
    s_add_u32 s33, s33, 32768
    s_sub_u32 s26, s33, 98304
    s_cmp_ge_u32 s33, 98304
    s_cselect_b32 s33, s26, s33
L_gd_47:
    s_waitcnt lgkmcnt(0)
    v_mfma_f32_16x16x32_bf16 v[64:67], v[144:147], v[128:131], v[64:67]
    ds_read_b64_tr_b16 v[176:177], v28 offset:8192
    ds_read_b64_tr_b16 v[178:179], v28 offset:9216
    v_mfma_f32_16x16x32_bf16 v[68:71], v[148:151], v[128:131], v[68:71]
    ds_read_b128 v[160:163], v27 offset:0
    v_mfma_f32_16x16x32_bf16 v[72:75], v[152:155], v[128:131], v[72:75]
    ds_read_b64_tr_b16 v[180:181], v29 offset:8192
    ds_read_b64_tr_b16 v[182:183], v29 offset:9216
    v_mfma_f32_16x16x32_bf16 v[76:79], v[156:159], v[128:131], v[76:79]
    ds_read_b128 v[164:167], v27 offset:2048
    v_mfma_f32_16x16x32_bf16 v[80:83], v[144:147], v[132:135], v[80:83]
    ds_read_b64_tr_b16 v[184:185], v30 offset:8192
    ds_read_b64_tr_b16 v[186:187], v30 offset:9216
    v_mfma_f32_16x16x32_bf16 v[84:87], v[148:151], v[132:135], v[84:87]
    ds_read_b128 v[168:171], v27 offset:4096
    v_mfma_f32_16x16x32_bf16 v[88:91], v[152:155], v[132:135], v[88:91]
    ds_read_b64_tr_b16 v[188:189], v31 offset:8192
    ds_read_b64_tr_b16 v[190:191], v31 offset:9216
    v_mfma_f32_16x16x32_bf16 v[92:95], v[156:159], v[132:135], v[92:95]
    ds_read_b128 v[172:175], v27 offset:6144
    v_mfma_f32_16x16x32_bf16 v[96:99], v[144:147], v[136:139], v[96:99]
    v_mfma_f32_16x16x32_bf16 v[100:103], v[148:151], v[136:139], v[100:103]
    v_mfma_f32_16x16x32_bf16 v[104:107], v[152:155], v[136:139], v[104:107]
    v_mfma_f32_16x16x32_bf16 v[108:111], v[156:159], v[136:139], v[108:111]
    v_mfma_f32_16x16x32_bf16 v[112:115], v[144:147], v[140:143], v[112:115]
    v_mfma_f32_16x16x32_bf16 v[116:119], v[148:151], v[140:143], v[116:119]
    v_mfma_f32_16x16x32_bf16 v[120:123], v[152:155], v[140:143], v[120:123]
    v_mfma_f32_16x16x32_bf16 v[124:127], v[156:159], v[140:143], v[124:127]
    s_waitcnt lgkmcnt(0)
    v_mfma_f32_16x16x32_bf16 v[64:67], v[176:179], v[160:163], v[64:67]
    v_mfma_f32_16x16x32_bf16 v[68:71], v[180:183], v[160:163], v[68:71]
    v_mfma_f32_16x16x32_bf16 v[72:75], v[184:187], v[160:163], v[72:75]
    v_mfma_f32_16x16x32_bf16 v[76:79], v[188:191], v[160:163], v[76:79]
    v_mfma_f32_16x16x32_bf16 v[80:83], v[176:179], v[164:167], v[80:83]
    v_mfma_f32_16x16x32_bf16 v[84:87], v[180:183], v[164:167], v[84:87]
    v_mfma_f32_16x16x32_bf16 v[88:91], v[184:187], v[164:167], v[88:91]
    v_mfma_f32_16x16x32_bf16 v[92:95], v[188:191], v[164:167], v[92:95]
    v_mfma_f32_16x16x32_bf16 v[96:99], v[176:179], v[168:171], v[96:99]
    v_mfma_f32_16x16x32_bf16 v[100:103], v[180:183], v[168:171], v[100:103]
    v_mfma_f32_16x16x32_bf16 v[104:107], v[184:187], v[168:171], v[104:107]
    v_mfma_f32_16x16x32_bf16 v[108:111], v[188:191], v[168:171], v[108:111]
    v_mfma_f32_16x16x32_bf16 v[112:115], v[176:179], v[172:175], v[112:115]
    v_mfma_f32_16x16x32_bf16 v[116:119], v[180:183], v[172:175], v[116:119]
    v_mfma_f32_16x16x32_bf16 v[120:123], v[184:187], v[172:175], v[120:123]
    v_mfma_f32_16x16x32_bf16 v[124:127], v[188:191], v[172:175], v[124:127]
    s_add_u32 s32, s32, 32768
    s_cmp_ge_u32 s32, 98304
    s_cselect_b32 s32, 0, s32
    s_add_u32 s34, s34, 1
    s_cmp_lt_u32 s34, 10
    s_cbranch_scc1 L_gemm_K_46
    s_nop 7
    s_lshl_b32 s26, s36, 2
    s_lshl_b32 s27, s40, 1
    s_add_u32 s26, s26, s27
    s_lshl_b32 s26, s26, 5
    s_add_u32 s26, s26, s37
    s_lshl_b32 s26, s26, 13
    s_lshl_b32 s27, s39, 11
    s_add_u32 s26, s26, s27
    s_add_u32 s26, s26, 0
    s_add_u32 s27, s26, 4096
    s_add_u32 s28, s26, 262144
    s_add_u32 s41, s28, 4096
    v_cvt_pk_bf16_f32 v32, v64, v65
    v_cvt_pk_bf16_f32 v33, v66, v67
    v_cvt_pk_bf16_f32 v34, v68, v69
    v_cvt_pk_bf16_f32 v35, v70, v71
    buffer_store_dwordx4 v[32:35], v1, s[8:11], s26 offen offset:0 sc1
    v_cvt_pk_bf16_f32 v36, v72, v73
    v_cvt_pk_bf16_f32 v37, v74, v75
    v_cvt_pk_bf16_f32 v38, v76, v77
    v_cvt_pk_bf16_f32 v39, v78, v79
    buffer_store_dwordx4 v[36:39], v1, s[8:11], s26 offen offset:1024 sc1
    v_cvt_pk_bf16_f32 v40, v80, v81
    v_cvt_pk_bf16_f32 v41, v82, v83
    v_cvt_pk_bf16_f32 v42, v84, v85
    v_cvt_pk_bf16_f32 v43, v86, v87
    buffer_store_dwordx4 v[40:43], v1, s[8:11], s27 offen offset:0 sc1
    v_cvt_pk_bf16_f32 v44, v88, v89
    v_cvt_pk_bf16_f32 v45, v90, v91
    v_cvt_pk_bf16_f32 v46, v92, v93
    v_cvt_pk_bf16_f32 v47, v94, v95
    buffer_store_dwordx4 v[44:47], v1, s[8:11], s27 offen offset:1024 sc1
    v_cvt_pk_bf16_f32 v48, v96, v97
    v_cvt_pk_bf16_f32 v49, v98, v99
    v_cvt_pk_bf16_f32 v50, v100, v101
    v_cvt_pk_bf16_f32 v51, v102, v103
    buffer_store_dwordx4 v[48:51], v1, s[8:11], s28 offen offset:0 sc1
    v_cvt_pk_bf16_f32 v52, v104, v105
    v_cvt_pk_bf16_f32 v53, v106, v107
    v_cvt_pk_bf16_f32 v54, v108, v109
    v_cvt_pk_bf16_f32 v55, v110, v111
    buffer_store_dwordx4 v[52:55], v1, s[8:11], s28 offen offset:1024 sc1
    v_cvt_pk_bf16_f32 v56, v112, v113
    v_cvt_pk_bf16_f32 v57, v114, v115
    v_cvt_pk_bf16_f32 v58, v116, v117
    v_cvt_pk_bf16_f32 v59, v118, v119
    buffer_store_dwordx4 v[56:59], v1, s[8:11], s41 offen offset:0 sc1
    v_cvt_pk_bf16_f32 v60, v120, v121
    v_cvt_pk_bf16_f32 v61, v122, v123
    v_cvt_pk_bf16_f32 v62, v124, v125
    v_cvt_pk_bf16_f32 v63, v126, v127
    buffer_store_dwordx4 v[60:63], v1, s[8:11], s41 offen offset:1024 sc1
    s_lshl_b32 s41, s39, 6
    s_lshl_b32 s42, s40, 2
    v_add_u32 v5, s41, v2
    v_lshlrev_b32 v5, 7, v5
    v_and_b32 v6, 7, v2
    v_xor_b32 v6, v6, v3
    v_lshl_add_u32 v20, v6, 4, v5
    v_add_u32 v20, 0, v20
    v_xor_b32 v21, 64, v20
    v_lshrrev_b32 v5, 2, v2
    v_and_b32 v6, 3, v2
    v_lshl_add_u32 v7, v3, 3, v5
    v_lshlrev_b32 v7, 8, v7
    v_and_b32 v8, 1, v3
    v_lshl_or_b32 v8, v8, 2, v5
    v_lshl_add_u32 v7, v8, 5, v7
    v_lshrrev_b32 v8, 1, v6
    v_lshl_add_u32 v7, v8, 4, v7
    v_and_b32 v8, 1, v6
    v_lshl_add_u32 v7, v8, 3, v7
    s_lshl_b32 s26, s42, 5
    s_add_u32 s27, s26, 0
    v_xor_b32 v22, s27, v7
    v_add_u32 v22, 16384, v22
    s_add_u32 s27, s26, 32
    v_xor_b32 v23, s27, v7
    v_add_u32 v23, 16384, v23
    s_add_u32 s27, s26, 64
    v_xor_b32 v24, s27, v7
    v_add_u32 v24, 16384, v24
    s_add_u32 s27, s26, 96
    v_xor_b32 v25, s27, v7
    v_add_u32 v25, 16384, v25
    v_mov_b32 v64, 0
    v_mov_b32 v65, 0
    v_mov_b32 v66, 0
    v_mov_b32 v67, 0
    v_mov_b32 v68, 0
    v_mov_b32 v69, 0
    v_mov_b32 v70, 0
    v_mov_b32 v71, 0
    v_mov_b32 v72, 0
    v_mov_b32 v73, 0
    v_mov_b32 v74, 0
    v_mov_b32 v75, 0
    v_mov_b32 v76, 0
    v_mov_b32 v77, 0
    v_mov_b32 v78, 0
    v_mov_b32 v79, 0
    v_mov_b32 v80, 0
    v_mov_b32 v81, 0
    v_mov_b32 v82, 0
    v_mov_b32 v83, 0
    v_mov_b32 v84, 0
    v_mov_b32 v85, 0
    v_mov_b32 v86, 0
    v_mov_b32 v87, 0
    v_mov_b32 v88, 0
    v_mov_b32 v89, 0
    v_mov_b32 v90, 0
    v_mov_b32 v91, 0
    v_mov_b32 v92, 0
    v_mov_b32 v93, 0
    v_mov_b32 v94, 0
    v_mov_b32 v95, 0
    v_mov_b32 v96, 0
    v_mov_b32 v97, 0
    v_mov_b32 v98, 0
    v_mov_b32 v99, 0
    v_mov_b32 v100, 0
    v_mov_b32 v101, 0
    v_mov_b32 v102, 0
    v_mov_b32 v103, 0
    v_mov_b32 v104, 0
    v_mov_b32 v105, 0
    v_mov_b32 v106, 0
    v_mov_b32 v107, 0
    v_mov_b32 v108, 0
    v_mov_b32 v109, 0
    v_mov_b32 v110, 0
    v_mov_b32 v111, 0
    v_mov_b32 v112, 0
    v_mov_b32 v113, 0
    v_mov_b32 v114, 0
    v_mov_b32 v115, 0
    v_mov_b32 v116, 0
    v_mov_b32 v117, 0
    v_mov_b32 v118, 0
    v_mov_b32 v119, 0
    v_mov_b32 v120, 0
    v_mov_b32 v121, 0
    v_mov_b32 v122, 0
    v_mov_b32 v123, 0
    v_mov_b32 v124, 0
    v_mov_b32 v125, 0
    v_mov_b32 v126, 0
    v_mov_b32 v127, 0
    s_mov_b32 s34, 0
L_gemm_V_49:
    s_waitcnt vmcnt(8)
    s_barrier
    v_add_u32 v26, s32, v20
    v_add_u32 v27, s32, v21
    v_add_u32 v28, s32, v22
    v_add_u32 v29, s32, v23
    v_add_u32 v30, s32, v24
    v_add_u32 v31, s32, v25
    ds_read_b64_tr_b16 v[144:145], v28 offset:0
    ds_read_b64_tr_b16 v[146:147], v28 offset:1024
    ds_read_b128 v[128:131], v26 offset:0
    ds_read_b64_tr_b16 v[148:149], v29 offset:0
    ds_read_b64_tr_b16 v[150:151], v29 offset:1024
    ds_read_b128 v[132:135], v26 offset:2048
    ds_read_b64_tr_b16 v[152:153], v30 offset:0
    ds_read_b64_tr_b16 v[154:155], v30 offset:1024
    ds_read_b128 v[136:139], v26 offset:4096
    ds_read_b64_tr_b16 v[156:157], v31 offset:0
    ds_read_b64_tr_b16 v[158:159], v31 offset:1024
    ds_read_b128 v[140:143], v26 offset:6144
    s_cmp_lg_u32 s34, 8
    s_cbranch_scc1 L_gn_51
    s_load_dwordx2 s[4:5], s[0:1], 16
    s_waitcnt lgkmcnt(0)
    s_mov_b32 s16, s4
    s_mov_b32 s17, s5
    s_mul_i32 s30, s36, 163840
    s_lshl_b32 s31, s37, 8
L_gn_51:
    s_add_u32 m0, s33, 0
    s_nop 0
    buffer_load_dwordx4 v12, s[12:15], s30 offen lds
    s_add_u32 m0, s33, 1024
    s_nop 0
    buffer_load_dwordx4 v13, s[12:15], s30 offen lds
    s_add_u32 m0, s33, 2048
    s_nop 0
    buffer_load_dwordx4 v14, s[12:15], s30 offen lds
    s_add_u32 m0, s33, 3072
    s_nop 0
    buffer_load_dwordx4 v15, s[12:15], s30 offen lds
    s_add_u32 m0, s33, 16384
    s_nop 0
    buffer_load_dwordx4 v16, s[16:19], s31 offen lds
    s_add_u32 m0, s33, 17408
    s_nop 0
    buffer_load_dwordx4 v17, s[16:19], s31 offen lds
    s_add_u32 m0, s33, 18432
    s_nop 0
    buffer_load_dwordx4 v18, s[16:19], s31 offen lds
    s_add_u32 m0, s33, 19456
    s_nop 0
    buffer_load_dwordx4 v19, s[16:19], s31 offen lds
    s_add_u32 s30, s30, s52
    s_add_u32 s31, s31, s53
    s_add_u32 s33, s33, 32768
    s_sub_u32 s26, s33, 98304
    s_cmp_ge_u32 s33, 98304
    s_cselect_b32 s33, s26, s33
L_gd_50:
    s_waitcnt lgkmcnt(0)
    v_mfma_f32_16x16x32_bf16 v[64:67], v[128:131], v[144:147], v[64:67]
    ds_read_b64_tr_b16 v[176:177], v28 offset:8192
    ds_read_b64_tr_b16 v[178:179], v28 offset:9216
    v_mfma_f32_16x16x32_bf16 v[68:71], v[128:131], v[148:151], v[68:71]
    ds_read_b128 v[160:163], v27 offset:0
    v_mfma_f32_16x16x32_bf16 v[72:75], v[128:131], v[152:155], v[72:75]
    ds_read_b64_tr_b16 v[180:181], v29 offset:8192
    ds_read_b64_tr_b16 v[182:183], v29 offset:9216
    v_mfma_f32_16x16x32_bf16 v[76:79], v[128:131], v[156:159], v[76:79]
    ds_read_b128 v[164:167], v27 offset:2048
    v_mfma_f32_16x16x32_bf16 v[80:83], v[132:135], v[144:147], v[80:83]
    ds_read_b64_tr_b16 v[184:185], v30 offset:8192
    ds_read_b64_tr_b16 v[186:187], v30 offset:9216
    v_mfma_f32_16x16x32_bf16 v[84:87], v[132:135], v[148:151], v[84:87]
    ds_read_b128 v[168:171], v27 offset:4096
    v_mfma_f32_16x16x32_bf16 v[88:91], v[132:135], v[152:155], v[88:91]
    ds_read_b64_tr_b16 v[188:189], v31 offset:8192
    ds_read_b64_tr_b16 v[190:191], v31 offset:9216
    v_mfma_f32_16x16x32_bf16 v[92:95], v[132:135], v[156:159], v[92:95]
    ds_read_b128 v[172:175], v27 offset:6144
    v_mfma_f32_16x16x32_bf16 v[96:99], v[136:139], v[144:147], v[96:99]
    v_mfma_f32_16x16x32_bf16 v[100:103], v[136:139], v[148:151], v[100:103]
    v_mfma_f32_16x16x32_bf16 v[104:107], v[136:139], v[152:155], v[104:107]
    v_mfma_f32_16x16x32_bf16 v[108:111], v[136:139], v[156:159], v[108:111]
    v_mfma_f32_16x16x32_bf16 v[112:115], v[140:143], v[144:147], v[112:115]
    v_mfma_f32_16x16x32_bf16 v[116:119], v[140:143], v[148:151], v[116:119]
    v_mfma_f32_16x16x32_bf16 v[120:123], v[140:143], v[152:155], v[120:123]
    v_mfma_f32_16x16x32_bf16 v[124:127], v[140:143], v[156:159], v[124:127]
    s_waitcnt lgkmcnt(0)
    v_mfma_f32_16x16x32_bf16 v[64:67], v[160:163], v[176:179], v[64:67]
    v_mfma_f32_16x16x32_bf16 v[68:71], v[160:163], v[180:183], v[68:71]
    v_mfma_f32_16x16x32_bf16 v[72:75], v[160:163], v[184:187], v[72:75]
    v_mfma_f32_16x16x32_bf16 v[76:79], v[160:163], v[188:191], v[76:79]
    v_mfma_f32_16x16x32_bf16 v[80:83], v[164:167], v[176:179], v[80:83]
    v_mfma_f32_16x16x32_bf16 v[84:87], v[164:167], v[180:183], v[84:87]
    v_mfma_f32_16x16x32_bf16 v[88:91], v[164:167], v[184:187], v[88:91]
    v_mfma_f32_16x16x32_bf16 v[92:95], v[164:167], v[188:191], v[92:95]
    v_mfma_f32_16x16x32_bf16 v[96:99], v[168:171], v[176:179], v[96:99]
    v_mfma_f32_16x16x32_bf16 v[100:103], v[168:171], v[180:183], v[100:103]
    v_mfma_f32_16x16x32_bf16 v[104:107], v[168:171], v[184:187], v[104:107]
    v_mfma_f32_16x16x32_bf16 v[108:111], v[168:171], v[188:191], v[108:111]
    v_mfma_f32_16x16x32_bf16 v[112:115], v[172:175], v[176:179], v[112:115]
    v_mfma_f32_16x16x32_bf16 v[116:119], v[172:175], v[180:183], v[116:119]
    v_mfma_f32_16x16x32_bf16 v[120:123], v[172:175], v[184:187], v[120:123]
    v_mfma_f32_16x16x32_bf16 v[124:127], v[172:175], v[188:191], v[124:127]
    s_add_u32 s32, s32, 32768
    s_cmp_ge_u32 s32, 98304
    s_cselect_b32 s32, 0, s32
    s_add_u32 s34, s34, 1
    s_cmp_lt_u32 s34, 10
    s_cbranch_scc1 L_gemm_V_49
    s_nop 7
    s_lshl_b32 s26, s36, 2
    s_lshl_b32 s27, s39, 1
    s_add_u32 s26, s26, s27
    s_lshl_b32 s26, s26, 5
    s_add_u32 s26, s26, s37
    s_lshl_b32 s26, s26, 13
    s_lshl_b32 s27, s40, 12
    s_add_u32 s26, s26, s27
    s_add_u32 s26, s26, 16777216
    s_add_u32 s27, s26, 262144
    v_cvt_pk_bf16_f32 v32, v64, v65
    v_cvt_pk_bf16_f32 v33, v66, v67
    v_cvt_pk_bf16_f32 v34, v80, v81
    v_cvt_pk_bf16_f32 v35, v82, v83
    buffer_store_dwordx4 v[32:35], v1, s[8:11], s26 offen offset:0 sc1
    v_cvt_pk_bf16_f32 v36, v68, v69
    v_cvt_pk_bf16_f32 v37, v70, v71
    v_cvt_pk_bf16_f32 v38, v84, v85
    v_cvt_pk_bf16_f32 v39, v86, v87
    buffer_store_dwordx4 v[36:39], v1, s[8:11], s26 offen offset:1024 sc1
    v_cvt_pk_bf16_f32 v40, v72, v73
    v_cvt_pk_bf16_f32 v41, v74, v75
    v_cvt_pk_bf16_f32 v42, v88, v89
    v_cvt_pk_bf16_f32 v43, v90, v91
    buffer_store_dwordx4 v[40:43], v1, s[8:11], s26 offen offset:2048 sc1
    v_cvt_pk_bf16_f32 v44, v76, v77
    v_cvt_pk_bf16_f32 v45, v78, v79
    v_cvt_pk_bf16_f32 v46, v92, v93
    v_cvt_pk_bf16_f32 v47, v94, v95
    buffer_store_dwordx4 v[44:47], v1, s[8:11], s26 offen offset:3072 sc1
    v_cvt_pk_bf16_f32 v48, v96, v97
    v_cvt_pk_bf16_f32 v49, v98, v99
    v_cvt_pk_bf16_f32 v50, v112, v113
    v_cvt_pk_bf16_f32 v51, v114, v115
    buffer_store_dwordx4 v[48:51], v1, s[8:11], s27 offen offset:0 sc1
    v_cvt_pk_bf16_f32 v52, v100, v101
    v_cvt_pk_bf16_f32 v53, v102, v103
    v_cvt_pk_bf16_f32 v54, v116, v117
    v_cvt_pk_bf16_f32 v55, v118, v119
    buffer_store_dwordx4 v[52:55], v1, s[8:11], s27 offen offset:1024 sc1
    v_cvt_pk_bf16_f32 v56, v104, v105
    v_cvt_pk_bf16_f32 v57, v106, v107
    v_cvt_pk_bf16_f32 v58, v120, v121
    v_cvt_pk_bf16_f32 v59, v122, v123
    buffer_store_dwordx4 v[56:59], v1, s[8:11], s27 offen offset:2048 sc1
    v_cvt_pk_bf16_f32 v60, v108, v109
    v_cvt_pk_bf16_f32 v61, v110, v111
    v_cvt_pk_bf16_f32 v62, v124, v125
    v_cvt_pk_bf16_f32 v63, v126, v127
    buffer_store_dwordx4 v[60:63], v1, s[8:11], s27 offen offset:3072 sc1
    s_lshl_b32 s41, s40, 6
    s_lshl_b32 s42, s39, 2
    v_add_u32 v5, s41, v2
    v_lshlrev_b32 v5, 7, v5
    v_and_b32 v6, 7, v2
    v_xor_b32 v6, v6, v3
    v_lshl_add_u32 v20, v6, 4, v5
    v_add_u32 v20, 0, v20
    v_xor_b32 v21, 64, v20
    v_lshrrev_b32 v5, 2, v2
    v_and_b32 v6, 3, v2
    v_lshl_add_u32 v7, v3, 3, v5
    v_lshlrev_b32 v7, 8, v7
    v_and_b32 v8, 1, v3
    v_lshl_or_b32 v8, v8, 2, v5
    v_lshl_add_u32 v7, v8, 5, v7
    v_lshrrev_b32 v8, 1, v6
    v_lshl_add_u32 v7, v8, 4, v7
    v_and_b32 v8, 1, v6
    v_lshl_add_u32 v7, v8, 3, v7
    s_lshl_b32 s26, s42, 5
    s_add_u32 s27, s26, 0
    v_xor_b32 v22, s27, v7
    v_add_u32 v22, 16384, v22
    s_add_u32 s27, s26, 32
    v_xor_b32 v23, s27, v7
    v_add_u32 v23, 16384, v23
    s_add_u32 s27, s26, 64
    v_xor_b32 v24, s27, v7
    v_add_u32 v24, 16384, v24
    s_add_u32 s27, s26, 96
    v_xor_b32 v25, s27, v7
    v_add_u32 v25, 16384, v25
    v_mov_b32 v64, 0
    v_mov_b32 v65, 0
    v_mov_b32 v66, 0
    v_mov_b32 v67, 0
    v_mov_b32 v68, 0
    v_mov_b32 v69, 0
    v_mov_b32 v70, 0
    v_mov_b32 v71, 0
    v_mov_b32 v72, 0
    v_mov_b32 v73, 0
    v_mov_b32 v74, 0
    v_mov_b32 v75, 0
    v_mov_b32 v76, 0
    v_mov_b32 v77, 0
    v_mov_b32 v78, 0
    v_mov_b32 v79, 0
    v_mov_b32 v80, 0
    v_mov_b32 v81, 0
    v_mov_b32 v82, 0
    v_mov_b32 v83, 0
    v_mov_b32 v84, 0
    v_mov_b32 v85, 0
    v_mov_b32 v86, 0
    v_mov_b32 v87, 0
    v_mov_b32 v88, 0
    v_mov_b32 v89, 0
    v_mov_b32 v90, 0
    v_mov_b32 v91, 0
    v_mov_b32 v92, 0
    v_mov_b32 v93, 0
    v_mov_b32 v94, 0
    v_mov_b32 v95, 0
    v_mov_b32 v96, 0
    v_mov_b32 v97, 0
    v_mov_b32 v98, 0
    v_mov_b32 v99, 0
    v_mov_b32 v100, 0
    v_mov_b32 v101, 0
    v_mov_b32 v102, 0
    v_mov_b32 v103, 0
    v_mov_b32 v104, 0
    v_mov_b32 v105, 0
    v_mov_b32 v106, 0
    v_mov_b32 v107, 0
    v_mov_b32 v108, 0
    v_mov_b32 v109, 0
    v_mov_b32 v110, 0
    v_mov_b32 v111, 0
    v_mov_b32 v112, 0
    v_mov_b32 v113, 0
    v_mov_b32 v114, 0
    v_mov_b32 v115, 0
    v_mov_b32 v116, 0
    v_mov_b32 v117, 0
    v_mov_b32 v118, 0
    v_mov_b32 v119, 0
    v_mov_b32 v120, 0
    v_mov_b32 v121, 0
    v_mov_b32 v122, 0
    v_mov_b32 v123, 0
    v_mov_b32 v124, 0
    v_mov_b32 v125, 0
    v_mov_b32 v126, 0
    v_mov_b32 v127, 0
    s_mov_b32 s34, 0
L_gemm_Q_52:
    s_cmp_ge_u32 s34, 9
    s_cbranch_scc1 L_gw_53_last
    s_waitcnt vmcnt(8)
    s_branch L_gw_53
L_gw_53_last:
    s_waitcnt vmcnt(0)
L_gw_53:
    s_barrier
    v_add_u32 v26, s32, v20
    v_add_u32 v27, s32, v21
    v_add_u32 v28, s32, v22
    v_add_u32 v29, s32, v23
    v_add_u32 v30, s32, v24
    v_add_u32 v31, s32, v25
    ds_read_b64_tr_b16 v[144:145], v28 offset:0
    ds_read_b64_tr_b16 v[146:147], v28 offset:1024
    ds_read_b128 v[128:131], v26 offset:0
    ds_read_b64_tr_b16 v[148:149], v29 offset:0
    ds_read_b64_tr_b16 v[150:151], v29 offset:1024
    ds_read_b128 v[132:135], v26 offset:2048
    ds_read_b64_tr_b16 v[152:153], v30 offset:0
    ds_read_b64_tr_b16 v[154:155], v30 offset:1024
    ds_read_b128 v[136:139], v26 offset:4096
    ds_read_b64_tr_b16 v[156:157], v31 offset:0
    ds_read_b64_tr_b16 v[158:159], v31 offset:1024
    ds_read_b128 v[140:143], v26 offset:6144
    s_cmp_ge_u32 s34, 8
    s_cbranch_scc1 L_gd_54
    s_add_u32 m0, s33, 0
    s_nop 0
    buffer_load_dwordx4 v12, s[12:15], s30 offen lds
    s_add_u32 m0, s33, 1024
    s_nop 0
    buffer_load_dwordx4 v13, s[12:15], s30 offen lds
    s_add_u32 m0, s33, 2048
    s_nop 0
    buffer_load_dwordx4 v14, s[12:15], s30 offen lds
    s_add_u32 m0, s33, 3072
    s_nop 0
    buffer_load_dwordx4 v15, s[12:15], s30 offen lds
    s_add_u32 m0, s33, 16384
    s_nop 0
    buffer_load_dwordx4 v16, s[16:19], s31 offen lds
    s_add_u32 m0, s33, 17408
    s_nop 0
    buffer_load_dwordx4 v17, s[16:19], s31 offen lds
    s_add_u32 m0, s33, 18432
    s_nop 0
    buffer_load_dwordx4 v18, s[16:19], s31 offen lds
    s_add_u32 m0, s33, 19456
    s_nop 0
    buffer_load_dwordx4 v19, s[16:19], s31 offen lds
    s_add_u32 s30, s30, s52
    s_add_u32 s31, s31, s53
    s_add_u32 s33, s33, 32768
    s_sub_u32 s26, s33, 98304
    s_cmp_ge_u32 s33, 98304
    s_cselect_b32 s33, s26, s33
L_gd_54:
    s_waitcnt lgkmcnt(0)
    v_mfma_f32_16x16x32_bf16 v[64:67], v[144:147], v[128:131], v[64:67]
    ds_read_b64_tr_b16 v[176:177], v28 offset:8192
    ds_read_b64_tr_b16 v[178:179], v28 offset:9216
    v_mfma_f32_16x16x32_bf16 v[68:71], v[148:151], v[128:131], v[68:71]
    ds_read_b128 v[160:163], v27 offset:0
    v_mfma_f32_16x16x32_bf16 v[72:75], v[152:155], v[128:131], v[72:75]
    ds_read_b64_tr_b16 v[180:181], v29 offset:8192
    ds_read_b64_tr_b16 v[182:183], v29 offset:9216
    v_mfma_f32_16x16x32_bf16 v[76:79], v[156:159], v[128:131], v[76:79]
    ds_read_b128 v[164:167], v27 offset:2048
    v_mfma_f32_16x16x32_bf16 v[80:83], v[144:147], v[132:135], v[80:83]
    ds_read_b64_tr_b16 v[184:185], v30 offset:8192
    ds_read_b64_tr_b16 v[186:187], v30 offset:9216
    v_mfma_f32_16x16x32_bf16 v[84:87], v[148:151], v[132:135], v[84:87]
    ds_read_b128 v[168:171], v27 offset:4096
    v_mfma_f32_16x16x32_bf16 v[88:91], v[152:155], v[132:135], v[88:91]
    ds_read_b64_tr_b16 v[188:189], v31 offset:8192
    ds_read_b64_tr_b16 v[190:191], v31 offset:9216
    v_mfma_f32_16x16x32_bf16 v[92:95], v[156:159], v[132:135], v[92:95]
    ds_read_b128 v[172:175], v27 offset:6144
    v_mfma_f32_16x16x32_bf16 v[96:99], v[144:147], v[136:139], v[96:99]
    v_mfma_f32_16x16x32_bf16 v[100:103], v[148:151], v[136:139], v[100:103]
    v_mfma_f32_16x16x32_bf16 v[104:107], v[152:155], v[136:139], v[104:107]
    v_mfma_f32_16x16x32_bf16 v[108:111], v[156:159], v[136:139], v[108:111]
    v_mfma_f32_16x16x32_bf16 v[112:115], v[144:147], v[140:143], v[112:115]
    v_mfma_f32_16x16x32_bf16 v[116:119], v[148:151], v[140:143], v[116:119]
    v_mfma_f32_16x16x32_bf16 v[120:123], v[152:155], v[140:143], v[120:123]
    v_mfma_f32_16x16x32_bf16 v[124:127], v[156:159], v[140:143], v[124:127]
    s_waitcnt lgkmcnt(0)
    v_mfma_f32_16x16x32_bf16 v[64:67], v[176:179], v[160:163], v[64:67]
    v_mfma_f32_16x16x32_bf16 v[68:71], v[180:183], v[160:163], v[68:71]
    v_mfma_f32_16x16x32_bf16 v[72:75], v[184:187], v[160:163], v[72:75]
    v_mfma_f32_16x16x32_bf16 v[76:79], v[188:191], v[160:163], v[76:79]
    v_mfma_f32_16x16x32_bf16 v[80:83], v[176:179], v[164:167], v[80:83]
    v_mfma_f32_16x16x32_bf16 v[84:87], v[180:183], v[164:167], v[84:87]
    v_mfma_f32_16x16x32_bf16 v[88:91], v[184:187], v[164:167], v[88:91]
    v_mfma_f32_16x16x32_bf16 v[92:95], v[188:191], v[164:167], v[92:95]
    v_mfma_f32_16x16x32_bf16 v[96:99], v[176:179], v[168:171], v[96:99]
    v_mfma_f32_16x16x32_bf16 v[100:103], v[180:183], v[168:171], v[100:103]
    v_mfma_f32_16x16x32_bf16 v[104:107], v[184:187], v[168:171], v[104:107]
    v_mfma_f32_16x16x32_bf16 v[108:111], v[188:191], v[168:171], v[108:111]
    v_mfma_f32_16x16x32_bf16 v[112:115], v[176:179], v[172:175], v[112:115]
    v_mfma_f32_16x16x32_bf16 v[116:119], v[180:183], v[172:175], v[116:119]
    v_mfma_f32_16x16x32_bf16 v[120:123], v[184:187], v[172:175], v[120:123]
    v_mfma_f32_16x16x32_bf16 v[124:127], v[188:191], v[172:175], v[124:127]
    s_add_u32 s32, s32, 32768
    s_cmp_ge_u32 s32, 98304
    s_cselect_b32 s32, 0, s32
    s_add_u32 s34, s34, 1
    s_cmp_lt_u32 s34, 10
    s_cbranch_scc1 L_gemm_Q_52
    s_nop 7
    s_barrier
    s_lshl_b32 s26, s36, 2
    s_lshl_b32 s27, s40, 1
    s_add_u32 s26, s26, s27
    s_lshl_b32 s26, s26, 5
    s_add_u32 s26, s26, s37
    s_lshl_b32 s26, s26, 13
    s_lshl_b32 s27, s39, 11
    s_add_u32 s26, s26, s27
    s_add_u32 s26, s26, 33554432
    s_add_u32 s27, s26, 4096
    s_add_u32 s28, s26, 262144
    s_add_u32 s41, s28, 4096
    v_cvt_pk_bf16_f32 v32, v64, v65
    v_cvt_pk_bf16_f32 v33, v66, v67
    v_cvt_pk_bf16_f32 v34, v68, v69
    v_cvt_pk_bf16_f32 v35, v70, v71
    buffer_store_dwordx4 v[32:35], v1, s[8:11], s26 offen offset:0 sc1
    v_cvt_pk_bf16_f32 v36, v72, v73
    v_cvt_pk_bf16_f32 v37, v74, v75
    v_cvt_pk_bf16_f32 v38, v76, v77
    v_cvt_pk_bf16_f32 v39, v78, v79
    buffer_store_dwordx4 v[36:39], v1, s[8:11], s26 offen offset:1024 sc1
    v_cvt_pk_bf16_f32 v40, v80, v81
    v_cvt_pk_bf16_f32 v41, v82, v83
    v_cvt_pk_bf16_f32 v42, v84, v85
    v_cvt_pk_bf16_f32 v43, v86, v87
    buffer_store_dwordx4 v[40:43], v1, s[8:11], s27 offen offset:0 sc1
    v_cvt_pk_bf16_f32 v44, v88, v89
    v_cvt_pk_bf16_f32 v45, v90, v91
    v_cvt_pk_bf16_f32 v46, v92, v93
    v_cvt_pk_bf16_f32 v47, v94, v95
    buffer_store_dwordx4 v[44:47], v1, s[8:11], s27 offen offset:1024 sc1
    v_cvt_pk_bf16_f32 v48, v96, v97
    v_cvt_pk_bf16_f32 v49, v98, v99
    v_cvt_pk_bf16_f32 v50, v100, v101
    v_cvt_pk_bf16_f32 v51, v102, v103
    buffer_store_dwordx4 v[48:51], v1, s[8:11], s28 offen offset:0 sc1
    v_cvt_pk_bf16_f32 v52, v104, v105
    v_cvt_pk_bf16_f32 v53, v106, v107
    v_cvt_pk_bf16_f32 v54, v108, v109
    v_cvt_pk_bf16_f32 v55, v110, v111
    buffer_store_dwordx4 v[52:55], v1, s[8:11], s28 offen offset:1024 sc1
    v_cvt_pk_bf16_f32 v56, v112, v113
    v_cvt_pk_bf16_f32 v57, v114, v115
    v_cvt_pk_bf16_f32 v58, v116, v117
    v_cvt_pk_bf16_f32 v59, v118, v119
    buffer_store_dwordx4 v[56:59], v1, s[8:11], s41 offen offset:0 sc1
    v_cvt_pk_bf16_f32 v60, v120, v121
    v_cvt_pk_bf16_f32 v61, v122, v123
    v_cvt_pk_bf16_f32 v62, v124, v125
    v_cvt_pk_bf16_f32 v63, v126, v127
    buffer_store_dwordx4 v[60:63], v1, s[8:11], s41 offen offset:1024 sc1
    s_lshl_b32 s26, s36, 5
    s_add_u32 s26, s26, s37
    s_lshl_b32 s26, s26, 2
    s_add_u32 s39, s26, 102760448
    s_cmp_eq_u32 s58, 1
    s_cbranch_scc1 L_zok_55
    v_mov_b32 v10, 40
L_wsp_56:
    buffer_load_dword v11, v10, s[20:23], 0 offen sc1
    s_waitcnt vmcnt(0)
    v_readfirstlane_b32 s29, v11
    s_cmp_ge_u32 s29, 256
    s_cbranch_scc1 L_wsp_56_ok
    s_sleep 2
    s_sub_u32 s38, s38, 1
    s_cbranch_scc0 L_wsp_56
    s_branch L_w_abort
L_wsp_56_ok:
    s_mov_b32 s58, 1
L_zok_55:
    s_waitcnt vmcnt(0)
    s_barrier
    s_cmp_lg_u32 s24, 0
    s_cbranch_scc1 L_sig_57
    v_mov_b32 v5, s39
    v_mov_b32 v6, 2
    s_mov_b64 exec, 1
    buffer_atomic_add v6, v5, s[8:11], 0 offen sc1
    s_mov_b64 exec, -1
L_sig_57:
    s_lshl_b32 s26, s36, 5
    s_add_u32 s26, s26, s37
    s_lshl_b32 s26, s26, 2
    s_add_u32 s39, s26, 102762496
    s_cmp_lg_u32 s24, 0
    s_cbranch_scc1 L_sig_58
    v_mov_b32 v5, s39
    v_mov_b32 v6, 1
    s_mov_b64 exec, 1
    buffer_atomic_add v6, v5, s[8:11], 0 offen sc1
    s_mov_b64 exec, -1
L_sig_58:
    s_branch L_kvq_next_21
L_kvq_qd_24:
    s_add_u32 s60, s60, 1
    s_cmp_lt_u32 s60, 6
    s_cbranch_scc1 L_kvq_q_22
    s_mov_b32 s61, 112
L_G1_next_59:
    s_mov_b32 s61, 112
    s_barrier
    s_cmp_lg_u32 s24, 0
    s_cbranch_scc1 L_fetch_61
    v_mov_b32 v5, s61
    v_mov_b32 v6, 1
    s_mov_b64 exec, 1
    buffer_atomic_add v6, v5, s[20:23], 0 offen sc0
    s_waitcnt vmcnt(0)
    v_mov_b32 v5, 163836
    ds_write_b32 v5, v6
    s_waitcnt lgkmcnt(0)
    s_mov_b64 exec, -1
L_fetch_61:
    s_barrier
    v_mov_b32 v5, 163836
    ds_read_b32 v6, v5
    s_waitcnt lgkmcnt(0)
    v_readfirstlane_b32 s25, v6
    s_cmp_ge_u32 s25, 160
    s_cbranch_scc1 L_G1_done_60
    s_mul_i32 s36, s25, 6554
    s_lshr_b32 s36, s36, 16
    s_mul_i32 s26, s36, 10
    s_sub_u32 s37, s25, s26
    s_load_dwordx2 s[4:5], s[0:1], 56
    s_waitcnt lgkmcnt(0)
    s_mov_b32 s12, s4
    s_mov_b32 s13, s5
    s_mov_b32 s14, 2621440
    s_mov_b32 s15, 0x20000
    s_load_dwordx2 s[4:5], s[0:1], 80
    s_load_dwordx2 s[6:7], s[0:1], 88
    s_waitcnt lgkmcnt(0)
    s_cmp_ge_u32 s24, 2
    s_cselect_b32 s16, s6, s4
    s_cselect_b32 s17, s7, s5
    s_mov_b32 s18, 819200
    s_mov_b32 s19, 0x20000
    v_lshrrev_b32 v5, 3, v4
    v_and_b32 v6, 7, v4
    v_and_b32 v7, 3, v5
    s_and_b32 s26, s24, 1
    s_lshl_b32 s26, s26, 2
    v_or_b32 v7, s26, v7
    v_xor_b32 v6, v6, v7
    s_lshl_b32 s26, s24, 5
    v_add_u32 v5, s26, v5
    s_mov_b32 s26, 1280
    v_mul_lo_u32 v5, v5, s26
    v_lshl_add_u32 v12, v6, 4, v5
    v_add_u32 v13, 10240, v12
    v_add_u32 v14, 20480, v12
    v_add_u32 v15, 30720, v12
    v_lshrrev_b32 v5, 3, v4
    v_and_b32 v6, 7, v4
    v_xor_b32 v6, v6, v5
    s_and_b32 s26, s24, 1
    s_lshl_b32 s26, s26, 5
    v_add_u32 v5, s26, v5
    v_mul_u32_u24 v5, 1280, v5
    v_lshl_add_u32 v16, v6, 4, v5
    v_add_u32 v17, 10240, v16
    v_add_u32 v18, 20480, v16
    v_add_u32 v19, 30720, v16
    s_mul_i32 s30, s36, 163840
    s_mul_i32 s31, s37, 81920
    s_mov_b32 s52, 128
    s_mov_b32 s53, 128
    s_lshl_b32 s41, s24, 4
    v_lshrrev_b32 v5, 2, v2
    v_lshlrev_b32 v5, 5, v5
    v_and_b32 v6, 3, v2
    v_add_u32 v5, v5, v6
    v_lshlrev_b32 v5, 7, v5
    v_bfe_u32 v7, v2, 2, 1
    v_lshl_or_b32 v6, v7, 2, v6
    v_xor_b32 v6, v6, v3
    v_lshl_add_u32 v20, v6, 4, v5
    v_add_u32 v20, 0, v20
    v_xor_b32 v21, 64, v20
    v_add_u32 v5, s41, v2
    v_lshlrev_b32 v5, 7, v5
    v_and_b32 v6, 7, v2
    v_xor_b32 v6, v6, v3
    v_lshl_add_u32 v22, v6, 4, v5
    v_add_u32 v22, 16384, v22
    v_xor_b32 v23, 64, v22
    s_lshl_b32 s26, s37, 6
    s_add_u32 s26, s26, s41
    v_add_u32 v56, s26, v2
    s_load_dwordx2 s[4:5], s[0:1], 64
    s_waitcnt lgkmcnt(0)
    s_mov_b32 s48, s4
    s_mov_b32 s49, s5
    s_mov_b32 s50, 1280
    s_mov_b32 s51, 0x20000
    v_lshlrev_b32 v5, 1, v56
    buffer_load_ushort v32, v5, s[48:51], 0 offen
    s_waitcnt vmcnt(0)
    v_lshlrev_b32 v32, 16, v32
    s_load_dwordx2 s[4:5], s[0:1], 72
    s_waitcnt lgkmcnt(0)
    s_mov_b32 s48, s4
    s_mov_b32 s49, s5
    s_mov_b32 s50, 1280
    s_mov_b32 s51, 0x20000
    v_lshlrev_b32 v5, 1, v56
    buffer_load_ushort v33, v5, s[48:51], 0 offen
    s_waitcnt vmcnt(0)
    v_lshlrev_b32 v33, 16, v33
    s_load_dwordx2 s[4:5], s[0:1], 112
    s_waitcnt lgkmcnt(0)
    s_mov_b32 s48, s4
    s_mov_b32 s49, s5
    s_mov_b32 s50, 1280
    s_mov_b32 s51, 0x20000
    v_lshlrev_b32 v5, 1, v56
    buffer_load_ushort v44, v5, s[48:51], 0 offen
    s_waitcnt vmcnt(0)
    v_lshlrev_b32 v44, 16, v44
    v_mul_f32 v44, 0x3fb8aa3b, v44
    v_exp_f32 v44, v44
    s_nop 0
    v_cvt_pk_bf16_f32 v44, v44, v44
    v_lshlrev_b32 v44, 16, v44
    v_mul_f32 v45, v44, v32
    v_mul_f32 v46, v44, v33
    v_mul_f32 v45, 0x3fb8aa3b, v45
    v_exp_f32 v45, v45
    v_mul_f32 v46, 0.15915494, v46
    v_fract_f32 v47, v46
    v_cos_f32 v34, v47
    v_sin_f32 v35, v47
    s_nop 0
    v_mul_f32 v34, v34, v45
    v_mul_f32 v35, v35, v45
    v_add_f32 v44, -1.0, v34
    v_mul_f32 v45, v32, v32
    v_fma_f32 v45, v33, v33, v45
    v_rcp_f32 v45, v45
    v_mul_f32 v46, v44, v32
    v_fma_f32 v46, v35, v33, v46
    v_mul_f32 v47, v35, v32
    v_fma_f32 v47, -v44, v33, v47
    v_mov_b32 v32, v34
    v_mov_b32 v33, v35
    v_add_f32 v45, v45, v45
    v_mul_f32 v34, v46, v45
    v_mul_f32 v35, v47, v45
    v_mov_b32 v36, v32
    v_mov_b32 v37, v33
    v_mul_f32 v44, v36, v36
    v_mul_f32 v45, v36, v37
    v_fma_f32 v44, -v37, v37, v44
    v_fma_f32 v37, v37, v36, v45
    v_mov_b32 v36, v44
    v_mul_f32 v44, v36, v36
    v_mul_f32 v45, v36, v37
    v_fma_f32 v44, -v37, v37, v44
    v_fma_f32 v37, v37, v36, v45
    v_mov_b32 v36, v44
    v_mul_f32 v44, v36, v36
    v_mul_f32 v45, v36, v37
    v_fma_f32 v44, -v37, v37, v44
    v_fma_f32 v37, v37, v36, v45
    v_mov_b32 v36, v44
    v_mul_f32 v44, v36, v36
    v_mul_f32 v45, v36, v37
    v_fma_f32 v44, -v37, v37, v44
    v_fma_f32 v37, v37, v36, v45
    v_mov_b32 v36, v44
    v_mul_f32 v44, v36, v36
    v_mul_f32 v45, v36, v37
    v_fma_f32 v44, -v37, v37, v44
    v_fma_f32 v37, v37, v36, v45
    v_mov_b32 v36, v44
    v_mov_b32 v38, v36
    v_mov_b32 v39, v37
    v_mul_f32 v44, v38, v38
    v_mul_f32 v45, v38, v39
    v_fma_f32 v44, -v39, v39, v44
    v_fma_f32 v39, v39, v38, v45
    v_mov_b32 v38, v44
    v_mul_f32 v44, v38, v38
    v_mul_f32 v45, v38, v39
    v_fma_f32 v44, -v39, v39, v44
    v_fma_f32 v39, v39, v38, v45
    v_mov_b32 v38, v44
    s_lshl_b32 s33, s24, 12
    s_add_u32 m0, s33, 0
    s_nop 0
    buffer_load_dwordx4 v12, s[12:15], s30 offen lds
    s_add_u32 m0, s33, 1024
    s_nop 0
    buffer_load_dwordx4 v13, s[12:15], s30 offen lds
    s_add_u32 m0, s33, 2048
    s_nop 0
    buffer_load_dwordx4 v14, s[12:15], s30 offen lds
    s_add_u32 m0, s33, 3072
    s_nop 0
    buffer_load_dwordx4 v15, s[12:15], s30 offen lds
    s_add_u32 m0, s33, 16384
    s_nop 0
    buffer_load_dwordx4 v16, s[16:19], s31 offen lds
    s_add_u32 m0, s33, 17408
    s_nop 0
    buffer_load_dwordx4 v17, s[16:19], s31 offen lds
    s_add_u32 m0, s33, 18432
    s_nop 0
    buffer_load_dwordx4 v18, s[16:19], s31 offen lds
    s_add_u32 m0, s33, 19456
    s_nop 0
    buffer_load_dwordx4 v19, s[16:19], s31 offen lds
    s_add_u32 s30, s30, s52
    s_add_u32 s31, s31, s53
    s_add_u32 s33, s33, 32768
    s_add_u32 m0, s33, 0
    s_nop 0
    buffer_load_dwordx4 v12, s[12:15], s30 offen lds
    s_add_u32 m0, s33, 1024
    s_nop 0
    buffer_load_dwordx4 v13, s[12:15], s30 offen lds
    s_add_u32 m0, s33, 2048
    s_nop 0
    buffer_load_dwordx4 v14, s[12:15], s30 offen lds
    s_add_u32 m0, s33, 3072
    s_nop 0
    buffer_load_dwordx4 v15, s[12:15], s30 offen lds
    s_add_u32 m0, s33, 16384
    s_nop 0
    buffer_load_dwordx4 v16, s[16:19], s31 offen lds
    s_add_u32 m0, s33, 17408
    s_nop 0
    buffer_load_dwordx4 v17, s[16:19], s31 offen lds
    s_add_u32 m0, s33, 18432
    s_nop 0
    buffer_load_dwordx4 v18, s[16:19], s31 offen lds
    s_add_u32 m0, s33, 19456
    s_nop 0
    buffer_load_dwordx4 v19, s[16:19], s31 offen lds
    s_add_u32 s30, s30, s52
    s_add_u32 s31, s31, s53
    s_add_u32 s33, s33, 32768
    s_mov_b32 s32, 0
    v_mov_b32 v64, 0
    v_mov_b32 v65, 0
    v_mov_b32 v66, 0
    v_mov_b32 v67, 0
    v_mov_b32 v68, 0
    v_mov_b32 v69, 0
    v_mov_b32 v70, 0
    v_mov_b32 v71, 0
    v_mov_b32 v72, 0
    v_mov_b32 v73, 0
    v_mov_b32 v74, 0
    v_mov_b32 v75, 0
    v_mov_b32 v76, 0
    v_mov_b32 v77, 0
    v_mov_b32 v78, 0
    v_mov_b32 v79, 0
    v_mov_b32 v80, 0
    v_mov_b32 v81, 0
    v_mov_b32 v82, 0
    v_mov_b32 v83, 0
    v_mov_b32 v84, 0
    v_mov_b32 v85, 0
    v_mov_b32 v86, 0
    v_mov_b32 v87, 0
    v_mov_b32 v88, 0
    v_mov_b32 v89, 0
    v_mov_b32 v90, 0
    v_mov_b32 v91, 0
    v_mov_b32 v92, 0
    v_mov_b32 v93, 0
    v_mov_b32 v94, 0
    v_mov_b32 v95, 0
    v_mov_b32 v96, 0
    v_mov_b32 v97, 0
    v_mov_b32 v98, 0
    v_mov_b32 v99, 0
    v_mov_b32 v100, 0
    v_mov_b32 v101, 0
    v_mov_b32 v102, 0
    v_mov_b32 v103, 0
    v_mov_b32 v104, 0
    v_mov_b32 v105, 0
    v_mov_b32 v106, 0
    v_mov_b32 v107, 0
    v_mov_b32 v108, 0
    v_mov_b32 v109, 0
    v_mov_b32 v110, 0
    v_mov_b32 v111, 0
    v_mov_b32 v112, 0
    v_mov_b32 v113, 0
    v_mov_b32 v114, 0
    v_mov_b32 v115, 0
    v_mov_b32 v116, 0
    v_mov_b32 v117, 0
    v_mov_b32 v118, 0
    v_mov_b32 v119, 0
    v_mov_b32 v120, 0
    v_mov_b32 v121, 0
    v_mov_b32 v122, 0
    v_mov_b32 v123, 0
    v_mov_b32 v124, 0
    v_mov_b32 v125, 0
    v_mov_b32 v126, 0
    v_mov_b32 v127, 0
    s_mov_b32 s34, 0
L_gemm_G1_62:
    s_cmp_ge_u32 s34, 9
    s_cbranch_scc1 L_gw_63_last
    s_waitcnt vmcnt(8)
    s_branch L_gw_63
L_gw_63_last:
    s_waitcnt vmcnt(0)
L_gw_63:
    s_barrier
    v_add_u32 v26, s32, v20
    v_add_u32 v27, s32, v21
    v_add_u32 v28, s32, v22
    v_add_u32 v29, s32, v23
    ds_read_b128 v[160:163], v28 offset:0
    ds_read_b128 v[128:131], v26 offset:0
    ds_read_b128 v[164:167], v28 offset:8192
    ds_read_b128 v[132:135], v26 offset:512
    ds_read_b128 v[136:139], v26 offset:1024
    ds_read_b128 v[140:143], v26 offset:1536
    ds_read_b128 v[144:147], v26 offset:2048
    ds_read_b128 v[148:151], v26 offset:2560
    ds_read_b128 v[152:155], v26 offset:3072
    ds_read_b128 v[156:159], v26 offset:3584
    s_cmp_ge_u32 s34, 8
    s_cbranch_scc1 L_gd_64
    s_add_u32 m0, s33, 0
    s_nop 0
    buffer_load_dwordx4 v12, s[12:15], s30 offen lds
    s_add_u32 m0, s33, 1024
    s_nop 0
    buffer_load_dwordx4 v13, s[12:15], s30 offen lds
    s_add_u32 m0, s33, 2048
    s_nop 0
    buffer_load_dwordx4 v14, s[12:15], s30 offen lds
    s_add_u32 m0, s33, 3072
    s_nop 0
    buffer_load_dwordx4 v15, s[12:15], s30 offen lds
    s_add_u32 m0, s33, 16384
    s_nop 0
    buffer_load_dwordx4 v16, s[16:19], s31 offen lds
    s_add_u32 m0, s33, 17408
    s_nop 0
    buffer_load_dwordx4 v17, s[16:19], s31 offen lds
    s_add_u32 m0, s33, 18432
    s_nop 0
    buffer_load_dwordx4 v18, s[16:19], s31 offen lds
    s_add_u32 m0, s33, 19456
    s_nop 0
    buffer_load_dwordx4 v19, s[16:19], s31 offen lds
    s_add_u32 s30, s30, s52
    s_add_u32 s31, s31, s53
    s_add_u32 s33, s33, 32768
    s_sub_u32 s26, s33, 98304
    s_cmp_ge_u32 s33, 98304
    s_cselect_b32 s33, s26, s33
L_gd_64:
    s_waitcnt lgkmcnt(0)
    v_mfma_f32_16x16x32_bf16 v[64:67], v[128:131], v[160:163], v[64:67]
    ds_read_b128 v[200:203], v29 offset:0
    v_mfma_f32_16x16x32_bf16 v[68:71], v[128:131], v[164:167], v[68:71]
    ds_read_b128 v[168:171], v27 offset:0
    v_mfma_f32_16x16x32_bf16 v[72:75], v[132:135], v[160:163], v[72:75]
    ds_read_b128 v[204:207], v29 offset:8192
    v_mfma_f32_16x16x32_bf16 v[76:79], v[132:135], v[164:167], v[76:79]
    ds_read_b128 v[172:175], v27 offset:512
    v_mfma_f32_16x16x32_bf16 v[80:83], v[136:139], v[160:163], v[80:83]
    ds_read_b128 v[176:179], v27 offset:1024
    v_mfma_f32_16x16x32_bf16 v[84:87], v[136:139], v[164:167], v[84:87]
    ds_read_b128 v[180:183], v27 offset:1536
    v_mfma_f32_16x16x32_bf16 v[88:91], v[140:143], v[160:163], v[88:91]
    ds_read_b128 v[184:187], v27 offset:2048
    v_mfma_f32_16x16x32_bf16 v[92:95], v[140:143], v[164:167], v[92:95]
    ds_read_b128 v[188:191], v27 offset:2560
    v_mfma_f32_16x16x32_bf16 v[96:99], v[144:147], v[160:163], v[96:99]
    ds_read_b128 v[192:195], v27 offset:3072
    v_mfma_f32_16x16x32_bf16 v[100:103], v[144:147], v[164:167], v[100:103]
    ds_read_b128 v[196:199], v27 offset:3584
    v_mfma_f32_16x16x32_bf16 v[104:107], v[148:151], v[160:163], v[104:107]
    v_mfma_f32_16x16x32_bf16 v[108:111], v[148:151], v[164:167], v[108:111]
    v_mfma_f32_16x16x32_bf16 v[112:115], v[152:155], v[160:163], v[112:115]
    v_mfma_f32_16x16x32_bf16 v[116:119], v[152:155], v[164:167], v[116:119]
    v_mfma_f32_16x16x32_bf16 v[120:123], v[156:159], v[160:163], v[120:123]
    v_mfma_f32_16x16x32_bf16 v[124:127], v[156:159], v[164:167], v[124:127]
    s_waitcnt lgkmcnt(0)
    v_mfma_f32_16x16x32_bf16 v[64:67], v[168:171], v[200:203], v[64:67]
    v_mfma_f32_16x16x32_bf16 v[68:71], v[168:171], v[204:207], v[68:71]
    v_mfma_f32_16x16x32_bf16 v[72:75], v[172:175], v[200:203], v[72:75]
    v_mfma_f32_16x16x32_bf16 v[76:79], v[172:175], v[204:207], v[76:79]
    v_mfma_f32_16x16x32_bf16 v[80:83], v[176:179], v[200:203], v[80:83]
    v_mfma_f32_16x16x32_bf16 v[84:87], v[176:179], v[204:207], v[84:87]
    v_mfma_f32_16x16x32_bf16 v[88:91], v[180:183], v[200:203], v[88:91]
    v_mfma_f32_16x16x32_bf16 v[92:95], v[180:183], v[204:207], v[92:95]
    v_mfma_f32_16x16x32_bf16 v[96:99], v[184:187], v[200:203], v[96:99]
    v_mfma_f32_16x16x32_bf16 v[100:103], v[184:187], v[204:207], v[100:103]
    v_mfma_f32_16x16x32_bf16 v[104:107], v[188:191], v[200:203], v[104:107]
    v_mfma_f32_16x16x32_bf16 v[108:111], v[188:191], v[204:207], v[108:111]
    v_mfma_f32_16x16x32_bf16 v[112:115], v[192:195], v[200:203], v[112:115]
    v_mfma_f32_16x16x32_bf16 v[116:119], v[192:195], v[204:207], v[116:119]
    v_mfma_f32_16x16x32_bf16 v[120:123], v[196:199], v[200:203], v[120:123]
    v_mfma_f32_16x16x32_bf16 v[124:127], v[196:199], v[204:207], v[124:127]
    s_add_u32 s32, s32, 32768
    s_cmp_ge_u32 s32, 98304
    s_cselect_b32 s32, 0, s32
    s_add_u32 s34, s34, 1
    s_cmp_lt_u32 s34, 10
    s_cbranch_scc1 L_gemm_G1_62
    s_nop 7
    s_barrier
    v_mov_b32 v58, 0
    v_mov_b32 v59, 0
    v_fma_f32 v44, v32, v58, v64
    v_fma_f32 v45, v32, v59, v68
    v_fma_f32 v44, -v33, v59, v44
    v_fma_f32 v59, v33, v58, v45
    v_mov_b32 v58, v44
    v_fma_f32 v44, v32, v58, v65
    v_fma_f32 v45, v32, v59, v69
    v_fma_f32 v44, -v33, v59, v44
    v_fma_f32 v59, v33, v58, v45
    v_mov_b32 v58, v44
    v_fma_f32 v44, v32, v58, v66
    v_fma_f32 v45, v32, v59, v70
    v_fma_f32 v44, -v33, v59, v44
    v_fma_f32 v59, v33, v58, v45
    v_mov_b32 v58, v44
    v_fma_f32 v44, v32, v58, v67
    v_fma_f32 v45, v32, v59, v71
    v_fma_f32 v44, -v33, v59, v44
    v_fma_f32 v59, v33, v58, v45
    v_mov_b32 v58, v44
    v_fma_f32 v44, v32, v58, v72
    v_fma_f32 v45, v32, v59, v76
    v_fma_f32 v44, -v33, v59, v44
    v_fma_f32 v59, v33, v58, v45
    v_mov_b32 v58, v44
    v_fma_f32 v44, v32, v58, v73
    v_fma_f32 v45, v32, v59, v77
    v_fma_f32 v44, -v33, v59, v44
    v_fma_f32 v59, v33, v58, v45
    v_mov_b32 v58, v44
    v_fma_f32 v44, v32, v58, v74
    v_fma_f32 v45, v32, v59, v78
    v_fma_f32 v44, -v33, v59, v44
    v_fma_f32 v59, v33, v58, v45
    v_mov_b32 v58, v44
    v_fma_f32 v44, v32, v58, v75
    v_fma_f32 v45, v32, v59, v79
    v_fma_f32 v44, -v33, v59, v44
    v_fma_f32 v59, v33, v58, v45
    v_mov_b32 v58, v44
    v_fma_f32 v44, v32, v58, v80
    v_fma_f32 v45, v32, v59, v84
    v_fma_f32 v44, -v33, v59, v44
    v_fma_f32 v59, v33, v58, v45
    v_mov_b32 v58, v44
    v_fma_f32 v44, v32, v58, v81
    v_fma_f32 v45, v32, v59, v85
    v_fma_f32 v44, -v33, v59, v44
    v_fma_f32 v59, v33, v58, v45
    v_mov_b32 v58, v44
    v_fma_f32 v44, v32, v58, v82
    v_fma_f32 v45, v32, v59, v86
    v_fma_f32 v44, -v33, v59, v44
    v_fma_f32 v59, v33, v58, v45
    v_mov_b32 v58, v44
    v_fma_f32 v44, v32, v58, v83
    v_fma_f32 v45, v32, v59, v87
    v_fma_f32 v44, -v33, v59, v44
    v_fma_f32 v59, v33, v58, v45
    v_mov_b32 v58, v44
    v_fma_f32 v44, v32, v58, v88
    v_fma_f32 v45, v32, v59, v92
    v_fma_f32 v44, -v33, v59, v44
    v_fma_f32 v59, v33, v58, v45
    v_mov_b32 v58, v44
    v_fma_f32 v44, v32, v58, v89
    v_fma_f32 v45, v32, v59, v93
    v_fma_f32 v44, -v33, v59, v44
    v_fma_f32 v59, v33, v58, v45
    v_mov_b32 v58, v44
    v_fma_f32 v44, v32, v58, v90
    v_fma_f32 v45, v32, v59, v94
    v_fma_f32 v44, -v33, v59, v44
    v_fma_f32 v59, v33, v58, v45
    v_mov_b32 v58, v44
    v_fma_f32 v44, v32, v58, v91
    v_fma_f32 v45, v32, v59, v95
    v_fma_f32 v44, -v33, v59, v44
    v_fma_f32 v59, v33, v58, v45
    v_mov_b32 v58, v44
    v_fma_f32 v44, v32, v58, v96
    v_fma_f32 v45, v32, v59, v100
    v_fma_f32 v44, -v33, v59, v44
    v_fma_f32 v59, v33, v58, v45
    v_mov_b32 v58, v44
    v_fma_f32 v44, v32, v58, v97
    v_fma_f32 v45, v32, v59, v101
    v_fma_f32 v44, -v33, v59, v44
    v_fma_f32 v59, v33, v58, v45
    v_mov_b32 v58, v44
    v_fma_f32 v44, v32, v58, v98
    v_fma_f32 v45, v32, v59, v102
    v_fma_f32 v44, -v33, v59, v44
    v_fma_f32 v59, v33, v58, v45
    v_mov_b32 v58, v44
    v_fma_f32 v44, v32, v58, v99
    v_fma_f32 v45, v32, v59, v103
    v_fma_f32 v44, -v33, v59, v44
    v_fma_f32 v59, v33, v58, v45
    v_mov_b32 v58, v44
    v_fma_f32 v44, v32, v58, v104
    v_fma_f32 v45, v32, v59, v108
    v_fma_f32 v44, -v33, v59, v44
    v_fma_f32 v59, v33, v58, v45
    v_mov_b32 v58, v44
    v_fma_f32 v44, v32, v58, v105
    v_fma_f32 v45, v32, v59, v109
    v_fma_f32 v44, -v33, v59, v44
    v_fma_f32 v59, v33, v58, v45
    v_mov_b32 v58, v44
    v_fma_f32 v44, v32, v58, v106
    v_fma_f32 v45, v32, v59, v110
    v_fma_f32 v44, -v33, v59, v44
    v_fma_f32 v59, v33, v58, v45
    v_mov_b32 v58, v44
    v_fma_f32 v44, v32, v58, v107
    v_fma_f32 v45, v32, v59, v111
    v_fma_f32 v44, -v33, v59, v44
    v_fma_f32 v59, v33, v58, v45
    v_mov_b32 v58, v44
    v_fma_f32 v44, v32, v58, v112
    v_fma_f32 v45, v32, v59, v116
    v_fma_f32 v44, -v33, v59, v44
    v_fma_f32 v59, v33, v58, v45
    v_mov_b32 v58, v44
    v_fma_f32 v44, v32, v58, v113
    v_fma_f32 v45, v32, v59, v117
    v_fma_f32 v44, -v33, v59, v44
    v_fma_f32 v59, v33, v58, v45
    v_mov_b32 v58, v44
    v_fma_f32 v44, v32, v58, v114
    v_fma_f32 v45, v32, v59, v118
    v_fma_f32 v44, -v33, v59, v44
    v_fma_f32 v59, v33, v58, v45
    v_mov_b32 v58, v44
    v_fma_f32 v44, v32, v58, v115
    v_fma_f32 v45, v32, v59, v119
    v_fma_f32 v44, -v33, v59, v44
    v_fma_f32 v59, v33, v58, v45
    v_mov_b32 v58, v44
    v_fma_f32 v44, v32, v58, v120
    v_fma_f32 v45, v32, v59, v124
    v_fma_f32 v44, -v33, v59, v44
    v_fma_f32 v59, v33, v58, v45
    v_mov_b32 v58, v44
    v_fma_f32 v44, v32, v58, v121
    v_fma_f32 v45, v32, v59, v125
    v_fma_f32 v44, -v33, v59, v44
    v_fma_f32 v59, v33, v58, v45
    v_mov_b32 v58, v44
    v_fma_f32 v44, v32, v58, v122
    v_fma_f32 v45, v32, v59, v126
    v_fma_f32 v44, -v33, v59, v44
    v_fma_f32 v59, v33, v58, v45
    v_mov_b32 v58, v44
    v_fma_f32 v44, v32, v58, v123
    v_fma_f32 v45, v32, v59, v127
    v_fma_f32 v44, -v33, v59, v44
    v_fma_f32 v59, v33, v58, v45
    v_mov_b32 v58, v44
    v_lshlrev_b32 v5, 2, v2
    v_add_u32 v5, 0, v5
    ds_bpermute_b32 v48, v5, v58
    ds_bpermute_b32 v49, v5, v59
    v_lshlrev_b32 v5, 2, v2
    v_add_u32 v5, 64, v5
    ds_bpermute_b32 v50, v5, v58
    ds_bpermute_b32 v51, v5, v59
    v_lshlrev_b32 v5, 2, v2
    v_add_u32 v5, 128, v5
    ds_bpermute_b32 v52, v5, v58
    ds_bpermute_b32 v53, v5, v59
    v_lshlrev_b32 v5, 2, v2
    v_add_u32 v5, 192, v5
    ds_bpermute_b32 v54, v5, v58
    ds_bpermute_b32 v55, v5, v59
    s_waitcnt lgkmcnt(0)
    v_mov_b32 v40, v48
    v_mov_b32 v41, v49
    v_mul_f32 v44, v40, v36
    v_mul_f32 v45, v40, v37
    v_fma_f32 v44, -v41, v37, v44
    v_fma_f32 v41, v41, v36, v45
    v_mov_b32 v40, v44
    v_add_f32 v40, v40, v50
    v_add_f32 v41, v41, v51
    v_mul_f32 v44, v40, v36
    v_mul_f32 v45, v40, v37
    v_fma_f32 v44, -v41, v37, v44
    v_fma_f32 v41, v41, v36, v45
    v_mov_b32 v40, v44
    v_add_f32 v40, v40, v52
    v_add_f32 v41, v41, v53
    v_mul_f32 v44, v40, v36
    v_mul_f32 v45, v40, v37
    v_fma_f32 v44, -v41, v37, v44
    v_fma_f32 v41, v41, v36, v45
    v_mov_b32 v40, v44
    v_add_f32 v40, v40, v54
    v_add_f32 v41, v41, v55
    s_mul_i32 s26, s36, 5120
    s_add_u32 s26, s26, 92274688
    v_lshlrev_b32 v5, 3, v56
    s_mov_b64 exec, 0xffff
    buffer_store_dwordx2 v[40:41], v5, s[8:11], s26 offen sc1
    s_mov_b64 exec, -1
    s_mul_i32 s26, s36, 10
    s_add_u32 s26, s26, s37
    s_lshl_b32 s26, s26, 2
    s_add_u32 s39, s26, 102768640
    s_cmp_eq_u32 s58, 1
    s_cbranch_scc1 L_zok_65
    v_mov_b32 v10, 40
L_wsp_66:
    buffer_load_dword v11, v10, s[20:23], 0 offen sc1
    s_waitcnt vmcnt(0)
    v_readfirstlane_b32 s29, v11
    s_cmp_ge_u32 s29, 256
    s_cbranch_scc1 L_wsp_66_ok
    s_sleep 2
    s_sub_u32 s38, s38, 1
    s_cbranch_scc0 L_wsp_66
    s_branch L_w_abort
L_wsp_66_ok:
    s_mov_b32 s58, 1
L_zok_65:
    s_waitcnt vmcnt(0)
    s_barrier
    s_cmp_lg_u32 s24, 0
    s_cbranch_scc1 L_sig_67
    v_mov_b32 v5, s39
    v_mov_b32 v6, 1
    s_mov_b64 exec, 1
    buffer_atomic_add v6, v5, s[8:11], 0 offen sc1
    s_mov_b64 exec, -1
L_sig_67:
    v_mov_b32 v42, 0
    v_mov_b32 v43, 0
    s_mov_b32 s40, 0
L_lb_68:
    s_cmp_ge_u32 s40, s36
    s_cbranch_scc1 L_lbe_69
    s_mul_i32 s26, s40, 10
    s_add_u32 s26, s26, s37
    s_lshl_b32 s26, s26, 2
    s_add_u32 s26, s26, 102768640
    v_mov_b32 v6, s26
L_wsp_70:
    buffer_load_dword v11, v6, s[8:11], 0 offen sc1
    s_waitcnt vmcnt(0)
    v_readfirstlane_b32 s29, v11
    s_cmp_ge_u32 s29, 1
    s_cbranch_scc1 L_wsp_70_ok
    s_sleep 2
    s_sub_u32 s38, s38, 1
    s_cbranch_scc0 L_wsp_70
    s_branch L_w_abort
L_wsp_70_ok:
    s_mul_i32 s26, s40, 5120
    s_add_u32 s26, s26, 92274688
    v_lshlrev_b32 v5, 3, v56
    buffer_load_dwordx2 v[40:41], v5, s[8:11], s26 offen sc1
    v_mul_f32 v44, v42, v38
    v_mul_f32 v45, v42, v39
    v_fma_f32 v44, -v43, v39, v44
    v_fma_f32 v43, v43, v38, v45
    v_mov_b32 v42, v44
    s_waitcnt vmcnt(0)
    v_add_f32 v42, v42, v40
    v_add_f32 v43, v43, v41
    s_add_u32 s40, s40, 1
    s_branch L_lb_68
L_lbe_69:
    v_mov_b32 v58, v42
    v_mov_b32 v59, v43
    v_mul_f32 v44, v42, v36
    v_mul_f32 v45, v42, v37
    v_fma_f32 v44, -v43, v37, v44
    v_fma_f32 v43, v43, v36, v45
    v_mov_b32 v42, v44
    v_add_f32 v42, v42, v48
    v_add_f32 v43, v43, v49
    v_cmp_eq_u32 vcc, 1, v3
    s_nop 1
    v_cndmask_b32 v58, v58, v42, vcc
    v_cndmask_b32 v59, v59, v43, vcc
    v_mul_f32 v44, v42, v36
    v_mul_f32 v45, v42, v37
    v_fma_f32 v44, -v43, v37, v44
    v_fma_f32 v43, v43, v36, v45
    v_mov_b32 v42, v44
    v_add_f32 v42, v42, v50
    v_add_f32 v43, v43, v51
    v_cmp_eq_u32 vcc, 2, v3
    s_nop 1
    v_cndmask_b32 v58, v58, v42, vcc
    v_cndmask_b32 v59, v59, v43, vcc
    v_mul_f32 v44, v42, v36
    v_mul_f32 v45, v42, v37
    v_fma_f32 v44, -v43, v37, v44
    v_fma_f32 v43, v43, v36, v45
    v_mov_b32 v42, v44
    v_add_f32 v42, v42, v52
    v_add_f32 v43, v43, v53
    v_cmp_eq_u32 vcc, 3, v3
    s_nop 1
    v_cndmask_b32 v58, v58, v42, vcc
    v_cndmask_b32 v59, v59, v43, vcc
    v_fma_f32 v44, v32, v58, v64
    v_fma_f32 v45, v32, v59, v68
    v_fma_f32 v44, -v33, v59, v44
    v_fma_f32 v59, v33, v58, v45
    v_mov_b32 v58, v44
    v_mul_f32 v64, v34, v58
    v_mul_f32 v68, v34, v59
    v_fma_f32 v64, -v35, v59, v64
    v_fma_f32 v68, v35, v58, v68
    v_sub_f32 v68, 0, v68
    v_fma_f32 v44, v32, v58, v65
    v_fma_f32 v45, v32, v59, v69
    v_fma_f32 v44, -v33, v59, v44
    v_fma_f32 v59, v33, v58, v45
    v_mov_b32 v58, v44
    v_mul_f32 v65, v34, v58
    v_mul_f32 v69, v34, v59
    v_fma_f32 v65, -v35, v59, v65
    v_fma_f32 v69, v35, v58, v69
    v_sub_f32 v69, 0, v69
    v_fma_f32 v44, v32, v58, v66
    v_fma_f32 v45, v32, v59, v70
    v_fma_f32 v44, -v33, v59, v44
    v_fma_f32 v59, v33, v58, v45
    v_mov_b32 v58, v44
    v_mul_f32 v66, v34, v58
    v_mul_f32 v70, v34, v59
    v_fma_f32 v66, -v35, v59, v66
    v_fma_f32 v70, v35, v58, v70
    v_sub_f32 v70, 0, v70
    v_fma_f32 v44, v32, v58, v67
    v_fma_f32 v45, v32, v59, v71
    v_fma_f32 v44, -v33, v59, v44
    v_fma_f32 v59, v33, v58, v45
    v_mov_b32 v58, v44
    v_mul_f32 v67, v34, v58
    v_mul_f32 v71, v34, v59
    v_fma_f32 v67, -v35, v59, v67
    v_fma_f32 v71, v35, v58, v71
    v_sub_f32 v71, 0, v71
    v_fma_f32 v44, v32, v58, v72
    v_fma_f32 v45, v32, v59, v76
    v_fma_f32 v44, -v33, v59, v44
    v_fma_f32 v59, v33, v58, v45
    v_mov_b32 v58, v44
    v_mul_f32 v72, v34, v58
    v_mul_f32 v76, v34, v59
    v_fma_f32 v72, -v35, v59, v72
    v_fma_f32 v76, v35, v58, v76
    v_sub_f32 v76, 0, v76
    v_fma_f32 v44, v32, v58, v73
    v_fma_f32 v45, v32, v59, v77
    v_fma_f32 v44, -v33, v59, v44
    v_fma_f32 v59, v33, v58, v45
    v_mov_b32 v58, v44
    v_mul_f32 v73, v34, v58
    v_mul_f32 v77, v34, v59
    v_fma_f32 v73, -v35, v59, v73
    v_fma_f32 v77, v35, v58, v77
    v_sub_f32 v77, 0, v77
    v_fma_f32 v44, v32, v58, v74
    v_fma_f32 v45, v32, v59, v78
    v_fma_f32 v44, -v33, v59, v44
    v_fma_f32 v59, v33, v58, v45
    v_mov_b32 v58, v44
    v_mul_f32 v74, v34, v58
    v_mul_f32 v78, v34, v59
    v_fma_f32 v74, -v35, v59, v74
    v_fma_f32 v78, v35, v58, v78
    v_sub_f32 v78, 0, v78
    v_fma_f32 v44, v32, v58, v75
    v_fma_f32 v45, v32, v59, v79
    v_fma_f32 v44, -v33, v59, v44
    v_fma_f32 v59, v33, v58, v45
    v_mov_b32 v58, v44
    v_mul_f32 v75, v34, v58
    v_mul_f32 v79, v34, v59
    v_fma_f32 v75, -v35, v59, v75
    v_fma_f32 v79, v35, v58, v79
    v_sub_f32 v79, 0, v79
    v_fma_f32 v44, v32, v58, v80
    v_fma_f32 v45, v32, v59, v84
    v_fma_f32 v44, -v33, v59, v44
    v_fma_f32 v59, v33, v58, v45
    v_mov_b32 v58, v44
    v_mul_f32 v80, v34, v58
    v_mul_f32 v84, v34, v59
    v_fma_f32 v80, -v35, v59, v80
    v_fma_f32 v84, v35, v58, v84
    v_sub_f32 v84, 0, v84
    v_fma_f32 v44, v32, v58, v81
    v_fma_f32 v45, v32, v59, v85
    v_fma_f32 v44, -v33, v59, v44
    v_fma_f32 v59, v33, v58, v45
    v_mov_b32 v58, v44
    v_mul_f32 v81, v34, v58
    v_mul_f32 v85, v34, v59
    v_fma_f32 v81, -v35, v59, v81
    v_fma_f32 v85, v35, v58, v85
    v_sub_f32 v85, 0, v85
    v_fma_f32 v44, v32, v58, v82
    v_fma_f32 v45, v32, v59, v86
    v_fma_f32 v44, -v33, v59, v44
    v_fma_f32 v59, v33, v58, v45
    v_mov_b32 v58, v44
    v_mul_f32 v82, v34, v58
    v_mul_f32 v86, v34, v59
    v_fma_f32 v82, -v35, v59, v82
    v_fma_f32 v86, v35, v58, v86
    v_sub_f32 v86, 0, v86
    v_fma_f32 v44, v32, v58, v83
    v_fma_f32 v45, v32, v59, v87
    v_fma_f32 v44, -v33, v59, v44
    v_fma_f32 v59, v33, v58, v45
    v_mov_b32 v58, v44
    v_mul_f32 v83, v34, v58
    v_mul_f32 v87, v34, v59
    v_fma_f32 v83, -v35, v59, v83
    v_fma_f32 v87, v35, v58, v87
    v_sub_f32 v87, 0, v87
    v_fma_f32 v44, v32, v58, v88
    v_fma_f32 v45, v32, v59, v92
    v_fma_f32 v44, -v33, v59, v44
    v_fma_f32 v59, v33, v58, v45
    v_mov_b32 v58, v44
    v_mul_f32 v88, v34, v58
    v_mul_f32 v92, v34, v59
    v_fma_f32 v88, -v35, v59, v88
    v_fma_f32 v92, v35, v58, v92
    v_sub_f32 v92, 0, v92
    v_fma_f32 v44, v32, v58, v89
    v_fma_f32 v45, v32, v59, v93
    v_fma_f32 v44, -v33, v59, v44
    v_fma_f32 v59, v33, v58, v45
    v_mov_b32 v58, v44
    v_mul_f32 v89, v34, v58
    v_mul_f32 v93, v34, v59
    v_fma_f32 v89, -v35, v59, v89
    v_fma_f32 v93, v35, v58, v93
    v_sub_f32 v93, 0, v93
    v_fma_f32 v44, v32, v58, v90
    v_fma_f32 v45, v32, v59, v94
    v_fma_f32 v44, -v33, v59, v44
    v_fma_f32 v59, v33, v58, v45
    v_mov_b32 v58, v44
    v_mul_f32 v90, v34, v58
    v_mul_f32 v94, v34, v59
    v_fma_f32 v90, -v35, v59, v90
    v_fma_f32 v94, v35, v58, v94
    v_sub_f32 v94, 0, v94
    v_fma_f32 v44, v32, v58, v91
    v_fma_f32 v45, v32, v59, v95
    v_fma_f32 v44, -v33, v59, v44
    v_fma_f32 v59, v33, v58, v45
    v_mov_b32 v58, v44
    v_mul_f32 v91, v34, v58
    v_mul_f32 v95, v34, v59
    v_fma_f32 v91, -v35, v59, v91
    v_fma_f32 v95, v35, v58, v95
    v_sub_f32 v95, 0, v95
    v_fma_f32 v44, v32, v58, v96
    v_fma_f32 v45, v32, v59, v100
    v_fma_f32 v44, -v33, v59, v44
    v_fma_f32 v59, v33, v58, v45
    v_mov_b32 v58, v44
    v_mul_f32 v96, v34, v58
    v_mul_f32 v100, v34, v59
    v_fma_f32 v96, -v35, v59, v96
    v_fma_f32 v100, v35, v58, v100
    v_sub_f32 v100, 0, v100
    v_fma_f32 v44, v32, v58, v97
    v_fma_f32 v45, v32, v59, v101
    v_fma_f32 v44, -v33, v59, v44
    v_fma_f32 v59, v33, v58, v45
    v_mov_b32 v58, v44
    v_mul_f32 v97, v34, v58
    v_mul_f32 v101, v34, v59
    v_fma_f32 v97, -v35, v59, v97
    v_fma_f32 v101, v35, v58, v101
    v_sub_f32 v101, 0, v101
    v_fma_f32 v44, v32, v58, v98
    v_fma_f32 v45, v32, v59, v102
    v_fma_f32 v44, -v33, v59, v44
    v_fma_f32 v59, v33, v58, v45
    v_mov_b32 v58, v44
    v_mul_f32 v98, v34, v58
    v_mul_f32 v102, v34, v59
    v_fma_f32 v98, -v35, v59, v98
    v_fma_f32 v102, v35, v58, v102
    v_sub_f32 v102, 0, v102
    v_fma_f32 v44, v32, v58, v99
    v_fma_f32 v45, v32, v59, v103
    v_fma_f32 v44, -v33, v59, v44
    v_fma_f32 v59, v33, v58, v45
    v_mov_b32 v58, v44
    v_mul_f32 v99, v34, v58
    v_mul_f32 v103, v34, v59
    v_fma_f32 v99, -v35, v59, v99
    v_fma_f32 v103, v35, v58, v103
    v_sub_f32 v103, 0, v103
    v_fma_f32 v44, v32, v58, v104
    v_fma_f32 v45, v32, v59, v108
    v_fma_f32 v44, -v33, v59, v44
    v_fma_f32 v59, v33, v58, v45
    v_mov_b32 v58, v44
    v_mul_f32 v104, v34, v58
    v_mul_f32 v108, v34, v59
    v_fma_f32 v104, -v35, v59, v104
    v_fma_f32 v108, v35, v58, v108
    v_sub_f32 v108, 0, v108
    v_fma_f32 v44, v32, v58, v105
    v_fma_f32 v45, v32, v59, v109
    v_fma_f32 v44, -v33, v59, v44
    v_fma_f32 v59, v33, v58, v45
    v_mov_b32 v58, v44
    v_mul_f32 v105, v34, v58
    v_mul_f32 v109, v34, v59
    v_fma_f32 v105, -v35, v59, v105
    v_fma_f32 v109, v35, v58, v109
    v_sub_f32 v109, 0, v109
    v_fma_f32 v44, v32, v58, v106
    v_fma_f32 v45, v32, v59, v110
    v_fma_f32 v44, -v33, v59, v44
    v_fma_f32 v59, v33, v58, v45
    v_mov_b32 v58, v44
    v_mul_f32 v106, v34, v58
    v_mul_f32 v110, v34, v59
    v_fma_f32 v106, -v35, v59, v106
    v_fma_f32 v110, v35, v58, v110
    v_sub_f32 v110, 0, v110
    v_fma_f32 v44, v32, v58, v107
    v_fma_f32 v45, v32, v59, v111
    v_fma_f32 v44, -v33, v59, v44
    v_fma_f32 v59, v33, v58, v45
    v_mov_b32 v58, v44
    v_mul_f32 v107, v34, v58
    v_mul_f32 v111, v34, v59
    v_fma_f32 v107, -v35, v59, v107
    v_fma_f32 v111, v35, v58, v111
    v_sub_f32 v111, 0, v111
    v_fma_f32 v44, v32, v58, v112
    v_fma_f32 v45, v32, v59, v116
    v_fma_f32 v44, -v33, v59, v44
    v_fma_f32 v59, v33, v58, v45
    v_mov_b32 v58, v44
    v_mul_f32 v112, v34, v58
    v_mul_f32 v116, v34, v59
    v_fma_f32 v112, -v35, v59, v112
    v_fma_f32 v116, v35, v58, v116
    v_sub_f32 v116, 0, v116
    v_fma_f32 v44, v32, v58, v113
    v_fma_f32 v45, v32, v59, v117
    v_fma_f32 v44, -v33, v59, v44
    v_fma_f32 v59, v33, v58, v45
    v_mov_b32 v58, v44
    v_mul_f32 v113, v34, v58
    v_mul_f32 v117, v34, v59
    v_fma_f32 v113, -v35, v59, v113
    v_fma_f32 v117, v35, v58, v117
    v_sub_f32 v117, 0, v117
    v_fma_f32 v44, v32, v58, v114
    v_fma_f32 v45, v32, v59, v118
    v_fma_f32 v44, -v33, v59, v44
    v_fma_f32 v59, v33, v58, v45
    v_mov_b32 v58, v44
    v_mul_f32 v114, v34, v58
    v_mul_f32 v118, v34, v59
    v_fma_f32 v114, -v35, v59, v114
    v_fma_f32 v118, v35, v58, v118
    v_sub_f32 v118, 0, v118
    v_fma_f32 v44, v32, v58, v115
    v_fma_f32 v45, v32, v59, v119
    v_fma_f32 v44, -v33, v59, v44
    v_fma_f32 v59, v33, v58, v45
    v_mov_b32 v58, v44
    v_mul_f32 v115, v34, v58
    v_mul_f32 v119, v34, v59
    v_fma_f32 v115, -v35, v59, v115
    v_fma_f32 v119, v35, v58, v119
    v_sub_f32 v119, 0, v119
    v_fma_f32 v44, v32, v58, v120
    v_fma_f32 v45, v32, v59, v124
    v_fma_f32 v44, -v33, v59, v44
    v_fma_f32 v59, v33, v58, v45
    v_mov_b32 v58, v44
    v_mul_f32 v120, v34, v58
    v_mul_f32 v124, v34, v59
    v_fma_f32 v120, -v35, v59, v120
    v_fma_f32 v124, v35, v58, v124
    v_sub_f32 v124, 0, v124
    v_fma_f32 v44, v32, v58, v121
    v_fma_f32 v45, v32, v59, v125
    v_fma_f32 v44, -v33, v59, v44
    v_fma_f32 v59, v33, v58, v45
    v_mov_b32 v58, v44
    v_mul_f32 v121, v34, v58
    v_mul_f32 v125, v34, v59
    v_fma_f32 v121, -v35, v59, v121
    v_fma_f32 v125, v35, v58, v125
    v_sub_f32 v125, 0, v125
    v_fma_f32 v44, v32, v58, v122
    v_fma_f32 v45, v32, v59, v126
    v_fma_f32 v44, -v33, v59, v44
    v_fma_f32 v59, v33, v58, v45
    v_mov_b32 v58, v44
    v_mul_f32 v122, v34, v58
    v_mul_f32 v126, v34, v59
    v_fma_f32 v122, -v35, v59, v122
    v_fma_f32 v126, v35, v58, v126
    v_sub_f32 v126, 0, v126
    v_fma_f32 v44, v32, v58, v123
    v_fma_f32 v45, v32, v59, v127
    v_fma_f32 v44, -v33, v59, v44
    v_fma_f32 v59, v33, v58, v45
    v_mov_b32 v58, v44
    v_mul_f32 v123, v34, v58
    v_mul_f32 v127, v34, v59
    v_fma_f32 v123, -v35, v59, v123
    v_fma_f32 v127, v35, v58, v127
    v_sub_f32 v127, 0, v127
    s_lshl_b32 s26, s24, 4
    v_add_u32 v5, s26, v2
    v_mul_u32_u24 v5, 272, v5
    v_lshl_add_u32 v5, v3, 6, v5
    v_cvt_pk_bf16_f32 v128, v64, v65
    v_cvt_pk_bf16_f32 v129, v66, v67
    v_cvt_pk_bf16_f32 v130, v72, v73
    v_cvt_pk_bf16_f32 v131, v74, v75
    ds_write_b128 v5, v[128:131] offset:0
    v_cvt_pk_bf16_f32 v132, v80, v81
    v_cvt_pk_bf16_f32 v133, v82, v83
    v_cvt_pk_bf16_f32 v134, v88, v89
    v_cvt_pk_bf16_f32 v135, v90, v91
    ds_write_b128 v5, v[132:135] offset:16
    v_cvt_pk_bf16_f32 v136, v96, v97
    v_cvt_pk_bf16_f32 v137, v98, v99
    v_cvt_pk_bf16_f32 v138, v104, v105
    v_cvt_pk_bf16_f32 v139, v106, v107
    ds_write_b128 v5, v[136:139] offset:32
    v_cvt_pk_bf16_f32 v140, v112, v113
    v_cvt_pk_bf16_f32 v141, v114, v115
    v_cvt_pk_bf16_f32 v142, v120, v121
    v_cvt_pk_bf16_f32 v143, v122, v123
    ds_write_b128 v5, v[140:143] offset:48
    v_cvt_pk_bf16_f32 v144, v68, v69
    v_cvt_pk_bf16_f32 v145, v70, v71
    v_cvt_pk_bf16_f32 v146, v76, v77
    v_cvt_pk_bf16_f32 v147, v78, v79
    ds_write_b128 v5, v[144:147] offset:17408
    v_cvt_pk_bf16_f32 v148, v84, v85
    v_cvt_pk_bf16_f32 v149, v86, v87
    v_cvt_pk_bf16_f32 v150, v92, v93
    v_cvt_pk_bf16_f32 v151, v94, v95
    ds_write_b128 v5, v[148:151] offset:17424
    v_cvt_pk_bf16_f32 v152, v100, v101
    v_cvt_pk_bf16_f32 v153, v102, v103
    v_cvt_pk_bf16_f32 v154, v108, v109
    v_cvt_pk_bf16_f32 v155, v110, v111
    ds_write_b128 v5, v[152:155] offset:17440
    v_cvt_pk_bf16_f32 v156, v116, v117
    v_cvt_pk_bf16_f32 v157, v118, v119
    v_cvt_pk_bf16_f32 v158, v124, v125
    v_cvt_pk_bf16_f32 v159, v126, v127
    ds_write_b128 v5, v[156:159] offset:17456
    s_waitcnt lgkmcnt(0)
    s_barrier
    v_lshrrev_b32 v5, 2, v2
    v_lshl_add_u32 v5, v3, 3, v5
    v_mul_u32_u24 v5, 272, v5
    v_and_b32 v6, 3, v2
    v_lshl_add_u32 v5, v6, 3, v5
    s_lshl_b32 s26, s24, 6
    v_add_u32 v5, s26, v5
    s_lshl_b32 s26, s36, 3
    s_lshl_b32 s27, s24, 1
    s_add_u32 s26, s26, s27
    s_mul_i32 s26, s26, 40
    s_lshl_b32 s27, s37, 1
    s_add_u32 s26, s26, s27
    s_lshl_b32 s26, s26, 10
    s_add_u32 s26, s26, 83886080
    ds_read_b64_tr_b16 v[128:129], v5 offset:0
    ds_read_b64_tr_b16 v[130:131], v5 offset:1088
    s_waitcnt lgkmcnt(0)
    s_add_u32 s27, s26, 0
    buffer_store_dwordx4 v[128:131], v1, s[8:11], s27 offen sc1
    ds_read_b64_tr_b16 v[132:133], v5 offset:8704
    ds_read_b64_tr_b16 v[134:135], v5 offset:9792
    s_waitcnt lgkmcnt(0)
    s_add_u32 s27, s26, 1024
    buffer_store_dwordx4 v[132:135], v1, s[8:11], s27 offen sc1
    ds_read_b64_tr_b16 v[136:137], v5 offset:17408
    ds_read_b64_tr_b16 v[138:139], v5 offset:18496
    s_waitcnt lgkmcnt(0)
    s_add_u32 s27, s26, 20480
    buffer_store_dwordx4 v[136:139], v1, s[8:11], s27 offen sc1
    ds_read_b64_tr_b16 v[140:141], v5 offset:26112
    ds_read_b64_tr_b16 v[142:143], v5 offset:27200
    s_waitcnt lgkmcnt(0)
    s_add_u32 s27, s26, 21504
    buffer_store_dwordx4 v[140:143], v1, s[8:11], s27 offen sc1
    ds_read_b64_tr_b16 v[144:145], v5 offset:32
    ds_read_b64_tr_b16 v[146:147], v5 offset:1120
    s_waitcnt lgkmcnt(0)
    s_add_u32 s27, s26, 40960
    buffer_store_dwordx4 v[144:147], v1, s[8:11], s27 offen sc1
    ds_read_b64_tr_b16 v[148:149], v5 offset:8736
    ds_read_b64_tr_b16 v[150:151], v5 offset:9824
    s_waitcnt lgkmcnt(0)
    s_add_u32 s27, s26, 41984
    buffer_store_dwordx4 v[148:151], v1, s[8:11], s27 offen sc1
    ds_read_b64_tr_b16 v[152:153], v5 offset:17440
    ds_read_b64_tr_b16 v[154:155], v5 offset:18528
    s_waitcnt lgkmcnt(0)
    s_add_u32 s27, s26, 61440
    buffer_store_dwordx4 v[152:155], v1, s[8:11], s27 offen sc1
    ds_read_b64_tr_b16 v[156:157], v5 offset:26144
    ds_read_b64_tr_b16 v[158:159], v5 offset:27232
    s_waitcnt lgkmcnt(0)
    s_add_u32 s27, s26, 62464
    buffer_store_dwordx4 v[156:159], v1, s[8:11], s27 offen sc1
    s_lshl_b32 s26, s36, 2
    s_add_u32 s39, s26, 102769664
    s_cmp_eq_u32 s58, 1
    s_cbranch_scc1 L_zok_71
    v_mov_b32 v10, 40
L_wsp_72:
    buffer_load_dword v11, v10, s[20:23], 0 offen sc1
    s_waitcnt vmcnt(0)
    v_readfirstlane_b32 s29, v11
    s_cmp_ge_u32 s29, 256
    s_cbranch_scc1 L_wsp_72_ok
    s_sleep 2
    s_sub_u32 s38, s38, 1
    s_cbranch_scc0 L_wsp_72
    s_branch L_w_abort
L_wsp_72_ok:
    s_mov_b32 s58, 1
L_zok_71:
    s_waitcnt vmcnt(0)
    s_barrier
    s_cmp_lg_u32 s24, 0
    s_cbranch_scc1 L_sig_73
    v_mov_b32 v5, s39
    v_mov_b32 v6, 1
    s_mov_b64 exec, 1
    buffer_atomic_add v6, v5, s[8:11], 0 offen sc1
    s_mov_b64 exec, -1
L_sig_73:
    s_branch L_G1_next_59
L_G1_done_60:
    s_mov_b32 s61, 116
L_G2_next_74:
    s_mov_b32 s61, 116
    s_barrier
    s_cmp_lg_u32 s24, 0
    s_cbranch_scc1 L_fetch_76
    v_mov_b32 v5, s61
    v_mov_b32 v6, 1
    s_mov_b64 exec, 1
    buffer_atomic_add v6, v5, s[20:23], 0 offen sc0
    s_waitcnt vmcnt(0)
    v_mov_b32 v5, 163836
    ds_write_b32 v5, v6
    s_waitcnt lgkmcnt(0)
    s_mov_b64 exec, -1
L_fetch_76:
    s_barrier
    v_mov_b32 v5, 163836
    ds_read_b32 v6, v5
    s_waitcnt lgkmcnt(0)
    v_readfirstlane_b32 s25, v6
    s_cmp_ge_u32 s25, 80
    s_cbranch_scc1 L_G2_done_75
    s_mul_i32 s36, s25, 13108
    s_lshr_b32 s36, s36, 16
    s_mul_i32 s26, s36, 5
    s_sub_u32 s37, s25, s26
    s_cmp_eq_u32 s58, 1
    s_cbranch_scc1 L_zok_77
    v_mov_b32 v10, 40
L_wsp_78:
    buffer_load_dword v11, v10, s[20:23], 0 offen sc1
    s_waitcnt vmcnt(0)
    v_readfirstlane_b32 s29, v11
    s_cmp_ge_u32 s29, 256
    s_cbranch_scc1 L_wsp_78_ok
    s_sleep 2
    s_sub_u32 s38, s38, 1
    s_cbranch_scc0 L_wsp_78
    s_branch L_w_abort
L_wsp_78_ok:
    s_mov_b32 s58, 1
L_zok_77:
    s_lshl_b32 s26, s36, 2
    s_add_u32 s26, s26, 102769664
    v_mov_b32 v6, s26
L_wsp_79:
    buffer_load_dword v11, v6, s[8:11], 0 offen sc1
    s_waitcnt vmcnt(0)
    v_readfirstlane_b32 s29, v11
    s_cmp_ge_u32 s29, 10
    s_cbranch_scc1 L_wsp_79_ok
    s_sleep 8
    s_sub_u32 s38, s38, 1
    s_cbranch_scc0 L_wsp_79
    s_branch L_w_abort
L_wsp_79_ok:
    s_load_dwordx2 s[4:5], s[0:1], 96
    s_waitcnt lgkmcnt(0)
    s_mov_b32 s12, s4
    s_mov_b32 s13, s5
    s_mov_b32 s14, 819200
    s_mov_b32 s15, 0x20000
    s_mov_b32 s16, s8
    s_mov_b32 s17, s9
    s_mov_b32 s18, s10
    s_mov_b32 s19, 0x20000
    v_lshrrev_b32 v5, 3, v4
    v_and_b32 v6, 7, v4
    v_xor_b32 v6, v6, v5
    s_lshl_b32 s26, s24, 5
    v_add_u32 v5, s26, v5
    s_mov_b32 s26, 1280
    v_mul_lo_u32 v5, v5, s26
    v_lshl_add_u32 v12, v6, 4, v5
    v_add_u32 v13, 10240, v12
    v_add_u32 v14, 20480, v12
    v_add_u32 v15, 30720, v12
    v_mov_b32 v16, v1
    v_add_u32 v17, 1024, v1
    v_add_u32 v18, 40960, v1
    v_add_u32 v19, 41984, v1
    s_mul_i32 s30, s37, 163840
    s_mov_b32 s42, s30
    s_lshl_b32 s26, s36, 3
    s_lshl_b32 s27, s24, 1
    s_add_u32 s26, s26, s27
    s_mul_i32 s26, s26, 40960
    s_add_u32 s31, s26, 83886080
    s_mov_b32 s52, 128
    s_mov_b32 s53, 2048
    s_lshr_b32 s39, s24, 1
    s_and_b32 s40, s24, 1
    s_lshl_b32 s41, s39, 6
    v_add_u32 v5, s41, v2
    v_lshlrev_b32 v5, 7, v5
    v_and_b32 v6, 7, v2
    v_xor_b32 v6, v6, v3
    v_lshl_add_u32 v20, v6, 4, v5
    v_add_u32 v20, 0, v20
    v_xor_b32 v21, 64, v20
    s_lshl_b32 s26, s40, 13
    s_add_u32 s26, s26, 16384
    v_add_u32 v22, s26, v1
    s_lshl_b32 s33, s24, 12
    s_add_u32 m0, s33, 0
    s_nop 0
    buffer_load_dwordx4 v12, s[12:15], s30 offen lds
    s_add_u32 m0, s33, 1024
    s_nop 0
    buffer_load_dwordx4 v13, s[12:15], s30 offen lds
    s_add_u32 m0, s33, 2048
    s_nop 0
    buffer_load_dwordx4 v14, s[12:15], s30 offen lds
    s_add_u32 m0, s33, 3072
    s_nop 0
    buffer_load_dwordx4 v15, s[12:15], s30 offen lds
    s_add_u32 m0, s33, 16384
    s_nop 0
    buffer_load_dwordx4 v16, s[16:19], s31 offen sc1 lds
    s_add_u32 m0, s33, 17408
    s_nop 0
    buffer_load_dwordx4 v17, s[16:19], s31 offen sc1 lds
    s_add_u32 m0, s33, 18432
    s_nop 0
    buffer_load_dwordx4 v18, s[16:19], s31 offen sc1 lds
    s_add_u32 m0, s33, 19456
    s_nop 0
    buffer_load_dwordx4 v19, s[16:19], s31 offen sc1 lds
    s_add_u32 s30, s30, s52
    s_add_u32 s31, s31, s53
    s_add_u32 s33, s33, 32768
    s_add_u32 m0, s33, 0
    s_nop 0
    buffer_load_dwordx4 v12, s[12:15], s30 offen lds
    s_add_u32 m0, s33, 1024
    s_nop 0
    buffer_load_dwordx4 v13, s[12:15], s30 offen lds
    s_add_u32 m0, s33, 2048
    s_nop 0
    buffer_load_dwordx4 v14, s[12:15], s30 offen lds
    s_add_u32 m0, s33, 3072
    s_nop 0
    buffer_load_dwordx4 v15, s[12:15], s30 offen lds
    s_add_u32 m0, s33, 16384
    s_nop 0
    buffer_load_dwordx4 v16, s[16:19], s31 offen sc1 lds
    s_add_u32 m0, s33, 17408
    s_nop 0
    buffer_load_dwordx4 v17, s[16:19], s31 offen sc1 lds
    s_add_u32 m0, s33, 18432
    s_nop 0
    buffer_load_dwordx4 v18, s[16:19], s31 offen sc1 lds
    s_add_u32 m0, s33, 19456
    s_nop 0
    buffer_load_dwordx4 v19, s[16:19], s31 offen sc1 lds
    s_add_u32 s30, s30, s52
    s_add_u32 s31, s31, s53
    s_add_u32 s33, s33, 32768
    s_mov_b32 s32, 0
    v_mov_b32 v64, 0
    v_mov_b32 v65, 0
    v_mov_b32 v66, 0
    v_mov_b32 v67, 0
    v_mov_b32 v68, 0
    v_mov_b32 v69, 0
    v_mov_b32 v70, 0
    v_mov_b32 v71, 0
    v_mov_b32 v72, 0
    v_mov_b32 v73, 0
    v_mov_b32 v74, 0
    v_mov_b32 v75, 0
    v_mov_b32 v76, 0
    v_mov_b32 v77, 0
    v_mov_b32 v78, 0
    v_mov_b32 v79, 0
    v_mov_b32 v80, 0
    v_mov_b32 v81, 0
    v_mov_b32 v82, 0
    v_mov_b32 v83, 0
    v_mov_b32 v84, 0
    v_mov_b32 v85, 0
    v_mov_b32 v86, 0
    v_mov_b32 v87, 0
    v_mov_b32 v88, 0
    v_mov_b32 v89, 0
    v_mov_b32 v90, 0
    v_mov_b32 v91, 0
    v_mov_b32 v92, 0
    v_mov_b32 v93, 0
    v_mov_b32 v94, 0
    v_mov_b32 v95, 0
    v_mov_b32 v96, 0
    v_mov_b32 v97, 0
    v_mov_b32 v98, 0
    v_mov_b32 v99, 0
    v_mov_b32 v100, 0
    v_mov_b32 v101, 0
    v_mov_b32 v102, 0
    v_mov_b32 v103, 0
    v_mov_b32 v104, 0
    v_mov_b32 v105, 0
    v_mov_b32 v106, 0
    v_mov_b32 v107, 0
    v_mov_b32 v108, 0
    v_mov_b32 v109, 0
    v_mov_b32 v110, 0
    v_mov_b32 v111, 0
    v_mov_b32 v112, 0
    v_mov_b32 v113, 0
    v_mov_b32 v114, 0
    v_mov_b32 v115, 0
    v_mov_b32 v116, 0
    v_mov_b32 v117, 0
    v_mov_b32 v118, 0
    v_mov_b32 v119, 0
    v_mov_b32 v120, 0
    v_mov_b32 v121, 0
    v_mov_b32 v122, 0
    v_mov_b32 v123, 0
    v_mov_b32 v124, 0
    v_mov_b32 v125, 0
    v_mov_b32 v126, 0
    v_mov_b32 v127, 0
    s_mov_b32 s34, 0
L_gemm_G2_80:
    s_cmp_ge_u32 s34, 19
    s_cbranch_scc1 L_gw_81_last
    s_waitcnt vmcnt(8)
    s_branch L_gw_81
L_gw_81_last:
    s_waitcnt vmcnt(0)
L_gw_81:
    s_barrier
    v_add_u32 v26, s32, v20
    v_add_u32 v27, s32, v21
    v_add_u32 v28, s32, v22
    ds_read_b128 v[144:147], v28 offset:0
    ds_read_b128 v[128:131], v26 offset:0
    ds_read_b128 v[148:151], v28 offset:2048
    ds_read_b128 v[132:135], v26 offset:2048
    ds_read_b128 v[152:155], v28 offset:4096
    ds_read_b128 v[136:139], v26 offset:4096
    ds_read_b128 v[156:159], v28 offset:6144
    ds_read_b128 v[140:143], v26 offset:6144
    s_cmp_ge_u32 s34, 18
    s_cbranch_scc1 L_gd_82
    s_cmp_lg_u32 s34, 8
    s_cbranch_scc1 L_gs_83
    s_load_dwordx2 s[4:5], s[0:1], 104
    s_waitcnt lgkmcnt(0)
    s_mov_b32 s12, s4
    s_mov_b32 s13, s5
    s_mov_b32 s30, s42
L_gs_83:
    s_add_u32 m0, s33, 0
    s_nop 0
    buffer_load_dwordx4 v12, s[12:15], s30 offen lds
    s_add_u32 m0, s33, 1024
    s_nop 0
    buffer_load_dwordx4 v13, s[12:15], s30 offen lds
    s_add_u32 m0, s33, 2048
    s_nop 0
    buffer_load_dwordx4 v14, s[12:15], s30 offen lds
    s_add_u32 m0, s33, 3072
    s_nop 0
    buffer_load_dwordx4 v15, s[12:15], s30 offen lds
    s_add_u32 m0, s33, 16384
    s_nop 0
    buffer_load_dwordx4 v16, s[16:19], s31 offen sc1 lds
    s_add_u32 m0, s33, 17408
    s_nop 0
    buffer_load_dwordx4 v17, s[16:19], s31 offen sc1 lds
    s_add_u32 m0, s33, 18432
    s_nop 0
    buffer_load_dwordx4 v18, s[16:19], s31 offen sc1 lds
    s_add_u32 m0, s33, 19456
    s_nop 0
    buffer_load_dwordx4 v19, s[16:19], s31 offen sc1 lds
    s_add_u32 s30, s30, s52
    s_add_u32 s31, s31, s53
    s_add_u32 s33, s33, 32768
    s_sub_u32 s26, s33, 98304
    s_cmp_ge_u32 s33, 98304
    s_cselect_b32 s33, s26, s33
L_gd_82:
    s_waitcnt lgkmcnt(0)
    v_mfma_f32_16x16x32_bf16 v[64:67], v[128:131], v[144:147], v[64:67]
    ds_read_b128 v[176:179], v28 offset:1024
    v_mfma_f32_16x16x32_bf16 v[68:71], v[128:131], v[148:151], v[68:71]
    ds_read_b128 v[160:163], v27 offset:0
    v_mfma_f32_16x16x32_bf16 v[72:75], v[128:131], v[152:155], v[72:75]
    ds_read_b128 v[180:183], v28 offset:3072
    v_mfma_f32_16x16x32_bf16 v[76:79], v[128:131], v[156:159], v[76:79]
    ds_read_b128 v[164:167], v27 offset:2048
    v_mfma_f32_16x16x32_bf16 v[80:83], v[132:135], v[144:147], v[80:83]
    ds_read_b128 v[184:187], v28 offset:5120
    v_mfma_f32_16x16x32_bf16 v[84:87], v[132:135], v[148:151], v[84:87]
    ds_read_b128 v[168:171], v27 offset:4096
    v_mfma_f32_16x16x32_bf16 v[88:91], v[132:135], v[152:155], v[88:91]
    ds_read_b128 v[188:191], v28 offset:7168
    v_mfma_f32_16x16x32_bf16 v[92:95], v[132:135], v[156:159], v[92:95]
    ds_read_b128 v[172:175], v27 offset:6144
    v_mfma_f32_16x16x32_bf16 v[96:99], v[136:139], v[144:147], v[96:99]
    v_mfma_f32_16x16x32_bf16 v[100:103], v[136:139], v[148:151], v[100:103]
    v_mfma_f32_16x16x32_bf16 v[104:107], v[136:139], v[152:155], v[104:107]
    v_mfma_f32_16x16x32_bf16 v[108:111], v[136:139], v[156:159], v[108:111]
    v_mfma_f32_16x16x32_bf16 v[112:115], v[140:143], v[144:147], v[112:115]
    v_mfma_f32_16x16x32_bf16 v[116:119], v[140:143], v[148:151], v[116:119]
    v_mfma_f32_16x16x32_bf16 v[120:123], v[140:143], v[152:155], v[120:123]
    v_mfma_f32_16x16x32_bf16 v[124:127], v[140:143], v[156:159], v[124:127]
    s_waitcnt lgkmcnt(0)
    v_mfma_f32_16x16x32_bf16 v[64:67], v[160:163], v[176:179], v[64:67]
    v_mfma_f32_16x16x32_bf16 v[68:71], v[160:163], v[180:183], v[68:71]
    v_mfma_f32_16x16x32_bf16 v[72:75], v[160:163], v[184:187], v[72:75]
    v_mfma_f32_16x16x32_bf16 v[76:79], v[160:163], v[188:191], v[76:79]
    v_mfma_f32_16x16x32_bf16 v[80:83], v[164:167], v[176:179], v[80:83]
    v_mfma_f32_16x16x32_bf16 v[84:87], v[164:167], v[180:183], v[84:87]
    v_mfma_f32_16x16x32_bf16 v[88:91], v[164:167], v[184:187], v[88:91]
    v_mfma_f32_16x16x32_bf16 v[92:95], v[164:167], v[188:191], v[92:95]
    v_mfma_f32_16x16x32_bf16 v[96:99], v[168:171], v[176:179], v[96:99]
    v_mfma_f32_16x16x32_bf16 v[100:103], v[168:171], v[180:183], v[100:103]
    v_mfma_f32_16x16x32_bf16 v[104:107], v[168:171], v[184:187], v[104:107]
    v_mfma_f32_16x16x32_bf16 v[108:111], v[168:171], v[188:191], v[108:111]
    v_mfma_f32_16x16x32_bf16 v[112:115], v[172:175], v[176:179], v[112:115]
    v_mfma_f32_16x16x32_bf16 v[116:119], v[172:175], v[180:183], v[116:119]
    v_mfma_f32_16x16x32_bf16 v[120:123], v[172:175], v[184:187], v[120:123]
    v_mfma_f32_16x16x32_bf16 v[124:127], v[172:175], v[188:191], v[124:127]
    s_add_u32 s32, s32, 32768
    s_cmp_ge_u32 s32, 98304
    s_cselect_b32 s32, 0, s32
    s_add_u32 s34, s34, 1
    s_cmp_lt_u32 s34, 20
    s_cbranch_scc1 L_gemm_G2_80
    s_nop 7
    s_barrier
    s_load_dwordx2 s[4:5], s[0:1], 56
    s_waitcnt lgkmcnt(0)
    s_mov_b32 s12, s4
    s_mov_b32 s13, s5
    s_mov_b32 s14, 2621440
    s_mov_b32 s15, 0x20000
    s_load_dwordx2 s[4:5], s[0:1], 120
    s_waitcnt lgkmcnt(0)
    s_mov_b32 s16, s4
    s_mov_b32 s17, s5
    s_mov_b32 s18, 1280
    s_mov_b32 s19, 0x20000
    s_load_dwordx2 s[4:5], s[0:1], 128
    s_waitcnt lgkmcnt(0)
    s_mov_b32 s44, s4
    s_mov_b32 s45, s5
    s_mov_b32 s46, 10485760
    s_mov_b32 s47, 0x20000
    s_lshl_b32 s26, s36, 7
    s_lshl_b32 s27, s40, 6
    s_add_u32 s26, s26, s27
    v_add_u32 v5, s26, v2
    s_lshl_b32 s26, s37, 7
    s_lshl_b32 s27, s39, 6
    s_add_u32 s26, s26, s27
    v_lshlrev_b32 v6, 2, v3
    v_add_u32 v6, s26, v6
    v_lshlrev_b32 v7, 1, v6
    v_mul_u32_u24 v8, 1280, v5
    v_add_u32 v8, v8, v7
    v_mul_u32_u24 v9, 5120, v5
    v_lshl_add_u32 v9, v6, 2, v9
    v_add_u32 v9, 2560, v9
    buffer_load_dwordx2 v[128:129], v7, s[16:19], 0 offen offset:0
    buffer_load_dwordx2 v[130:131], v7, s[16:19], 0 offen offset:32
    buffer_load_dwordx2 v[132:133], v7, s[16:19], 0 offen offset:64
    buffer_load_dwordx2 v[134:135], v7, s[16:19], 0 offen offset:96
    s_mov_b32 s26, 0
    buffer_load_dwordx2 v[136:137], v8, s[12:15], s26 offen offset:0
    buffer_load_dwordx2 v[138:139], v8, s[12:15], s26 offen offset:32
    buffer_load_dwordx2 v[140:141], v8, s[12:15], s26 offen offset:64
    buffer_load_dwordx2 v[142:143], v8, s[12:15], s26 offen offset:96
    s_mov_b32 s26, 20480
    buffer_load_dwordx2 v[144:145], v8, s[12:15], s26 offen offset:0
    buffer_load_dwordx2 v[146:147], v8, s[12:15], s26 offen offset:32
    buffer_load_dwordx2 v[148:149], v8, s[12:15], s26 offen offset:64
    buffer_load_dwordx2 v[150:151], v8, s[12:15], s26 offen offset:96
    s_mov_b32 s26, 40960
    buffer_load_dwordx2 v[152:153], v8, s[12:15], s26 offen offset:0
    buffer_load_dwordx2 v[154:155], v8, s[12:15], s26 offen offset:32
    buffer_load_dwordx2 v[156:157], v8, s[12:15], s26 offen offset:64
    buffer_load_dwordx2 v[158:159], v8, s[12:15], s26 offen offset:96
    s_mov_b32 s26, 61440
    buffer_load_dwordx2 v[160:161], v8, s[12:15], s26 offen offset:0
    buffer_load_dwordx2 v[162:163], v8, s[12:15], s26 offen offset:32
    buffer_load_dwordx2 v[164:165], v8, s[12:15], s26 offen offset:64
    buffer_load_dwordx2 v[166:167], v8, s[12:15], s26 offen offset:96
    s_waitcnt vmcnt(0)
    v_lshlrev_b32 v176, 16, v128
    v_and_b32 v177, 0xffff0000, v128
    v_lshlrev_b32 v178, 16, v129
    v_and_b32 v179, 0xffff0000, v129
    v_lshlrev_b32 v180, 16, v130
    v_and_b32 v181, 0xffff0000, v130
    v_lshlrev_b32 v182, 16, v131
    v_and_b32 v183, 0xffff0000, v131
    v_lshlrev_b32 v184, 16, v132
    v_and_b32 v185, 0xffff0000, v132
    v_lshlrev_b32 v186, 16, v133
    v_and_b32 v187, 0xffff0000, v133
    v_lshlrev_b32 v188, 16, v134
    v_and_b32 v189, 0xffff0000, v134
    v_lshlrev_b32 v190, 16, v135
    v_and_b32 v191, 0xffff0000, v135
    s_mov_b32 s26, 0
    v_lshlrev_b32 v10, 16, v136
    v_and_b32 v11, 0xffff0000, v136
    v_fma_f32 v64, v10, v176, v64
    v_fma_f32 v65, v11, v177, v65
    v_lshlrev_b32 v10, 16, v137
    v_and_b32 v11, 0xffff0000, v137
    v_fma_f32 v66, v10, v178, v66
    v_fma_f32 v67, v11, v179, v67
    buffer_store_dwordx4 v[64:67], v9, s[44:47], s26 offen offset:0
    v_lshlrev_b32 v10, 16, v138
    v_and_b32 v11, 0xffff0000, v138
    v_fma_f32 v80, v10, v180, v80
    v_fma_f32 v81, v11, v181, v81
    v_lshlrev_b32 v10, 16, v139
    v_and_b32 v11, 0xffff0000, v139
    v_fma_f32 v82, v10, v182, v82
    v_fma_f32 v83, v11, v183, v83
    buffer_store_dwordx4 v[80:83], v9, s[44:47], s26 offen offset:64
    v_lshlrev_b32 v10, 16, v140
    v_and_b32 v11, 0xffff0000, v140
    v_fma_f32 v96, v10, v184, v96
    v_fma_f32 v97, v11, v185, v97
    v_lshlrev_b32 v10, 16, v141
    v_and_b32 v11, 0xffff0000, v141
    v_fma_f32 v98, v10, v186, v98
    v_fma_f32 v99, v11, v187, v99
    buffer_store_dwordx4 v[96:99], v9, s[44:47], s26 offen offset:128
    v_lshlrev_b32 v10, 16, v142
    v_and_b32 v11, 0xffff0000, v142
    v_fma_f32 v112, v10, v188, v112
    v_fma_f32 v113, v11, v189, v113
    v_lshlrev_b32 v10, 16, v143
    v_and_b32 v11, 0xffff0000, v143
    v_fma_f32 v114, v10, v190, v114
    v_fma_f32 v115, v11, v191, v115
    buffer_store_dwordx4 v[112:115], v9, s[44:47], s26 offen offset:192
    s_mov_b32 s26, 81920
    v_lshlrev_b32 v10, 16, v144
    v_and_b32 v11, 0xffff0000, v144
    v_fma_f32 v68, v10, v176, v68
    v_fma_f32 v69, v11, v177, v69
    v_lshlrev_b32 v10, 16, v145
    v_and_b32 v11, 0xffff0000, v145
    v_fma_f32 v70, v10, v178, v70
    v_fma_f32 v71, v11, v179, v71
    buffer_store_dwordx4 v[68:71], v9, s[44:47], s26 offen offset:0
    v_lshlrev_b32 v10, 16, v146
    v_and_b32 v11, 0xffff0000, v146
    v_fma_f32 v84, v10, v180, v84
    v_fma_f32 v85, v11, v181, v85
    v_lshlrev_b32 v10, 16, v147
    v_and_b32 v11, 0xffff0000, v147
    v_fma_f32 v86, v10, v182, v86
    v_fma_f32 v87, v11, v183, v87
    buffer_store_dwordx4 v[84:87], v9, s[44:47], s26 offen offset:64
    v_lshlrev_b32 v10, 16, v148
    v_and_b32 v11, 0xffff0000, v148
    v_fma_f32 v100, v10, v184, v100
    v_fma_f32 v101, v11, v185, v101
    v_lshlrev_b32 v10, 16, v149
    v_and_b32 v11, 0xffff0000, v149
    v_fma_f32 v102, v10, v186, v102
    v_fma_f32 v103, v11, v187, v103
    buffer_store_dwordx4 v[100:103], v9, s[44:47], s26 offen offset:128
    v_lshlrev_b32 v10, 16, v150
    v_and_b32 v11, 0xffff0000, v150
    v_fma_f32 v116, v10, v188, v116
    v_fma_f32 v117, v11, v189, v117
    v_lshlrev_b32 v10, 16, v151
    v_and_b32 v11, 0xffff0000, v151
    v_fma_f32 v118, v10, v190, v118
    v_fma_f32 v119, v11, v191, v119
    buffer_store_dwordx4 v[116:119], v9, s[44:47], s26 offen offset:192
    s_mov_b32 s26, 163840
    v_lshlrev_b32 v10, 16, v152
    v_and_b32 v11, 0xffff0000, v152
    v_fma_f32 v72, v10, v176, v72
    v_fma_f32 v73, v11, v177, v73
    v_lshlrev_b32 v10, 16, v153
    v_and_b32 v11, 0xffff0000, v153
    v_fma_f32 v74, v10, v178, v74
    v_fma_f32 v75, v11, v179, v75
    buffer_store_dwordx4 v[72:75], v9, s[44:47], s26 offen offset:0
    v_lshlrev_b32 v10, 16, v154
    v_and_b32 v11, 0xffff0000, v154
    v_fma_f32 v88, v10, v180, v88
    v_fma_f32 v89, v11, v181, v89
    v_lshlrev_b32 v10, 16, v155
    v_and_b32 v11, 0xffff0000, v155
    v_fma_f32 v90, v10, v182, v90
    v_fma_f32 v91, v11, v183, v91
    buffer_store_dwordx4 v[88:91], v9, s[44:47], s26 offen offset:64
    v_lshlrev_b32 v10, 16, v156
    v_and_b32 v11, 0xffff0000, v156
    v_fma_f32 v104, v10, v184, v104
    v_fma_f32 v105, v11, v185, v105
    v_lshlrev_b32 v10, 16, v157
    v_and_b32 v11, 0xffff0000, v157
    v_fma_f32 v106, v10, v186, v106
    v_fma_f32 v107, v11, v187, v107
    buffer_store_dwordx4 v[104:107], v9, s[44:47], s26 offen offset:128
    v_lshlrev_b32 v10, 16, v158
    v_and_b32 v11, 0xffff0000, v158
    v_fma_f32 v120, v10, v188, v120
    v_fma_f32 v121, v11, v189, v121
    v_lshlrev_b32 v10, 16, v159
    v_and_b32 v11, 0xffff0000, v159
    v_fma_f32 v122, v10, v190, v122
    v_fma_f32 v123, v11, v191, v123
    buffer_store_dwordx4 v[120:123], v9, s[44:47], s26 offen offset:192
    s_mov_b32 s26, 245760
    v_lshlrev_b32 v10, 16, v160
    v_and_b32 v11, 0xffff0000, v160
    v_fma_f32 v76, v10, v176, v76
    v_fma_f32 v77, v11, v177, v77
    v_lshlrev_b32 v10, 16, v161
    v_and_b32 v11, 0xffff0000, v161
    v_fma_f32 v78, v10, v178, v78
    v_fma_f32 v79, v11, v179, v79
    buffer_store_dwordx4 v[76:79], v9, s[44:47], s26 offen offset:0
    v_lshlrev_b32 v10, 16, v162
    v_and_b32 v11, 0xffff0000, v162
    v_fma_f32 v92, v10, v180, v92
    v_fma_f32 v93, v11, v181, v93
    v_lshlrev_b32 v10, 16, v163
    v_and_b32 v11, 0xffff0000, v163
    v_fma_f32 v94, v10, v182, v94
    v_fma_f32 v95, v11, v183, v95
    buffer_store_dwordx4 v[92:95], v9, s[44:47], s26 offen offset:64
    v_lshlrev_b32 v10, 16, v164
    v_and_b32 v11, 0xffff0000, v164
    v_fma_f32 v108, v10, v184, v108
    v_fma_f32 v109, v11, v185, v109
    v_lshlrev_b32 v10, 16, v165
    v_and_b32 v11, 0xffff0000, v165
    v_fma_f32 v110, v10, v186, v110
    v_fma_f32 v111, v11, v187, v111
    buffer_store_dwordx4 v[108:111], v9, s[44:47], s26 offen offset:128
    v_lshlrev_b32 v10, 16, v166
    v_and_b32 v11, 0xffff0000, v166
    v_fma_f32 v124, v10, v188, v124
    v_fma_f32 v125, v11, v189, v125
    v_lshlrev_b32 v10, 16, v167
    v_and_b32 v11, 0xffff0000, v167
    v_fma_f32 v126, v10, v190, v126
    v_fma_f32 v127, v11, v191, v127
    buffer_store_dwordx4 v[124:127], v9, s[44:47], s26 offen offset:192
    s_waitcnt vmcnt(0)
    s_branch L_G2_next_74
L_G2_done_75:
    s_mov_b32 s61, 120
L_ATT_next_84:
    s_mov_b32 s61, 120
    s_barrier
    s_cmp_lg_u32 s24, 0
    s_cbranch_scc1 L_fetch_86
    v_mov_b32 v5, s61
    v_mov_b32 v6, 1
    s_mov_b64 exec, 1
    buffer_atomic_add v6, v5, s[20:23], 0 offen sc0
    s_waitcnt vmcnt(0)
    v_mov_b32 v5, 163836
    ds_write_b32 v5, v6
    s_waitcnt lgkmcnt(0)
    s_mov_b64 exec, -1
L_fetch_86:
    s_barrier
    v_mov_b32 v5, 163836
    ds_read_b32 v6, v5
    s_waitcnt lgkmcnt(0)
    v_readfirstlane_b32 s25, v6
    s_cmp_ge_u32 s25, 512
    s_cbranch_scc1 L_ATT_done_85
    s_lshr_b32 s36, s25, 3
    s_and_b32 s37, s25, 7
    s_cmp_eq_u32 s58, 1
    s_cbranch_scc1 L_zok_87
    v_mov_b32 v10, 40
L_wsp_88:
    buffer_load_dword v11, v10, s[20:23], 0 offen sc1
    s_waitcnt vmcnt(0)
    v_readfirstlane_b32 s29, v11
    s_cmp_ge_u32 s29, 256
    s_cbranch_scc1 L_wsp_88_ok
    s_sleep 2
    s_sub_u32 s38, s38, 1
    s_cbranch_scc0 L_wsp_88
    s_branch L_w_abort
L_wsp_88_ok:
    s_mov_b32 s58, 1
L_zok_87:
    s_lshl_b32 s39, s37, 2
    s_add_u32 s39, s39, s24
    s_lshr_b32 s26, s36, 2
    s_lshl_b32 s26, s26, 5
    s_add_u32 s26, s26, s39
    s_lshl_b32 s40, s26, 2
    s_add_u32 s26, s40, 102762496
    v_mov_b32 v6, s26
L_wsp_89:
    buffer_load_dword v11, v6, s[8:11], 0 offen sc1
    s_waitcnt vmcnt(0)
    v_readfirstlane_b32 s29, v11
    s_cmp_ge_u32 s29, 1
    s_cbranch_scc1 L_wsp_89_ok
    s_sleep 8
    s_sub_u32 s38, s38, 1
    s_cbranch_scc0 L_wsp_89
    s_branch L_w_abort
L_wsp_89_ok:
    s_add_u32 s26, s40, 102760448
    v_mov_b32 v6, s26
L_wsp_90:
    buffer_load_dword v11, v6, s[8:11], 0 offen sc1
    s_waitcnt vmcnt(0)
    v_readfirstlane_b32 s29, v11
    s_cmp_ge_u32 s29, 2
    s_cbranch_scc1 L_wsp_90_ok
    s_sleep 8
    s_sub_u32 s38, s38, 1
    s_cbranch_scc0 L_wsp_90
    s_branch L_w_abort
L_wsp_90_ok:
    s_lshl_b32 s26, s36, 5
    s_add_u32 s26, s26, s39
    s_lshl_b32 s40, s26, 13
    s_add_u32 s41, s40, 33554432
    s_add_u32 s42, s41, 4096
    buffer_load_dwordx4 v[32:35], v1, s[8:11], s41 offen offset:0 sc1
    buffer_load_dwordx4 v[36:39], v1, s[8:11], s41 offen offset:1024 sc1
    buffer_load_dwordx4 v[40:43], v1, s[8:11], s41 offen offset:2048 sc1
    buffer_load_dwordx4 v[44:47], v1, s[8:11], s41 offen offset:3072 sc1
    buffer_load_dwordx4 v[48:51], v1, s[8:11], s42 offen offset:0 sc1
    buffer_load_dwordx4 v[52:55], v1, s[8:11], s42 offen offset:1024 sc1
    buffer_load_dwordx4 v[56:59], v1, s[8:11], s42 offen offset:2048 sc1
    buffer_load_dwordx4 v[60:63], v1, s[8:11], s42 offen offset:3072 sc1
    s_add_u32 s41, s40, 0
    s_add_u32 s42, s41, 4096
    buffer_load_dwordx4 v[64:67], v1, s[8:11], s41 offen offset:0 sc1
    buffer_load_dwordx4 v[68:71], v1, s[8:11], s41 offen offset:1024 sc1
    buffer_load_dwordx4 v[72:75], v1, s[8:11], s41 offen offset:2048 sc1
    buffer_load_dwordx4 v[76:79], v1, s[8:11], s41 offen offset:3072 sc1
    buffer_load_dwordx4 v[80:83], v1, s[8:11], s42 offen offset:0 sc1
    buffer_load_dwordx4 v[84:87], v1, s[8:11], s42 offen offset:1024 sc1
    buffer_load_dwordx4 v[88:91], v1, s[8:11], s42 offen offset:2048 sc1
    buffer_load_dwordx4 v[92:95], v1, s[8:11], s42 offen offset:3072 sc1
    s_add_u32 s41, s40, 16777216
    s_add_u32 s42, s41, 4096
    buffer_load_dwordx4 v[112:115], v1, s[8:11], s41 offen offset:0 sc1
    buffer_load_dwordx4 v[116:119], v1, s[8:11], s41 offen offset:1024 sc1
    buffer_load_dwordx4 v[120:123], v1, s[8:11], s41 offen offset:2048 sc1
    buffer_load_dwordx4 v[124:127], v1, s[8:11], s41 offen offset:3072 sc1
    buffer_load_dwordx4 v[128:131], v1, s[8:11], s42 offen offset:0 sc1
    buffer_load_dwordx4 v[132:135], v1, s[8:11], s42 offen offset:1024 sc1
    buffer_load_dwordx4 v[136:139], v1, s[8:11], s42 offen offset:2048 sc1
    buffer_load_dwordx4 v[140:143], v1, s[8:11], s42 offen offset:3072 sc1
    s_add_u32 s34, s36, 1
    s_lshl_b32 s26, s39, 7
    s_add_u32 s26, s26, 102764544
    v_mov_b32 v6, s26
L_wsp_91:
    buffer_load_dword v11, v6, s[8:11], 0 offen sc1
    s_waitcnt vmcnt(0)
    v_readfirstlane_b32 s29, v11
    s_cmp_ge_u32 s29, s34
    s_cbranch_scc1 L_wsp_91_ok
    s_sleep 16
    s_sub_u32 s38, s38, 1
    s_cbranch_scc0 L_wsp_91
    s_branch L_w_abort
L_wsp_91_ok:
    s_lshl_b32 s26, s39, 7
    s_add_u32 s26, s26, 102764608
    v_mov_b32 v6, s26
L_wsp_92:
    buffer_load_dword v11, v6, s[8:11], 0 offen sc1
    s_waitcnt vmcnt(0)
    v_readfirstlane_b32 s29, v11
    s_cmp_ge_u32 s29, s34
    s_cbranch_scc1 L_wsp_92_ok
    s_sleep 16
    s_sub_u32 s38, s38, 1
    s_cbranch_scc0 L_wsp_92
    s_branch L_w_abort
L_wsp_92_ok:
    s_lshl_b32 s26, s36, 5
    s_add_u32 s26, s26, s39
    s_lshl_b32 s27, s26, 12
    s_add_u32 s41, s27, 50331648
    s_lshl_b32 s27, s26, 11
    s_add_u32 s42, s27, 58720256
    v_lshlrev_b32 v5, 3, v4
    buffer_load_dwordx4 v[96:99], v1, s[8:11], s41 offen offset:0 sc1
    buffer_load_dwordx4 v[100:103], v1, s[8:11], s41 offen offset:1024 sc1
    buffer_load_dwordx4 v[104:107], v1, s[8:11], s41 offen offset:2048 sc1
    buffer_load_dwordx4 v[108:111], v1, s[8:11], s41 offen offset:3072 sc1
    buffer_load_dwordx2 v[144:145], v5, s[8:11], s42 offen offset:0 sc1
    buffer_load_dwordx2 v[146:147], v5, s[8:11], s42 offen offset:512 sc1
    buffer_load_dwordx2 v[148:149], v5, s[8:11], s42 offen offset:1024 sc1
    buffer_load_dwordx2 v[150:151], v5, s[8:11], s42 offen offset:1536 sc1
    s_mov_b32 s54, 0x3e0293ee
    s_mov_b32 s55, 0x3e0293ee
    v_mov_b32 v169, 0
    v_mov_b32 v213, 0
    v_lshlrev_b32 v7, 2, v3
    v_sub_u32 v7, v2, v7
    v_mov_b32 v8, 0xf149f2ca
    s_waitcnt vmcnt(0)
    v_mfma_f32_16x16x32_bf16 v[156:159], v[64:67], v[32:35], 0
    v_mfma_f32_16x16x32_bf16 v[152:155], v[96:99], v[32:35], 0
    v_mfma_f32_16x16x32_bf16 v[156:159], v[68:71], v[36:39], v[156:159]
    v_mfma_f32_16x16x32_bf16 v[152:155], v[100:103], v[36:39], v[152:155]
    v_mfma_f32_16x16x32_bf16 v[156:159], v[72:75], v[40:43], v[156:159]
    v_mfma_f32_16x16x32_bf16 v[152:155], v[104:107], v[40:43], v[152:155]
    v_mfma_f32_16x16x32_bf16 v[156:159], v[76:79], v[44:47], v[156:159]
    v_mfma_f32_16x16x32_bf16 v[152:155], v[108:111], v[44:47], v[152:155]
    v_cmp_le_i32 vcc, 0, v7
    s_nop 2
    v_cndmask_b32 v156, v8, v156, vcc
    v_cmp_le_i32 vcc, 1, v7
    s_nop 1
    v_cndmask_b32 v157, v8, v157, vcc
    v_cmp_le_i32 vcc, 2, v7
    s_nop 1
    v_cndmask_b32 v158, v8, v158, vcc
    v_cmp_le_i32 vcc, 3, v7
    s_nop 1
    v_cndmask_b32 v159, v8, v159, vcc
    v_max_f32 v170, v152, v153
    v_max_f32 v170, v170, v156
    v_max_f32 v170, v170, v157
    v_max_f32 v170, v170, v158
    v_max_f32 v170, v170, v159
    v_mov_b32 v9, v170
    s_nop 1
    v_permlane16_swap_b32 v170, v9
    v_max_f32 v170, v170, v9
    v_mov_b32 v9, v170
    s_nop 1
    v_permlane32_swap_b32 v170, v9
    v_max_f32 v170, v170, v9
    v_mul_f32 v170, s54, v170
    v_fma_f32 v156, v156, s54, -v170
    v_fma_f32 v157, v157, s54, -v170
    v_fma_f32 v158, v158, s54, -v170
    v_fma_f32 v159, v159, s54, -v170
    v_fma_f32 v152, v152, s54, -v170
    v_fma_f32 v153, v153, s54, -v170
    v_exp_f32 v156, v156
    v_exp_f32 v157, v157
    v_exp_f32 v158, v158
    v_exp_f32 v159, v159
    v_exp_f32 v152, v152
    v_exp_f32 v153, v153
    v_cvt_pk_bf16_f32 v164, v156, v157
    v_cvt_pk_bf16_f32 v165, v158, v159
    v_mov_b32 v166, 0
    v_mov_b32 v167, 0
    v_cvt_pk_bf16_f32 v168, v152, v153
    v_add_f32 v171, v156, v157
    v_add_f32 v171, v171, v158
    v_add_f32 v171, v171, v159
    v_add_f32 v171, v171, v152
    v_add_f32 v171, v171, v153
    v_mov_b32 v9, v171
    s_nop 1
    v_permlane16_swap_b32 v171, v9
    v_add_f32 v171, v171, v9
    v_mov_b32 v9, v171
    s_nop 1
    v_permlane32_swap_b32 v171, v9
    v_add_f32 v171, v171, v9
    v_rcp_f32 v171, v171
    v_mfma_f32_16x16x32_bf16 v[172:175], v[112:115], v[164:167], 0
    v_mfma_f32_16x16x32_bf16 v[176:179], v[116:119], v[164:167], 0
    v_mfma_f32_16x16x32_bf16 v[180:183], v[120:123], v[164:167], 0
    v_mfma_f32_16x16x32_bf16 v[184:187], v[124:127], v[164:167], 0
    v_mfma_f32_16x16x32_bf16 v[188:191], v[128:131], v[164:167], 0
    v_mfma_f32_16x16x32_bf16 v[192:195], v[132:135], v[164:167], 0
    v_mfma_f32_16x16x32_bf16 v[196:199], v[136:139], v[164:167], 0
    v_mfma_f32_16x16x32_bf16 v[200:203], v[140:143], v[164:167], 0
    v_mov_b32 v212, v144
    s_nop 1
    v_mfma_f32_16x16x16_bf16 v[172:175], v[212:213], v[168:169], v[172:175]
    v_mov_b32 v212, v145
    s_nop 1
    v_mfma_f32_16x16x16_bf16 v[176:179], v[212:213], v[168:169], v[176:179]
    v_mov_b32 v212, v146
    s_nop 1
    v_mfma_f32_16x16x16_bf16 v[180:183], v[212:213], v[168:169], v[180:183]
    v_mov_b32 v212, v147
    s_nop 1
    v_mfma_f32_16x16x16_bf16 v[184:187], v[212:213], v[168:169], v[184:187]
    v_mov_b32 v212, v148
    s_nop 1
    v_mfma_f32_16x16x16_bf16 v[188:191], v[212:213], v[168:169], v[188:191]
    v_mov_b32 v212, v149
    s_nop 1
    v_mfma_f32_16x16x16_bf16 v[192:195], v[212:213], v[168:169], v[192:195]
    v_mov_b32 v212, v150
    s_nop 1
    v_mfma_f32_16x16x16_bf16 v[196:199], v[212:213], v[168:169], v[196:199]
    v_mov_b32 v212, v151
    s_nop 1
    v_mfma_f32_16x16x16_bf16 v[200:203], v[212:213], v[168:169], v[200:203]
    s_lshl_b32 s26, s36, 1
    s_add_u32 s26, s26, 0
    s_lshl_b32 s26, s26, 7
    s_lshl_b32 s27, s39, 2
    s_add_u32 s26, s26, s27
    s_lshl_b32 s26, s26, 10
    s_add_u32 s26, s26, 67108864
    v_mul_f32 v172, v172, v171
    v_mul_f32 v173, v173, v171
    v_mul_f32 v174, v174, v171
    v_mul_f32 v175, v175, v171
    v_cvt_pk_bf16_f32 v204, v172, v173
    v_cvt_pk_bf16_f32 v205, v174, v175
    v_mul_f32 v176, v176, v171
    v_mul_f32 v177, v177, v171
    v_mul_f32 v178, v178, v171
    v_mul_f32 v179, v179, v171
    v_cvt_pk_bf16_f32 v206, v176, v177
    v_cvt_pk_bf16_f32 v207, v178, v179
    buffer_store_dwordx4 v[204:207], v1, s[8:11], s26 offen offset:0 sc1
    v_mul_f32 v180, v180, v171
    v_mul_f32 v181, v181, v171
    v_mul_f32 v182, v182, v171
    v_mul_f32 v183, v183, v171
    v_cvt_pk_bf16_f32 v208, v180, v181
    v_cvt_pk_bf16_f32 v209, v182, v183
    v_mul_f32 v184, v184, v171
    v_mul_f32 v185, v185, v171
    v_mul_f32 v186, v186, v171
    v_mul_f32 v187, v187, v171
    v_cvt_pk_bf16_f32 v210, v184, v185
    v_cvt_pk_bf16_f32 v211, v186, v187
    buffer_store_dwordx4 v[208:211], v1, s[8:11], s26 offen offset:1024 sc1
    v_mul_f32 v188, v188, v171
    v_mul_f32 v189, v189, v171
    v_mul_f32 v190, v190, v171
    v_mul_f32 v191, v191, v171
    v_cvt_pk_bf16_f32 v204, v188, v189
    v_cvt_pk_bf16_f32 v205, v190, v191
    v_mul_f32 v192, v192, v171
    v_mul_f32 v193, v193, v171
    v_mul_f32 v194, v194, v171
    v_mul_f32 v195, v195, v171
    v_cvt_pk_bf16_f32 v206, v192, v193
    v_cvt_pk_bf16_f32 v207, v194, v195
    buffer_store_dwordx4 v[204:207], v1, s[8:11], s26 offen offset:2048 sc1
    v_mul_f32 v196, v196, v171
    v_mul_f32 v197, v197, v171
    v_mul_f32 v198, v198, v171
    v_mul_f32 v199, v199, v171
    v_cvt_pk_bf16_f32 v208, v196, v197
    v_cvt_pk_bf16_f32 v209, v198, v199
    v_mul_f32 v200, v200, v171
    v_mul_f32 v201, v201, v171
    v_mul_f32 v202, v202, v171
    v_mul_f32 v203, v203, v171
    v_cvt_pk_bf16_f32 v210, v200, v201
    v_cvt_pk_bf16_f32 v211, v202, v203
    buffer_store_dwordx4 v[208:211], v1, s[8:11], s26 offen offset:3072 sc1
    v_mfma_f32_16x16x32_bf16 v[156:159], v[64:67], v[48:51], 0
    v_mfma_f32_16x16x32_bf16 v[160:163], v[80:83], v[48:51], 0
    v_mfma_f32_16x16x32_bf16 v[152:155], v[96:99], v[48:51], 0
    v_mfma_f32_16x16x32_bf16 v[156:159], v[68:71], v[52:55], v[156:159]
    v_mfma_f32_16x16x32_bf16 v[160:163], v[84:87], v[52:55], v[160:163]
    v_mfma_f32_16x16x32_bf16 v[152:155], v[100:103], v[52:55], v[152:155]
    v_mfma_f32_16x16x32_bf16 v[156:159], v[72:75], v[56:59], v[156:159]
    v_mfma_f32_16x16x32_bf16 v[160:163], v[88:91], v[56:59], v[160:163]
    v_mfma_f32_16x16x32_bf16 v[152:155], v[104:107], v[56:59], v[152:155]
    v_mfma_f32_16x16x32_bf16 v[156:159], v[76:79], v[60:63], v[156:159]
    v_mfma_f32_16x16x32_bf16 v[160:163], v[92:95], v[60:63], v[160:163]
    v_mfma_f32_16x16x32_bf16 v[152:155], v[108:111], v[60:63], v[152:155]
    v_cmp_le_i32 vcc, 0, v7
    s_nop 2
    v_cndmask_b32 v160, v8, v160, vcc
    v_cmp_le_i32 vcc, 1, v7
    s_nop 1
    v_cndmask_b32 v161, v8, v161, vcc
    v_cmp_le_i32 vcc, 2, v7
    s_nop 1
    v_cndmask_b32 v162, v8, v162, vcc
    v_cmp_le_i32 vcc, 3, v7
    s_nop 1
    v_cndmask_b32 v163, v8, v163, vcc
    v_max_f32 v170, v152, v153
    v_max_f32 v170, v170, v156
    v_max_f32 v170, v170, v157
    v_max_f32 v170, v170, v158
    v_max_f32 v170, v170, v159
    v_max_f32 v170, v170, v160
    v_max_f32 v170, v170, v161
    v_max_f32 v170, v170, v162
    v_max_f32 v170, v170, v163
    v_mov_b32 v9, v170
    s_nop 1
    v_permlane16_swap_b32 v170, v9
    v_max_f32 v170, v170, v9
    v_mov_b32 v9, v170
    s_nop 1
    v_permlane32_swap_b32 v170, v9
    v_max_f32 v170, v170, v9
    v_mul_f32 v170, s54, v170
    v_fma_f32 v156, v156, s54, -v170
    v_fma_f32 v157, v157, s54, -v170
    v_fma_f32 v158, v158, s54, -v170
    v_fma_f32 v159, v159, s54, -v170
    v_fma_f32 v160, v160, s54, -v170
    v_fma_f32 v161, v161, s54, -v170
    v_fma_f32 v162, v162, s54, -v170
    v_fma_f32 v163, v163, s54, -v170
    v_fma_f32 v152, v152, s54, -v170
    v_fma_f32 v153, v153, s54, -v170
    v_exp_f32 v156, v156
    v_exp_f32 v157, v157
    v_exp_f32 v158, v158
    v_exp_f32 v159, v159
    v_exp_f32 v160, v160
    v_exp_f32 v161, v161
    v_exp_f32 v162, v162
    v_exp_f32 v163, v163
    v_exp_f32 v152, v152
    v_exp_f32 v153, v153
    v_cvt_pk_bf16_f32 v164, v156, v157
    v_cvt_pk_bf16_f32 v165, v158, v159
    v_cvt_pk_bf16_f32 v166, v160, v161
    v_cvt_pk_bf16_f32 v167, v162, v163
    v_cvt_pk_bf16_f32 v168, v152, v153
    v_add_f32 v171, v156, v157
    v_add_f32 v171, v171, v158
    v_add_f32 v171, v171, v159
    v_add_f32 v171, v171, v160
    v_add_f32 v171, v171, v161
    v_add_f32 v171, v171, v162
    v_add_f32 v171, v171, v163
    v_add_f32 v171, v171, v152
    v_add_f32 v171, v171, v153
    v_mov_b32 v9, v171
    s_nop 1
    v_permlane16_swap_b32 v171, v9
    v_add_f32 v171, v171, v9
    v_mov_b32 v9, v171
    s_nop 1
    v_permlane32_swap_b32 v171, v9
    v_add_f32 v171, v171, v9
    v_rcp_f32 v171, v171
    v_mfma_f32_16x16x32_bf16 v[172:175], v[112:115], v[164:167], 0
    v_mfma_f32_16x16x32_bf16 v[176:179], v[116:119], v[164:167], 0
    v_mfma_f32_16x16x32_bf16 v[180:183], v[120:123], v[164:167], 0
    v_mfma_f32_16x16x32_bf16 v[184:187], v[124:127], v[164:167], 0
    v_mfma_f32_16x16x32_bf16 v[188:191], v[128:131], v[164:167], 0
    v_mfma_f32_16x16x32_bf16 v[192:195], v[132:135], v[164:167], 0
    v_mfma_f32_16x16x32_bf16 v[196:199], v[136:139], v[164:167], 0
    v_mfma_f32_16x16x32_bf16 v[200:203], v[140:143], v[164:167], 0
    v_mov_b32 v212, v144
    s_nop 1
    v_mfma_f32_16x16x16_bf16 v[172:175], v[212:213], v[168:169], v[172:175]
    v_mov_b32 v212, v145
    s_nop 1
    v_mfma_f32_16x16x16_bf16 v[176:179], v[212:213], v[168:169], v[176:179]
    v_mov_b32 v212, v146
    s_nop 1
    v_mfma_f32_16x16x16_bf16 v[180:183], v[212:213], v[168:169], v[180:183]
    v_mov_b32 v212, v147
    s_nop 1
    v_mfma_f32_16x16x16_bf16 v[184:187], v[212:213], v[168:169], v[184:187]
    v_mov_b32 v212, v148
    s_nop 1
    v_mfma_f32_16x16x16_bf16 v[188:191], v[212:213], v[168:169], v[188:191]
    v_mov_b32 v212, v149
    s_nop 1
    v_mfma_f32_16x16x16_bf16 v[192:195], v[212:213], v[168:169], v[192:195]
    v_mov_b32 v212, v150
    s_nop 1
    v_mfma_f32_16x16x16_bf16 v[196:199], v[212:213], v[168:169], v[196:199]
    v_mov_b32 v212, v151
    s_nop 1
    v_mfma_f32_16x16x16_bf16 v[200:203], v[212:213], v[168:169], v[200:203]
    s_lshl_b32 s26, s36, 1
    s_add_u32 s26, s26, 1
    s_lshl_b32 s26, s26, 7
    s_lshl_b32 s27, s39, 2
    s_add_u32 s26, s26, s27
    s_lshl_b32 s26, s26, 10
    s_add_u32 s26, s26, 67108864
    v_mul_f32 v172, v172, v171
    v_mul_f32 v173, v173, v171
    v_mul_f32 v174, v174, v171
    v_mul_f32 v175, v175, v171
    v_cvt_pk_bf16_f32 v204, v172, v173
    v_cvt_pk_bf16_f32 v205, v174, v175
    v_mul_f32 v176, v176, v171
    v_mul_f32 v177, v177, v171
    v_mul_f32 v178, v178, v171
    v_mul_f32 v179, v179, v171
    v_cvt_pk_bf16_f32 v206, v176, v177
    v_cvt_pk_bf16_f32 v207, v178, v179
    buffer_store_dwordx4 v[204:207], v1, s[8:11], s26 offen offset:0 sc1
    v_mul_f32 v180, v180, v171
    v_mul_f32 v181, v181, v171
    v_mul_f32 v182, v182, v171
    v_mul_f32 v183, v183, v171
    v_cvt_pk_bf16_f32 v208, v180, v181
    v_cvt_pk_bf16_f32 v209, v182, v183
    v_mul_f32 v184, v184, v171
    v_mul_f32 v185, v185, v171
    v_mul_f32 v186, v186, v171
    v_mul_f32 v187, v187, v171
    v_cvt_pk_bf16_f32 v210, v184, v185
    v_cvt_pk_bf16_f32 v211, v186, v187
    buffer_store_dwordx4 v[208:211], v1, s[8:11], s26 offen offset:1024 sc1
    v_mul_f32 v188, v188, v171
    v_mul_f32 v189, v189, v171
    v_mul_f32 v190, v190, v171
    v_mul_f32 v191, v191, v171
    v_cvt_pk_bf16_f32 v204, v188, v189
    v_cvt_pk_bf16_f32 v205, v190, v191
    v_mul_f32 v192, v192, v171
    v_mul_f32 v193, v193, v171
    v_mul_f32 v194, v194, v171
    v_mul_f32 v195, v195, v171
    v_cvt_pk_bf16_f32 v206, v192, v193
    v_cvt_pk_bf16_f32 v207, v194, v195
    buffer_store_dwordx4 v[204:207], v1, s[8:11], s26 offen offset:2048 sc1
    v_mul_f32 v196, v196, v171
    v_mul_f32 v197, v197, v171
    v_mul_f32 v198, v198, v171
    v_mul_f32 v199, v199, v171
    v_cvt_pk_bf16_f32 v208, v196, v197
    v_cvt_pk_bf16_f32 v209, v198, v199
    v_mul_f32 v200, v200, v171
    v_mul_f32 v201, v201, v171
    v_mul_f32 v202, v202, v171
    v_mul_f32 v203, v203, v171
    v_cvt_pk_bf16_f32 v210, v200, v201
    v_cvt_pk_bf16_f32 v211, v202, v203
    buffer_store_dwordx4 v[208:211], v1, s[8:11], s26 offen offset:3072 sc1
    s_lshl_b32 s26, s36, 2
    s_add_u32 s39, s26, 102770176
    s_cmp_eq_u32 s58, 1
    s_cbranch_scc1 L_zok_93
    v_mov_b32 v10, 40
L_wsp_94:
    buffer_load_dword v11, v10, s[20:23], 0 offen sc1
    s_waitcnt vmcnt(0)
    v_readfirstlane_b32 s29, v11
    s_cmp_ge_u32 s29, 256
    s_cbranch_scc1 L_wsp_94_ok
    s_sleep 2
    s_sub_u32 s38, s38, 1
    s_cbranch_scc0 L_wsp_94
    s_branch L_w_abort
L_wsp_94_ok:
    s_mov_b32 s58, 1
L_zok_93:
    s_waitcnt vmcnt(0)
    s_barrier
    s_cmp_lg_u32 s24, 0
    s_cbranch_scc1 L_sig_95
    v_mov_b32 v5, s39
    v_mov_b32 v6, 1
    s_mov_b64 exec, 1
    buffer_atomic_add v6, v5, s[8:11], 0 offen sc1
    s_mov_b64 exec, -1
L_sig_95:
    s_branch L_ATT_next_84
L_ATT_done_85:
    s_branch L_exit
L_w_abort:
    v_mov_b32 v5, 36
    v_mov_b32 v6, 256
    s_mov_b64 exec, 1
    buffer_atomic_add v6, v5, s[20:23], 0 offen
    s_waitcnt vmcnt(0)
    s_branch L_exit
L_chain:
    v_lshrrev_b32 v15, 6, v0
    v_and_b32 v14, 63, v0
    v_lshlrev_b32 v1, 4, v14
    v_readfirstlane_b32 s19, v15
    s_load_dwordx2 s[4:5], s[0:1], 144
    s_load_dwordx2 s[6:7], s[0:1], 136
    s_waitcnt lgkmcnt(0)
    s_mov_b32 s8, s4
    s_mov_b32 s9, s5
    s_mov_b32 s10, 268435456
    s_mov_b32 s11, 0x20000
    s_mov_b32 s52, s6
    s_mov_b32 s53, s7
    s_mov_b32 s54, 256
    s_mov_b32 s55, 0x20000
    s_sub_u32 s38, 0, s4
    s_and_b32 s38, s38, 0x1fffff
    s_add_u32 s42, s38, 104857600
    s_mov_b32 s43, 0
    s_lshl_b32 s38, s18, 15
    s_add_u32 s44, s38, 101711872
    s_mov_b32 s28, 0xcccccccc
    s_mov_b32 s29, 0xcccccccc
    s_mov_b32 s30, 0x00550055
    s_mov_b32 s31, 0x00550055
    s_mov_b32 s32, 0x3e0293ee
    s_mov_b32 s33, 0x3e0293ee
    s_mov_b32 s27, 300000
    v_mov_b32 v100, -1
    v_mov_b32 v101, -1
    v_mov_b32 v102, -1
    v_mov_b32 v103, -1
    v_mov_b32 v18, 0x3f80
    v_mov_b32 v19, 0x3f800000
    v_and_b32 v15, 15, v14
    v_lshrrev_b32 v16, 4, v14
    v_mov_b32 v3, 0x4444
    v_mov_b32 v17, 0xeeee
    v_cmp_lt_u32 vcc, 7, v15
    s_nop 1
    v_cndmask_b32 v3, v3, v17, vcc
    v_and_b32 v17, 1, v15
    v_cmp_eq_u32 vcc, 1, v17
    s_nop 1
    v_cndmask_b32 v2, v18, v19, vcc
    v_and_b32 v17, 2, v15
    v_cmp_eq_u32 vcc, 0, v17
    s_nop 1
    v_cndmask_b32 v2, 0, v2, vcc
    v_lshrrev_b32 v17, 2, v15
    v_cmp_eq_u32 vcc, 0, v17
    s_nop 1
    v_cndmask_b32 v104, 0, v2, vcc
    v_cmp_eq_u32 vcc, 1, v17
    s_nop 1
    v_cndmask_b32 v105, 0, v2, vcc
    v_cmp_eq_u32 vcc, 2, v17
    s_nop 1
    v_cndmask_b32 v106, 0, v2, vcc
    v_cmp_eq_u32 vcc, 3, v17
    s_nop 1
    v_cndmask_b32 v107, 0, v2, vcc
    s_mul_i32 s38, s19, 96
    s_min_u32 s38, s38, 256
    v_lshrrev_b32 v17, 1, v16
    v_lshl_add_u32 v17, v17, 4, v15
    v_add_u32 v17, s38, v17
    v_lshrrev_b32 v2, 3, v17
    v_lshlrev_b32 v4, 12, v2
    v_and_b32 v2, 7, v17
    v_lshl_add_u32 v4, v2, 4, v4
    v_and_b32 v2, 1, v16
    v_lshl_add_u32 v4, v2, 3, v4
    s_mul_i32 s38, s18, 163840
    s_lshl_b32 s39, s17, 7
    s_add_u32 s38, s38, s39
    s_add_u32 s38, s38, 100663296
    v_add_u32 v4, s38, v4
    s_mov_b32 s50, 16384
    s_mov_b32 s51, 32768
    s_add_u32 s38, s17, 32
    s_cmp_eq_u32 s19, 2
    s_cselect_b32 s38, s17, s38
    s_cmp_lt_u32 s38, 40
    s_cselect_b32 s48, 1, 0
    s_and_b32 s39, s19, 1
    s_cmp_eq_u32 s39, 1
    s_cselect_b32 s48, 0, s48
    s_min_u32 s38, s38, 39
    s_mul_i32 s39, s18, 40
    s_add_u32 s39, s39, s38
    s_lshl_b32 s39, s39, 12
    s_add_u32 s39, s39, 100663296
    v_add_u32 v5, s39, v1
    v_mul_u32_u24 v6, 1280, v16
    v_and_b32 v17, 7, v15
    v_lshl_add_u32 v6, v17, 1, v6
    s_lshl_b32 s39, s38, 4
    v_add_u32 v6, s39, v6
    s_lshl_b32 s38, s19, 10
    v_lshrrev_b32 v17, 1, v16
    v_lshl_add_u32 v17, v17, 4, v15
    v_lshlrev_b32 v7, 5, v17
    v_add_u32 v7, s38, v7
    v_lshrrev_b32 v17, 2, v15
    v_xor_b32 v17, v17, v16
    v_and_b32 v17, 1, v17
    v_lshl_add_u32 v7, v17, 4, v7
    v_lshrrev_b32 v17, 2, v15
    v_lshl_add_u32 v17, v16, 2, v17
    v_lshlrev_b32 v8, 5, v17
    v_lshrrev_b32 v17, 1, v15
    v_xor_b32 v17, v17, v16
    v_and_b32 v17, 1, v17
    v_lshl_add_u32 v8, v17, 4, v8
    v_and_b32 v17, 1, v15
    v_lshl_add_u32 v8, v17, 3, v8
    v_lshrrev_b32 v17, 2, v15
    v_and_b32 v2, 1, v15
    v_lshl_add_u32 v2, v17, 1, v2
    v_mul_u32_u24 v9, 272, v2
    v_lshl_add_u32 v9, v16, 3, v9
    s_lshl_b32 s38, s19, 6
    s_add_u32 s38, s38, 4096
    v_add_u32 v9, s38, v9
    v_and_b32 v17, 7, v15
    v_mul_u32_u24 v10, 272, v17
    v_lshl_add_u32 v10, v16, 4, v10
    v_add_u32 v10, 4096, v10
    s_lshr_b32 s38, s19, 1
    s_lshl_b32 s38, s38, 14
    s_and_b32 s39, s19, 1
    s_lshl_b32 s39, s39, 12
    s_add_u32 s38, s38, s39
    v_add_u32 v90, s38, v1
    s_add_u32 s39, s38, 1024
    v_lshlrev_b32 v17, 3, v14
    v_add_u32 v91, s39, v17
    s_lshl_b32 s38, s19, 9
    s_add_u32 s39, s38, 6400
    v_add_u32 v98, s39, v17
    v_mov_b32 v169, 0
    v_mov_b32 v171, 0
    v_mov_b32 v173, 0
    s_cmp_eq_u32 s48, 0
    s_cbranch_scc1 L_noPinit_96
    buffer_store_dwordx4 v[100:103], v5, s[8:11], 0 offen offset:0
    buffer_store_dwordx4 v[100:103], v5, s[8:11], 0 offen offset:1024
    buffer_store_dwordx4 v[100:103], v5, s[8:11], 0 offen offset:2048
    buffer_store_dwordx4 v[100:103], v5, s[8:11], 0 offen offset:3072
L_noPinit_96:
    s_lshl_b32 s38, s17, 1
    s_xor_b32 s39, s18, 1
    s_add_u32 s39, s38, s39
    s_lshl_b32 s39, s39, 15
    s_add_u32 s25, s39, s42
    s_add_u32 s39, s38, s18
    s_lshl_b32 s39, s39, 15
    s_add_u32 s24, s39, s42
    s_add_u32 s38, s25, 0
    buffer_store_dwordx4 v[100:103], v90, s[8:11], s38 offen sc1
    buffer_store_dwordx2 v[100:101], v91, s[8:11], s38 offen sc1
    s_add_u32 s38, s25, 2048
    buffer_store_dwordx4 v[100:103], v90, s[8:11], s38 offen sc1
    buffer_store_dwordx2 v[100:101], v91, s[8:11], s38 offen sc1
    s_add_u32 s38, s25, 8192
    buffer_store_dwordx4 v[100:103], v90, s[8:11], s38 offen sc1
    buffer_store_dwordx2 v[100:101], v91, s[8:11], s38 offen sc1
    s_add_u32 s38, s25, 10240
    buffer_store_dwordx4 v[100:103], v90, s[8:11], s38 offen sc1
    buffer_store_dwordx2 v[100:101], v91, s[8:11], s38 offen sc1
    s_mov_b32 s71, s25
    s_mov_b32 s70, s24
    s_cmp_lg_u32 s19, 3
    s_cbranch_scc1 L_noMinit_97
    s_cmp_ge_u32 s17, 5
    s_cbranch_scc1 L_noMinit_97
    s_load_dwordx2 s[4:5], s[0:1], 8
    s_waitcnt lgkmcnt(0)
    s_mov_b32 s12, s4
    s_mov_b32 s13, s5
    s_mov_b32 s14, 10240
    s_mov_b32 s15, 0x20000
    s_lshl_b32 s39, s17, 6
    v_add_u32 v17, s39, v14
    v_mul_u32_u24 v2, 52429, v17
    v_lshrrev_b32 v2, 21, v2
    v_mul_u32_u24 v99, 40, v2
    v_sub_u32 v99, v17, v99
    v_mul_u32_u24 v2, 1280, v2
    v_lshl_add_u32 v2, v99, 4, v2
    s_mul_i32 s38, s18, 640
    buffer_load_dwordx4 v[20:23], v2, s[12:15], s38 offen
    s_lshl_b32 s39, s17, 10
    s_add_u32 s39, s39, s44
    s_add_u32 s40, s39, 8192
    s_add_u32 s41, s39, 16384
    buffer_store_dwordx4 v[100:103], v1, s[8:11], s40 offen
    buffer_store_dwordx4 v[100:103], v1, s[8:11], s41 offen
    s_waitcnt vmcnt(2)
    buffer_store_dwordx4 v[20:23], v1, s[8:11], s39 offen
L_noMinit_97:
    s_waitcnt vmcnt(0)
    s_barrier
    s_cmp_lg_u32 s19, 0
    s_cbranch_scc1 L_noinit_98
    v_mov_b32 v17, 32
    v_mov_b32 v2, 1
    s_mov_b64 exec, 1
    buffer_atomic_add v2, v17, s[52:55], 0 offen
    s_mov_b64 exec, -1
L_noinit_98:
    s_mul_i32 s40, s19, 40960
    v_lshrrev_b32 v17, 2, v14
    v_lshlrev_b32 v17, 13, v17
    v_and_b32 v2, 3, v14
    v_lshl_add_u32 v17, v2, 4, v17
    s_mul_i32 s38, s18, 2621440
    s_lshl_b32 s39, s17, 8
    s_add_u32 s38, s38, s39
    s_lshl_b32 s39, s19, 6
    s_add_u32 s38, s38, s39
    v_lshrrev_b32 v2, 1, v16
    v_lshlrev_b32 v2, 3, v2
    v_and_b32 v99, 1, v16
    v_lshl_add_u32 v2, v99, 2, v2
    v_bfe_u32 v99, v15, 2, 1
    v_add_u32 v22, v2, v99
    v_bfe_u32 v99, v15, 3, 1
    v_lshlrev_b32 v2, 5, v99
    v_and_b32 v99, 3, v15
    v_lshl_add_u32 v23, v99, 3, v2
    v_lshl_add_u32 v20, v22, 6, v23
    v_add_u32 v21, s40, v20
    s_load_dwordx2 s[4:5], s[0:1], 16
    s_waitcnt lgkmcnt(0)
    s_mov_b32 s12, s4
    s_mov_b32 s13, s5
    s_mov_b32 s14, 5242880
    s_mov_b32 s15, 0x20000
    s_add_u32 m0, s40, 0
    s_add_u32 s39, s38, 0
    buffer_load_dwordx4 v17, s[12:15], s39 offen lds
    s_add_u32 m0, s40, 1024
    s_add_u32 s39, s38, 131072
    buffer_load_dwordx4 v17, s[12:15], s39 offen lds
    s_add_u32 m0, s40, 2048
    s_add_u32 s39, s38, 262144
    buffer_load_dwordx4 v17, s[12:15], s39 offen lds
    s_add_u32 m0, s40, 3072
    s_add_u32 s39, s38, 393216
    buffer_load_dwordx4 v17, s[12:15], s39 offen lds
    s_add_u32 m0, s40, 4096
    s_add_u32 s39, s38, 524288
    buffer_load_dwordx4 v17, s[12:15], s39 offen lds
    s_add_u32 m0, s40, 5120
    s_add_u32 s39, s38, 655360
    buffer_load_dwordx4 v17, s[12:15], s39 offen lds
    s_add_u32 m0, s40, 6144
    s_add_u32 s39, s38, 786432
    buffer_load_dwordx4 v17, s[12:15], s39 offen lds
    s_add_u32 m0, s40, 7168
    s_add_u32 s39, s38, 917504
    buffer_load_dwordx4 v17, s[12:15], s39 offen lds
    s_add_u32 m0, s40, 8192
    s_add_u32 s39, s38, 1048576
    buffer_load_dwordx4 v17, s[12:15], s39 offen lds
    s_add_u32 m0, s40, 9216
    s_add_u32 s39, s38, 1179648
    buffer_load_dwordx4 v17, s[12:15], s39 offen lds
    s_add_u32 m0, s40, 10240
    s_add_u32 s39, s38, 1310720
    buffer_load_dwordx4 v17, s[12:15], s39 offen lds
    s_add_u32 m0, s40, 11264
    s_add_u32 s39, s38, 1441792
    buffer_load_dwordx4 v17, s[12:15], s39 offen lds
    s_add_u32 m0, s40, 12288
    s_add_u32 s39, s38, 1572864
    buffer_load_dwordx4 v17, s[12:15], s39 offen lds
    s_add_u32 m0, s40, 13312
    s_add_u32 s39, s38, 1703936
    buffer_load_dwordx4 v17, s[12:15], s39 offen lds
    s_add_u32 m0, s40, 14336
    s_add_u32 s39, s38, 1835008
    buffer_load_dwordx4 v17, s[12:15], s39 offen lds
    s_add_u32 m0, s40, 15360
    s_add_u32 s39, s38, 1966080
    buffer_load_dwordx4 v17, s[12:15], s39 offen lds
    s_add_u32 m0, s40, 16384
    s_add_u32 s39, s38, 2097152
    buffer_load_dwordx4 v17, s[12:15], s39 offen lds
    s_add_u32 m0, s40, 17408
    s_add_u32 s39, s38, 2228224
    buffer_load_dwordx4 v17, s[12:15], s39 offen lds
    s_add_u32 m0, s40, 18432
    s_add_u32 s39, s38, 2359296
    buffer_load_dwordx4 v17, s[12:15], s39 offen lds
    s_add_u32 m0, s40, 19456
    s_add_u32 s39, s38, 2490368
    buffer_load_dwordx4 v17, s[12:15], s39 offen lds
    s_load_dwordx2 s[4:5], s[0:1], 24
    s_waitcnt lgkmcnt(0)
    s_mov_b32 s12, s4
    s_mov_b32 s13, s5
    s_mov_b32 s14, 5242880
    s_mov_b32 s15, 0x20000
    s_add_u32 m0, s40, 20480
    s_add_u32 s39, s38, 0
    buffer_load_dwordx4 v17, s[12:15], s39 offen lds
    s_add_u32 m0, s40, 21504
    s_add_u32 s39, s38, 131072
    buffer_load_dwordx4 v17, s[12:15], s39 offen lds
    s_add_u32 m0, s40, 22528
    s_add_u32 s39, s38, 262144
    buffer_load_dwordx4 v17, s[12:15], s39 offen lds
    s_add_u32 m0, s40, 23552
    s_add_u32 s39, s38, 393216
    buffer_load_dwordx4 v17, s[12:15], s39 offen lds
    s_add_u32 m0, s40, 24576
    s_add_u32 s39, s38, 524288
    buffer_load_dwordx4 v17, s[12:15], s39 offen lds
    s_add_u32 m0, s40, 25600
    s_add_u32 s39, s38, 655360
    buffer_load_dwordx4 v17, s[12:15], s39 offen lds
    s_add_u32 m0, s40, 26624
    s_add_u32 s39, s38, 786432
    buffer_load_dwordx4 v17, s[12:15], s39 offen lds
    s_add_u32 m0, s40, 27648
    s_add_u32 s39, s38, 917504
    buffer_load_dwordx4 v17, s[12:15], s39 offen lds
    s_add_u32 m0, s40, 28672
    s_add_u32 s39, s38, 1048576
    buffer_load_dwordx4 v17, s[12:15], s39 offen lds
    s_add_u32 m0, s40, 29696
    s_add_u32 s39, s38, 1179648
    buffer_load_dwordx4 v17, s[12:15], s39 offen lds
    s_add_u32 m0, s40, 30720
    s_add_u32 s39, s38, 1310720
    buffer_load_dwordx4 v17, s[12:15], s39 offen lds
    s_add_u32 m0, s40, 31744
    s_add_u32 s39, s38, 1441792
    buffer_load_dwordx4 v17, s[12:15], s39 offen lds
    s_add_u32 m0, s40, 32768
    s_add_u32 s39, s38, 1572864
    buffer_load_dwordx4 v17, s[12:15], s39 offen lds
    s_add_u32 m0, s40, 33792
    s_add_u32 s39, s38, 1703936
    buffer_load_dwordx4 v17, s[12:15], s39 offen lds
    s_add_u32 m0, s40, 34816
    s_add_u32 s39, s38, 1835008
    buffer_load_dwordx4 v17, s[12:15], s39 offen lds
    s_add_u32 m0, s40, 35840
    s_add_u32 s39, s38, 1966080
    buffer_load_dwordx4 v17, s[12:15], s39 offen lds
    s_add_u32 m0, s40, 36864
    s_add_u32 s39, s38, 2097152
    buffer_load_dwordx4 v17, s[12:15], s39 offen lds
    s_add_u32 m0, s40, 37888
    s_add_u32 s39, s38, 2228224
    buffer_load_dwordx4 v17, s[12:15], s39 offen lds
    s_add_u32 m0, s40, 38912
    s_add_u32 s39, s38, 2359296
    buffer_load_dwordx4 v17, s[12:15], s39 offen lds
    s_add_u32 m0, s40, 39936
    s_add_u32 s39, s38, 2490368
    buffer_load_dwordx4 v17, s[12:15], s39 offen lds
    s_waitcnt vmcnt(20)
    ds_read_b64_tr_b16 a[0:1], v21 offset:0
    ds_read_b64_tr_b16 a[2:3], v21 offset:128
    ds_read_b64_tr_b16 a[4:5], v21 offset:1024
    ds_read_b64_tr_b16 a[6:7], v21 offset:1152
    ds_read_b64_tr_b16 a[8:9], v21 offset:2048
    ds_read_b64_tr_b16 a[10:11], v21 offset:2176
    ds_read_b64_tr_b16 a[12:13], v21 offset:3072
    ds_read_b64_tr_b16 a[14:15], v21 offset:3200
    ds_read_b64_tr_b16 a[16:17], v21 offset:4096
    ds_read_b64_tr_b16 a[18:19], v21 offset:4224
    ds_read_b64_tr_b16 a[20:21], v21 offset:5120
    ds_read_b64_tr_b16 a[22:23], v21 offset:5248
    ds_read_b64_tr_b16 a[24:25], v21 offset:6144
    ds_read_b64_tr_b16 a[26:27], v21 offset:6272
    ds_read_b64_tr_b16 a[28:29], v21 offset:7168
    ds_read_b64_tr_b16 a[30:31], v21 offset:7296
    ds_read_b64_tr_b16 a[32:33], v21 offset:8192
    ds_read_b64_tr_b16 a[34:35], v21 offset:8320
    ds_read_b64_tr_b16 a[36:37], v21 offset:9216
    ds_read_b64_tr_b16 a[38:39], v21 offset:9344
    ds_read_b64_tr_b16 a[40:41], v21 offset:10240
    ds_read_b64_tr_b16 a[42:43], v21 offset:10368
    ds_read_b64_tr_b16 a[44:45], v21 offset:11264
    ds_read_b64_tr_b16 a[46:47], v21 offset:11392
    ds_read_b64_tr_b16 a[48:49], v21 offset:12288
    ds_read_b64_tr_b16 a[50:51], v21 offset:12416
    ds_read_b64_tr_b16 a[52:53], v21 offset:13312
    ds_read_b64_tr_b16 a[54:55], v21 offset:13440
    ds_read_b64_tr_b16 a[56:57], v21 offset:14336
    ds_read_b64_tr_b16 a[58:59], v21 offset:14464
    ds_read_b64_tr_b16 a[60:61], v21 offset:15360
    ds_read_b64_tr_b16 a[62:63], v21 offset:15488
    ds_read_b64_tr_b16 a[64:65], v21 offset:16384
    ds_read_b64_tr_b16 a[66:67], v21 offset:16512
    ds_read_b64_tr_b16 a[68:69], v21 offset:17408
    ds_read_b64_tr_b16 a[70:71], v21 offset:17536
    ds_read_b64_tr_b16 a[72:73], v21 offset:18432
    ds_read_b64_tr_b16 a[74:75], v21 offset:18560
    ds_read_b64_tr_b16 a[76:77], v21 offset:19456
    ds_read_b64_tr_b16 a[78:79], v21 offset:19584
    s_waitcnt vmcnt(0)
    ds_read_b64_tr_b16 a[80:81], v21 offset:20480
    ds_read_b64_tr_b16 a[82:83], v21 offset:20608
    ds_read_b64_tr_b16 a[84:85], v21 offset:21504
    ds_read_b64_tr_b16 a[86:87], v21 offset:21632
    ds_read_b64_tr_b16 a[88:89], v21 offset:22528
    ds_read_b64_tr_b16 a[90:91], v21 offset:22656
    ds_read_b64_tr_b16 a[92:93], v21 offset:23552
    ds_read_b64_tr_b16 a[94:95], v21 offset:23680
    ds_read_b64_tr_b16 a[96:97], v21 offset:24576
    ds_read_b64_tr_b16 a[98:99], v21 offset:24704
    ds_read_b64_tr_b16 a[100:101], v21 offset:25600
    ds_read_b64_tr_b16 a[102:103], v21 offset:25728
    ds_read_b64_tr_b16 a[104:105], v21 offset:26624
    ds_read_b64_tr_b16 a[106:107], v21 offset:26752
    ds_read_b64_tr_b16 a[108:109], v21 offset:27648
    ds_read_b64_tr_b16 a[110:111], v21 offset:27776
    ds_read_b64_tr_b16 a[112:113], v21 offset:28672
    ds_read_b64_tr_b16 a[114:115], v21 offset:28800
    ds_read_b64_tr_b16 a[116:117], v21 offset:29696
    ds_read_b64_tr_b16 a[118:119], v21 offset:29824
    ds_read_b64_tr_b16 a[120:121], v21 offset:30720
    ds_read_b64_tr_b16 a[122:123], v21 offset:30848
    ds_read_b64_tr_b16 a[124:125], v21 offset:31744
    ds_read_b64_tr_b16 a[126:127], v21 offset:31872
    ds_read_b64_tr_b16 a[128:129], v21 offset:32768
    ds_read_b64_tr_b16 a[130:131], v21 offset:32896
    ds_read_b64_tr_b16 a[132:133], v21 offset:33792
    ds_read_b64_tr_b16 a[134:135], v21 offset:33920
    ds_read_b64_tr_b16 a[136:137], v21 offset:34816
    ds_read_b64_tr_b16 a[138:139], v21 offset:34944
    ds_read_b64_tr_b16 a[140:141], v21 offset:35840
    ds_read_b64_tr_b16 a[142:143], v21 offset:35968
    ds_read_b64_tr_b16 a[144:145], v21 offset:36864
    ds_read_b64_tr_b16 a[146:147], v21 offset:36992
    ds_read_b64_tr_b16 a[148:149], v21 offset:37888
    ds_read_b64_tr_b16 a[150:151], v21 offset:38016
    ds_read_b64_tr_b16 a[152:153], v21 offset:38912
    ds_read_b64_tr_b16 a[154:155], v21 offset:39040
    ds_read_b64_tr_b16 a[156:157], v21 offset:39936
    ds_read_b64_tr_b16 a[158:159], v21 offset:40064
    s_waitcnt lgkmcnt(0)
    s_barrier
    s_mul_i32 s40, s19, 45056
    s_cmp_eq_u32 s19, 3
    s_cselect_b32 s40, 126976, s40
    v_add_u32 v21, s40, v20
    s_load_dwordx2 s[4:5], s[0:1], 32
    s_waitcnt lgkmcnt(0)
    s_mov_b32 s12, s4
    s_mov_b32 s13, s5
    s_mov_b32 s14, 5242880
    s_mov_b32 s15, 0x20000
    s_add_u32 m0, s40, 0
    s_add_u32 s39, s38, 0
    buffer_load_dwordx4 v17, s[12:15], s39 offen lds
    s_add_u32 m0, s40, 1024
    s_add_u32 s39, s38, 131072
    buffer_load_dwordx4 v17, s[12:15], s39 offen lds
    s_add_u32 m0, s40, 2048
    s_add_u32 s39, s38, 262144
    buffer_load_dwordx4 v17, s[12:15], s39 offen lds
    s_add_u32 m0, s40, 3072
    s_add_u32 s39, s38, 393216
    buffer_load_dwordx4 v17, s[12:15], s39 offen lds
    s_add_u32 m0, s40, 4096
    s_add_u32 s39, s38, 524288
    buffer_load_dwordx4 v17, s[12:15], s39 offen lds
    s_add_u32 m0, s40, 5120
    s_add_u32 s39, s38, 655360
    buffer_load_dwordx4 v17, s[12:15], s39 offen lds
    s_add_u32 m0, s40, 6144
    s_add_u32 s39, s38, 786432
    buffer_load_dwordx4 v17, s[12:15], s39 offen lds
    s_add_u32 m0, s40, 7168
    s_add_u32 s39, s38, 917504
    buffer_load_dwordx4 v17, s[12:15], s39 offen lds
    s_add_u32 m0, s40, 8192
    s_add_u32 s39, s38, 1048576
    buffer_load_dwordx4 v17, s[12:15], s39 offen lds
    s_add_u32 m0, s40, 9216
    s_add_u32 s39, s38, 1179648
    buffer_load_dwordx4 v17, s[12:15], s39 offen lds
    s_add_u32 m0, s40, 10240
    s_add_u32 s39, s38, 1310720
    buffer_load_dwordx4 v17, s[12:15], s39 offen lds
    s_add_u32 m0, s40, 11264
    s_add_u32 s39, s38, 1441792
    buffer_load_dwordx4 v17, s[12:15], s39 offen lds
    s_add_u32 m0, s40, 12288
    s_add_u32 s39, s38, 1572864
    buffer_load_dwordx4 v17, s[12:15], s39 offen lds
    s_add_u32 m0, s40, 13312
    s_add_u32 s39, s38, 1703936
    buffer_load_dwordx4 v17, s[12:15], s39 offen lds
    s_add_u32 m0, s40, 14336
    s_add_u32 s39, s38, 1835008
    buffer_load_dwordx4 v17, s[12:15], s39 offen lds
    s_add_u32 m0, s40, 15360
    s_add_u32 s39, s38, 1966080
    buffer_load_dwordx4 v17, s[12:15], s39 offen lds
    s_add_u32 m0, s40, 16384
    s_add_u32 s39, s38, 2097152
    buffer_load_dwordx4 v17, s[12:15], s39 offen lds
    s_add_u32 m0, s40, 17408
    s_add_u32 s39, s38, 2228224
    buffer_load_dwordx4 v17, s[12:15], s39 offen lds
    s_add_u32 m0, s40, 18432
    s_add_u32 s39, s38, 2359296
    buffer_load_dwordx4 v17, s[12:15], s39 offen lds
    s_add_u32 m0, s40, 19456
    s_add_u32 s39, s38, 2490368
    buffer_load_dwordx4 v17, s[12:15], s39 offen lds
    s_load_dwordx2 s[4:5], s[0:1], 40
    s_waitcnt lgkmcnt(0)
    s_mov_b32 s12, s4
    s_mov_b32 s13, s5
    s_mov_b32 s14, 5242880
    s_mov_b32 s15, 0x20000
    s_mul_i32 s38, s17, 163840
    s_mul_i32 s39, s18, 640
    s_add_u32 s38, s38, s39
    s_mul_i32 s39, s19, 192
    s_min_u32 s39, s39, 512
    s_add_u32 s38, s38, s39
    s_cmp_ge_u32 s19, 2
    s_cbranch_scc1 L_wo2_99
    v_add_u32 v17, 0, v14
    v_mul_u32_u24 v2, 43691, v17
    v_lshrrev_b32 v2, 19, v2
    v_mul_u32_u24 v99, 12, v2
    v_sub_u32 v99, v17, v99
    v_mul_u32_u24 v2, 1280, v2
    v_lshl_add_u32 v2, v99, 4, v2
    s_add_u32 m0, s40, 20480
    s_nop 0
    buffer_load_dwordx4 v2, s[12:15], s38 offen lds
    v_add_u32 v17, 64, v14
    v_mul_u32_u24 v2, 43691, v17
    v_lshrrev_b32 v2, 19, v2
    v_mul_u32_u24 v99, 12, v2
    v_sub_u32 v99, v17, v99
    v_mul_u32_u24 v2, 1280, v2
    v_lshl_add_u32 v2, v99, 4, v2
    s_add_u32 m0, s40, 21504
    s_nop 0
    buffer_load_dwordx4 v2, s[12:15], s38 offen lds
    v_add_u32 v17, 128, v14
    v_mul_u32_u24 v2, 43691, v17
    v_lshrrev_b32 v2, 19, v2
    v_mul_u32_u24 v99, 12, v2
    v_sub_u32 v99, v17, v99
    v_mul_u32_u24 v2, 1280, v2
    v_lshl_add_u32 v2, v99, 4, v2
    s_add_u32 m0, s40, 22528
    s_nop 0
    buffer_load_dwordx4 v2, s[12:15], s38 offen lds
    v_add_u32 v17, 192, v14
    v_mul_u32_u24 v2, 43691, v17
    v_lshrrev_b32 v2, 19, v2
    v_mul_u32_u24 v99, 12, v2
    v_sub_u32 v99, v17, v99
    v_mul_u32_u24 v2, 1280, v2
    v_lshl_add_u32 v2, v99, 4, v2
    s_add_u32 m0, s40, 23552
    s_nop 0
    buffer_load_dwordx4 v2, s[12:15], s38 offen lds
    v_add_u32 v17, 256, v14
    v_mul_u32_u24 v2, 43691, v17
    v_lshrrev_b32 v2, 19, v2
    v_mul_u32_u24 v99, 12, v2
    v_sub_u32 v99, v17, v99
    v_mul_u32_u24 v2, 1280, v2
    v_lshl_add_u32 v2, v99, 4, v2
    s_add_u32 m0, s40, 24576
    s_nop 0
    buffer_load_dwordx4 v2, s[12:15], s38 offen lds
    v_add_u32 v17, 320, v14
    v_mul_u32_u24 v2, 43691, v17
    v_lshrrev_b32 v2, 19, v2
    v_mul_u32_u24 v99, 12, v2
    v_sub_u32 v99, v17, v99
    v_mul_u32_u24 v2, 1280, v2
    v_lshl_add_u32 v2, v99, 4, v2
    s_add_u32 m0, s40, 25600
    s_nop 0
    buffer_load_dwordx4 v2, s[12:15], s38 offen lds
    v_add_u32 v17, 384, v14
    v_mul_u32_u24 v2, 43691, v17
    v_lshrrev_b32 v2, 19, v2
    v_mul_u32_u24 v99, 12, v2
    v_sub_u32 v99, v17, v99
    v_mul_u32_u24 v2, 1280, v2
    v_lshl_add_u32 v2, v99, 4, v2
    s_add_u32 m0, s40, 26624
    s_nop 0
    buffer_load_dwordx4 v2, s[12:15], s38 offen lds
    v_add_u32 v17, 448, v14
    v_mul_u32_u24 v2, 43691, v17
    v_lshrrev_b32 v2, 19, v2
    v_mul_u32_u24 v99, 12, v2
    v_sub_u32 v99, v17, v99
    v_mul_u32_u24 v2, 1280, v2
    v_lshl_add_u32 v2, v99, 4, v2
    s_add_u32 m0, s40, 27648
    s_nop 0
    buffer_load_dwordx4 v2, s[12:15], s38 offen lds
    v_add_u32 v17, 512, v14
    v_mul_u32_u24 v2, 43691, v17
    v_lshrrev_b32 v2, 19, v2
    v_mul_u32_u24 v99, 12, v2
    v_sub_u32 v99, v17, v99
    v_mul_u32_u24 v2, 1280, v2
    v_lshl_add_u32 v2, v99, 4, v2
    s_add_u32 m0, s40, 28672
    s_nop 0
    buffer_load_dwordx4 v2, s[12:15], s38 offen lds
    v_add_u32 v17, 576, v14
    v_mul_u32_u24 v2, 43691, v17
    v_lshrrev_b32 v2, 19, v2
    v_mul_u32_u24 v99, 12, v2
    v_sub_u32 v99, v17, v99
    v_mul_u32_u24 v2, 1280, v2
    v_lshl_add_u32 v2, v99, 4, v2
    s_add_u32 m0, s40, 29696
    s_nop 0
    buffer_load_dwordx4 v2, s[12:15], s38 offen lds
    v_add_u32 v17, 640, v14
    v_mul_u32_u24 v2, 43691, v17
    v_lshrrev_b32 v2, 19, v2
    v_mul_u32_u24 v99, 12, v2
    v_sub_u32 v99, v17, v99
    v_mul_u32_u24 v2, 1280, v2
    v_lshl_add_u32 v2, v99, 4, v2
    s_add_u32 m0, s40, 30720
    s_nop 0
    buffer_load_dwordx4 v2, s[12:15], s38 offen lds
    v_add_u32 v17, 704, v14
    v_mul_u32_u24 v2, 43691, v17
    v_lshrrev_b32 v2, 19, v2
    v_mul_u32_u24 v99, 12, v2
    v_sub_u32 v99, v17, v99
    v_mul_u32_u24 v2, 1280, v2
    v_lshl_add_u32 v2, v99, 4, v2
    s_add_u32 m0, s40, 31744
    s_nop 0
    buffer_load_dwordx4 v2, s[12:15], s38 offen lds
    v_add_u32 v17, 768, v14
    v_mul_u32_u24 v2, 43691, v17
    v_lshrrev_b32 v2, 19, v2
    v_mul_u32_u24 v99, 12, v2
    v_sub_u32 v99, v17, v99
    v_mul_u32_u24 v2, 1280, v2
    v_lshl_add_u32 v2, v99, 4, v2
    s_add_u32 m0, s40, 32768
    s_nop 0
    buffer_load_dwordx4 v2, s[12:15], s38 offen lds
    v_add_u32 v17, 832, v14
    v_mul_u32_u24 v2, 43691, v17
    v_lshrrev_b32 v2, 19, v2
    v_mul_u32_u24 v99, 12, v2
    v_sub_u32 v99, v17, v99
    v_mul_u32_u24 v2, 1280, v2
    v_lshl_add_u32 v2, v99, 4, v2
    s_add_u32 m0, s40, 33792
    s_nop 0
    buffer_load_dwordx4 v2, s[12:15], s38 offen lds
    v_add_u32 v17, 896, v14
    v_mul_u32_u24 v2, 43691, v17
    v_lshrrev_b32 v2, 19, v2
    v_mul_u32_u24 v99, 12, v2
    v_sub_u32 v99, v17, v99
    v_mul_u32_u24 v2, 1280, v2
    v_lshl_add_u32 v2, v99, 4, v2
    s_add_u32 m0, s40, 34816
    s_nop 0
    buffer_load_dwordx4 v2, s[12:15], s38 offen lds
    v_add_u32 v17, 960, v14
    v_mul_u32_u24 v2, 43691, v17
    v_lshrrev_b32 v2, 19, v2
    v_mul_u32_u24 v99, 12, v2
    v_sub_u32 v99, v17, v99
    v_mul_u32_u24 v2, 1280, v2
    v_lshl_add_u32 v2, v99, 4, v2
    s_add_u32 m0, s40, 35840
    s_nop 0
    buffer_load_dwordx4 v2, s[12:15], s38 offen lds
    v_add_u32 v17, 1024, v14
    v_mul_u32_u24 v2, 43691, v17
    v_lshrrev_b32 v2, 19, v2
    v_mul_u32_u24 v99, 12, v2
    v_sub_u32 v99, v17, v99
    v_mul_u32_u24 v2, 1280, v2
    v_lshl_add_u32 v2, v99, 4, v2
    s_add_u32 m0, s40, 36864
    s_nop 0
    buffer_load_dwordx4 v2, s[12:15], s38 offen lds
    v_add_u32 v17, 1088, v14
    v_mul_u32_u24 v2, 43691, v17
    v_lshrrev_b32 v2, 19, v2
    v_mul_u32_u24 v99, 12, v2
    v_sub_u32 v99, v17, v99
    v_mul_u32_u24 v2, 1280, v2
    v_lshl_add_u32 v2, v99, 4, v2
    s_add_u32 m0, s40, 37888
    s_nop 0
    buffer_load_dwordx4 v2, s[12:15], s38 offen lds
    v_add_u32 v17, 1152, v14
    v_mul_u32_u24 v2, 43691, v17
    v_lshrrev_b32 v2, 19, v2
    v_mul_u32_u24 v99, 12, v2
    v_sub_u32 v99, v17, v99
    v_mul_u32_u24 v2, 1280, v2
    v_lshl_add_u32 v2, v99, 4, v2
    s_add_u32 m0, s40, 38912
    s_nop 0
    buffer_load_dwordx4 v2, s[12:15], s38 offen lds
    v_add_u32 v17, 1216, v14
    v_mul_u32_u24 v2, 43691, v17
    v_lshrrev_b32 v2, 19, v2
    v_mul_u32_u24 v99, 12, v2
    v_sub_u32 v99, v17, v99
    v_mul_u32_u24 v2, 1280, v2
    v_lshl_add_u32 v2, v99, 4, v2
    s_add_u32 m0, s40, 39936
    s_nop 0
    buffer_load_dwordx4 v2, s[12:15], s38 offen lds
    v_add_u32 v17, 1280, v14
    v_mul_u32_u24 v2, 43691, v17
    v_lshrrev_b32 v2, 19, v2
    v_mul_u32_u24 v99, 12, v2
    v_sub_u32 v99, v17, v99
    v_mul_u32_u24 v2, 1280, v2
    v_lshl_add_u32 v2, v99, 4, v2
    s_add_u32 m0, s40, 40960
    s_nop 0
    buffer_load_dwordx4 v2, s[12:15], s38 offen lds
    v_add_u32 v17, 1344, v14
    v_mul_u32_u24 v2, 43691, v17
    v_lshrrev_b32 v2, 19, v2
    v_mul_u32_u24 v99, 12, v2
    v_sub_u32 v99, v17, v99
    v_mul_u32_u24 v2, 1280, v2
    v_lshl_add_u32 v2, v99, 4, v2
    s_add_u32 m0, s40, 41984
    s_nop 0
    buffer_load_dwordx4 v2, s[12:15], s38 offen lds
    v_add_u32 v17, 1408, v14
    v_mul_u32_u24 v2, 43691, v17
    v_lshrrev_b32 v2, 19, v2
    v_mul_u32_u24 v99, 12, v2
    v_sub_u32 v99, v17, v99
    v_mul_u32_u24 v2, 1280, v2
    v_lshl_add_u32 v2, v99, 4, v2
    s_add_u32 m0, s40, 43008
    s_nop 0
    buffer_load_dwordx4 v2, s[12:15], s38 offen lds
    v_add_u32 v17, 1472, v14
    v_mul_u32_u24 v2, 43691, v17
    v_lshrrev_b32 v2, 19, v2
    v_mul_u32_u24 v99, 12, v2
    v_sub_u32 v99, v17, v99
    v_mul_u32_u24 v2, 1280, v2
    v_lshl_add_u32 v2, v99, 4, v2
    s_add_u32 m0, s40, 44032
    s_nop 0
    buffer_load_dwordx4 v2, s[12:15], s38 offen lds
    s_waitcnt vmcnt(24)
    ds_read_b64_tr_b16 a[160:161], v21 offset:0
    ds_read_b64_tr_b16 a[162:163], v21 offset:128
    ds_read_b64_tr_b16 a[164:165], v21 offset:1024
    ds_read_b64_tr_b16 a[166:167], v21 offset:1152
    ds_read_b64_tr_b16 a[168:169], v21 offset:2048
    ds_read_b64_tr_b16 a[170:171], v21 offset:2176
    ds_read_b64_tr_b16 a[172:173], v21 offset:3072
    ds_read_b64_tr_b16 a[174:175], v21 offset:3200
    ds_read_b64_tr_b16 a[176:177], v21 offset:4096
    ds_read_b64_tr_b16 a[178:179], v21 offset:4224
    ds_read_b64_tr_b16 a[180:181], v21 offset:5120
    ds_read_b64_tr_b16 a[182:183], v21 offset:5248
    ds_read_b64_tr_b16 a[184:185], v21 offset:6144
    ds_read_b64_tr_b16 a[186:187], v21 offset:6272
    ds_read_b64_tr_b16 a[188:189], v21 offset:7168
    ds_read_b64_tr_b16 a[190:191], v21 offset:7296
    ds_read_b64_tr_b16 a[192:193], v21 offset:8192
    ds_read_b64_tr_b16 a[194:195], v21 offset:8320
    ds_read_b64_tr_b16 a[196:197], v21 offset:9216
    ds_read_b64_tr_b16 a[198:199], v21 offset:9344
    ds_read_b64_tr_b16 a[200:201], v21 offset:10240
    ds_read_b64_tr_b16 a[202:203], v21 offset:10368
    ds_read_b64_tr_b16 a[204:205], v21 offset:11264
    ds_read_b64_tr_b16 a[206:207], v21 offset:11392
    ds_read_b64_tr_b16 a[208:209], v21 offset:12288
    ds_read_b64_tr_b16 a[210:211], v21 offset:12416
    ds_read_b64_tr_b16 a[212:213], v21 offset:13312
    ds_read_b64_tr_b16 a[214:215], v21 offset:13440
    ds_read_b64_tr_b16 a[216:217], v21 offset:14336
    ds_read_b64_tr_b16 a[218:219], v21 offset:14464
    ds_read_b64_tr_b16 a[220:221], v21 offset:15360
    ds_read_b64_tr_b16 a[222:223], v21 offset:15488
    ds_read_b64_tr_b16 a[224:225], v21 offset:16384
    ds_read_b64_tr_b16 a[226:227], v21 offset:16512
    ds_read_b64_tr_b16 a[228:229], v21 offset:17408
    ds_read_b64_tr_b16 a[230:231], v21 offset:17536
    ds_read_b64_tr_b16 a[232:233], v21 offset:18432
    ds_read_b64_tr_b16 a[234:235], v21 offset:18560
    ds_read_b64_tr_b16 a[236:237], v21 offset:19456
    ds_read_b64_tr_b16 a[238:239], v21 offset:19584
    v_mul_u32_u24 v2, 192, v22
    v_add_u32 v2, v2, v23
    v_add_u32 v2, s40, v2
    s_waitcnt vmcnt(0)
    ds_read_b64_tr_b16 a[240:241], v2 offset:20480
    ds_read_b64_tr_b16 a[242:243], v2 offset:20864
    ds_read_b64_tr_b16 a[244:245], v2 offset:23552
    ds_read_b64_tr_b16 a[246:247], v2 offset:23936
    ds_read_b64_tr_b16 a[248:249], v2 offset:26624
    ds_read_b64_tr_b16 a[250:251], v2 offset:27008
    ds_read_b64_tr_b16 a[252:253], v2 offset:29696
    ds_read_b64_tr_b16 a[254:255], v2 offset:30080
    ds_read_b64_tr_b16 v[176:177], v2 offset:32768
    ds_read_b64_tr_b16 v[178:179], v2 offset:33152
    ds_read_b64_tr_b16 v[180:181], v2 offset:35840
    ds_read_b64_tr_b16 v[182:183], v2 offset:36224
    ds_read_b64_tr_b16 v[184:185], v2 offset:38912
    ds_read_b64_tr_b16 v[186:187], v2 offset:39296
    ds_read_b64_tr_b16 v[188:189], v2 offset:41984
    ds_read_b64_tr_b16 v[190:191], v2 offset:42368
    ds_read_b64_tr_b16 v[192:193], v2 offset:20544
    ds_read_b64_tr_b16 v[194:195], v2 offset:20928
    ds_read_b64_tr_b16 v[196:197], v2 offset:23616
    ds_read_b64_tr_b16 v[198:199], v2 offset:24000
    ds_read_b64_tr_b16 v[200:201], v2 offset:26688
    ds_read_b64_tr_b16 v[202:203], v2 offset:27072
    ds_read_b64_tr_b16 v[204:205], v2 offset:29760
    ds_read_b64_tr_b16 v[206:207], v2 offset:30144
    ds_read_b64_tr_b16 v[208:209], v2 offset:32832
    ds_read_b64_tr_b16 v[210:211], v2 offset:33216
    ds_read_b64_tr_b16 v[212:213], v2 offset:35904
    ds_read_b64_tr_b16 v[214:215], v2 offset:36288
    ds_read_b64_tr_b16 v[216:217], v2 offset:38976
    ds_read_b64_tr_b16 v[218:219], v2 offset:39360
    ds_read_b64_tr_b16 v[220:221], v2 offset:42048
    ds_read_b64_tr_b16 v[222:223], v2 offset:42432
    ds_read_b64_tr_b16 v[224:225], v2 offset:20608
    ds_read_b64_tr_b16 v[226:227], v2 offset:20992
    ds_read_b64_tr_b16 v[228:229], v2 offset:23680
    ds_read_b64_tr_b16 v[230:231], v2 offset:24064
    ds_read_b64_tr_b16 v[232:233], v2 offset:26752
    ds_read_b64_tr_b16 v[234:235], v2 offset:27136
    ds_read_b64_tr_b16 v[236:237], v2 offset:29824
    ds_read_b64_tr_b16 v[238:239], v2 offset:30208
    ds_read_b64_tr_b16 v[240:241], v2 offset:32896
    ds_read_b64_tr_b16 v[242:243], v2 offset:33280
    ds_read_b64_tr_b16 v[244:245], v2 offset:35968
    ds_read_b64_tr_b16 v[246:247], v2 offset:36352
    ds_read_b64_tr_b16 v[248:249], v2 offset:39040
    ds_read_b64_tr_b16 v[250:251], v2 offset:39424
    ds_read_b64_tr_b16 v[252:253], v2 offset:42112
    ds_read_b64_tr_b16 v[254:255], v2 offset:42496
    s_branch L_woe_100
L_wo2_99:
    v_add_u32 v17, 0, v14
    v_lshrrev_b32 v2, 3, v17
    v_and_b32 v99, 7, v17
    v_mul_u32_u24 v2, 1280, v2
    v_lshl_add_u32 v2, v99, 4, v2
    s_add_u32 m0, s40, 20480
    s_nop 0
    buffer_load_dwordx4 v2, s[12:15], s38 offen lds
    v_add_u32 v17, 64, v14
    v_lshrrev_b32 v2, 3, v17
    v_and_b32 v99, 7, v17
    v_mul_u32_u24 v2, 1280, v2
    v_lshl_add_u32 v2, v99, 4, v2
    s_add_u32 m0, s40, 21504
    s_nop 0
    buffer_load_dwordx4 v2, s[12:15], s38 offen lds
    v_add_u32 v17, 128, v14
    v_lshrrev_b32 v2, 3, v17
    v_and_b32 v99, 7, v17
    v_mul_u32_u24 v2, 1280, v2
    v_lshl_add_u32 v2, v99, 4, v2
    s_add_u32 m0, s40, 22528
    s_nop 0
    buffer_load_dwordx4 v2, s[12:15], s38 offen lds
    v_add_u32 v17, 192, v14
    v_lshrrev_b32 v2, 3, v17
    v_and_b32 v99, 7, v17
    v_mul_u32_u24 v2, 1280, v2
    v_lshl_add_u32 v2, v99, 4, v2
    s_add_u32 m0, s40, 23552
    s_nop 0
    buffer_load_dwordx4 v2, s[12:15], s38 offen lds
    v_add_u32 v17, 256, v14
    v_lshrrev_b32 v2, 3, v17
    v_and_b32 v99, 7, v17
    v_mul_u32_u24 v2, 1280, v2
    v_lshl_add_u32 v2, v99, 4, v2
    s_add_u32 m0, s40, 24576
    s_nop 0
    buffer_load_dwordx4 v2, s[12:15], s38 offen lds
    v_add_u32 v17, 320, v14
    v_lshrrev_b32 v2, 3, v17
    v_and_b32 v99, 7, v17
    v_mul_u32_u24 v2, 1280, v2
    v_lshl_add_u32 v2, v99, 4, v2
    s_add_u32 m0, s40, 25600
    s_nop 0
    buffer_load_dwordx4 v2, s[12:15], s38 offen lds
    v_add_u32 v17, 384, v14
    v_lshrrev_b32 v2, 3, v17
    v_and_b32 v99, 7, v17
    v_mul_u32_u24 v2, 1280, v2
    v_lshl_add_u32 v2, v99, 4, v2
    s_add_u32 m0, s40, 26624
    s_nop 0
    buffer_load_dwordx4 v2, s[12:15], s38 offen lds
    v_add_u32 v17, 448, v14
    v_lshrrev_b32 v2, 3, v17
    v_and_b32 v99, 7, v17
    v_mul_u32_u24 v2, 1280, v2
    v_lshl_add_u32 v2, v99, 4, v2
    s_add_u32 m0, s40, 27648
    s_nop 0
    buffer_load_dwordx4 v2, s[12:15], s38 offen lds
    v_add_u32 v17, 512, v14
    v_lshrrev_b32 v2, 3, v17
    v_and_b32 v99, 7, v17
    v_mul_u32_u24 v2, 1280, v2
    v_lshl_add_u32 v2, v99, 4, v2
    s_add_u32 m0, s40, 28672
    s_nop 0
    buffer_load_dwordx4 v2, s[12:15], s38 offen lds
    v_add_u32 v17, 576, v14
    v_lshrrev_b32 v2, 3, v17
    v_and_b32 v99, 7, v17
    v_mul_u32_u24 v2, 1280, v2
    v_lshl_add_u32 v2, v99, 4, v2
    s_add_u32 m0, s40, 29696
    s_nop 0
    buffer_load_dwordx4 v2, s[12:15], s38 offen lds
    v_add_u32 v17, 640, v14
    v_lshrrev_b32 v2, 3, v17
    v_and_b32 v99, 7, v17
    v_mul_u32_u24 v2, 1280, v2
    v_lshl_add_u32 v2, v99, 4, v2
    s_add_u32 m0, s40, 30720
    s_nop 0
    buffer_load_dwordx4 v2, s[12:15], s38 offen lds
    v_add_u32 v17, 704, v14
    v_lshrrev_b32 v2, 3, v17
    v_and_b32 v99, 7, v17
    v_mul_u32_u24 v2, 1280, v2
    v_lshl_add_u32 v2, v99, 4, v2
    s_add_u32 m0, s40, 31744
    s_nop 0
    buffer_load_dwordx4 v2, s[12:15], s38 offen lds
    v_add_u32 v17, 768, v14
    v_lshrrev_b32 v2, 3, v17
    v_and_b32 v99, 7, v17
    v_mul_u32_u24 v2, 1280, v2
    v_lshl_add_u32 v2, v99, 4, v2
    s_add_u32 m0, s40, 32768
    s_nop 0
    buffer_load_dwordx4 v2, s[12:15], s38 offen lds
    v_add_u32 v17, 832, v14
    v_lshrrev_b32 v2, 3, v17
    v_and_b32 v99, 7, v17
    v_mul_u32_u24 v2, 1280, v2
    v_lshl_add_u32 v2, v99, 4, v2
    s_add_u32 m0, s40, 33792
    s_nop 0
    buffer_load_dwordx4 v2, s[12:15], s38 offen lds
    v_add_u32 v17, 896, v14
    v_lshrrev_b32 v2, 3, v17
    v_and_b32 v99, 7, v17
    v_mul_u32_u24 v2, 1280, v2
    v_lshl_add_u32 v2, v99, 4, v2
    s_add_u32 m0, s40, 34816
    s_nop 0
    buffer_load_dwordx4 v2, s[12:15], s38 offen lds
    v_add_u32 v17, 960, v14
    v_lshrrev_b32 v2, 3, v17
    v_and_b32 v99, 7, v17
    v_mul_u32_u24 v2, 1280, v2
    v_lshl_add_u32 v2, v99, 4, v2
    s_add_u32 m0, s40, 35840
    s_nop 0
    buffer_load_dwordx4 v2, s[12:15], s38 offen lds
    s_waitcnt vmcnt(16)
    ds_read_b64_tr_b16 a[160:161], v21 offset:0
    ds_read_b64_tr_b16 a[162:163], v21 offset:128
    ds_read_b64_tr_b16 a[164:165], v21 offset:1024
    ds_read_b64_tr_b16 a[166:167], v21 offset:1152
    ds_read_b64_tr_b16 a[168:169], v21 offset:2048
    ds_read_b64_tr_b16 a[170:171], v21 offset:2176
    ds_read_b64_tr_b16 a[172:173], v21 offset:3072
    ds_read_b64_tr_b16 a[174:175], v21 offset:3200
    ds_read_b64_tr_b16 a[176:177], v21 offset:4096
    ds_read_b64_tr_b16 a[178:179], v21 offset:4224
    ds_read_b64_tr_b16 a[180:181], v21 offset:5120
    ds_read_b64_tr_b16 a[182:183], v21 offset:5248
    ds_read_b64_tr_b16 a[184:185], v21 offset:6144
    ds_read_b64_tr_b16 a[186:187], v21 offset:6272
    ds_read_b64_tr_b16 a[188:189], v21 offset:7168
    ds_read_b64_tr_b16 a[190:191], v21 offset:7296
    ds_read_b64_tr_b16 a[192:193], v21 offset:8192
    ds_read_b64_tr_b16 a[194:195], v21 offset:8320
    ds_read_b64_tr_b16 a[196:197], v21 offset:9216
    ds_read_b64_tr_b16 a[198:199], v21 offset:9344
    ds_read_b64_tr_b16 a[200:201], v21 offset:10240
    ds_read_b64_tr_b16 a[202:203], v21 offset:10368
    ds_read_b64_tr_b16 a[204:205], v21 offset:11264
    ds_read_b64_tr_b16 a[206:207], v21 offset:11392
    ds_read_b64_tr_b16 a[208:209], v21 offset:12288
    ds_read_b64_tr_b16 a[210:211], v21 offset:12416
    ds_read_b64_tr_b16 a[212:213], v21 offset:13312
    ds_read_b64_tr_b16 a[214:215], v21 offset:13440
    ds_read_b64_tr_b16 a[216:217], v21 offset:14336
    ds_read_b64_tr_b16 a[218:219], v21 offset:14464
    ds_read_b64_tr_b16 a[220:221], v21 offset:15360
    ds_read_b64_tr_b16 a[222:223], v21 offset:15488
    ds_read_b64_tr_b16 a[224:225], v21 offset:16384
    ds_read_b64_tr_b16 a[226:227], v21 offset:16512
    ds_read_b64_tr_b16 a[228:229], v21 offset:17408
    ds_read_b64_tr_b16 a[230:231], v21 offset:17536
    ds_read_b64_tr_b16 a[232:233], v21 offset:18432
    ds_read_b64_tr_b16 a[234:235], v21 offset:18560
    ds_read_b64_tr_b16 a[236:237], v21 offset:19456
    ds_read_b64_tr_b16 a[238:239], v21 offset:19584
    v_mul_u32_u24 v2, 128, v22
    v_add_u32 v2, v2, v23
    v_add_u32 v2, s40, v2
    s_waitcnt vmcnt(0)
    ds_read_b64_tr_b16 a[240:241], v2 offset:20480
    ds_read_b64_tr_b16 a[242:243], v2 offset:20736
    ds_read_b64_tr_b16 a[244:245], v2 offset:22528
    ds_read_b64_tr_b16 a[246:247], v2 offset:22784
    ds_read_b64_tr_b16 a[248:249], v2 offset:24576
    ds_read_b64_tr_b16 a[250:251], v2 offset:24832
    ds_read_b64_tr_b16 a[252:253], v2 offset:26624
    ds_read_b64_tr_b16 a[254:255], v2 offset:26880
    ds_read_b64_tr_b16 v[176:177], v2 offset:28672
    ds_read_b64_tr_b16 v[178:179], v2 offset:28928
    ds_read_b64_tr_b16 v[180:181], v2 offset:30720
    ds_read_b64_tr_b16 v[182:183], v2 offset:30976
    ds_read_b64_tr_b16 v[184:185], v2 offset:32768
    ds_read_b64_tr_b16 v[186:187], v2 offset:33024
    ds_read_b64_tr_b16 v[188:189], v2 offset:34816
    ds_read_b64_tr_b16 v[190:191], v2 offset:35072
    ds_read_b64_tr_b16 v[192:193], v2 offset:20544
    ds_read_b64_tr_b16 v[194:195], v2 offset:20800
    ds_read_b64_tr_b16 v[196:197], v2 offset:22592
    ds_read_b64_tr_b16 v[198:199], v2 offset:22848
    ds_read_b64_tr_b16 v[200:201], v2 offset:24640
    ds_read_b64_tr_b16 v[202:203], v2 offset:24896
    ds_read_b64_tr_b16 v[204:205], v2 offset:26688
    ds_read_b64_tr_b16 v[206:207], v2 offset:26944
    ds_read_b64_tr_b16 v[208:209], v2 offset:28736
    ds_read_b64_tr_b16 v[210:211], v2 offset:28992
    ds_read_b64_tr_b16 v[212:213], v2 offset:30784
    ds_read_b64_tr_b16 v[214:215], v2 offset:31040
    ds_read_b64_tr_b16 v[216:217], v2 offset:32832
    ds_read_b64_tr_b16 v[218:219], v2 offset:33088
    ds_read_b64_tr_b16 v[220:221], v2 offset:34880
    ds_read_b64_tr_b16 v[222:223], v2 offset:35136
L_woe_100:
    s_waitcnt lgkmcnt(0)
    s_barrier
    v_and_b32 v14, 63, v0
    v_and_b32 v15, 15, v14
    v_lshrrev_b32 v16, 4, v14
    s_cmp_lg_u32 s19, 0
    s_cbranch_scc1 L_mw_101
    v_add_u32 v17, 128, v14
    v_mul_u32_u24 v99, 52429, v17
    v_lshrrev_b32 v99, 21, v99
    v_lshlrev_b32 v99, 1, v99
    v_add_u32 v99, v99, v17
    v_lshlrev_b32 v99, 4, v99
    v_add_u32 v99, 8704, v99
L_mw_101:
    s_cmp_lg_u32 s19, 1
    s_cbranch_scc1 L_mw_102
    v_add_u32 v17, 0, v14
    v_mul_u32_u24 v99, 52429, v17
    v_lshrrev_b32 v99, 21, v99
    v_lshlrev_b32 v99, 1, v99
    v_add_u32 v99, v99, v17
    v_lshlrev_b32 v99, 4, v99
    v_add_u32 v99, 8704, v99
    v_add_u32 v17, 64, v14
    v_mul_u32_u24 v5, 52429, v17
    v_lshrrev_b32 v5, 21, v5
    v_lshlrev_b32 v5, 1, v5
    v_add_u32 v5, v5, v17
    v_lshlrev_b32 v5, 4, v5
    v_add_u32 v5, 8704, v5
    v_add_u32 v17, 256, v14
    v_mul_u32_u24 v6, 52429, v17
    v_lshrrev_b32 v6, 21, v6
    v_lshlrev_b32 v6, 1, v6
    v_add_u32 v6, v6, v17
    v_lshlrev_b32 v6, 4, v6
    v_add_u32 v6, 8704, v6
L_mw_102:
    s_cmp_lg_u32 s19, 2
    s_cbranch_scc1 L_mw_103
    v_add_u32 v17, 192, v14
    v_mul_u32_u24 v99, 52429, v17
    v_lshrrev_b32 v99, 21, v99
    v_lshlrev_b32 v99, 1, v99
    v_add_u32 v99, v99, v17
    v_lshlrev_b32 v99, 4, v99
    v_add_u32 v99, 8704, v99
L_mw_103:
    v_mov_b32 v17, 32
L_sw_104:
    buffer_load_dword v2, v17, s[52:55], 0 offen sc1
    s_waitcnt vmcnt(0)
    v_readfirstlane_b32 s38, v2
    s_cmp_ge_u32 s38, 64
    s_cbranch_scc1 L_sw_104_ok
    s_sleep 4
    s_sub_u32 s27, s27, 1
    s_cbranch_scc0 L_sw_104
    s_branch L_chain_abort
L_sw_104_ok:
    v_mov_b32 v17, 40
L_sw_105:
    buffer_load_dword v2, v17, s[52:55], 0 offen sc1
    s_waitcnt vmcnt(0)
    v_readfirstlane_b32 s38, v2
    s_cmp_ge_u32 s38, 256
    s_cbranch_scc1 L_sw_105_ok
    s_sleep 4
    s_sub_u32 s27, s27, 1
    s_cbranch_scc0 L_sw_105
    s_branch L_chain_abort
L_sw_105_ok:
    v_mov_b32 v17, 102770688
L_sw_106:
    buffer_load_dword v2, v17, s[8:11], 0 offen sc1
    s_waitcnt vmcnt(0)
    v_readfirstlane_b32 s38, v2
    s_cmp_ge_u32 s38, 1
    s_cbranch_scc1 L_sw_106_ok
    s_sleep 4
    s_sub_u32 s27, s27, 1
    s_cbranch_scc0 L_sw_106
    s_branch L_chain_abort
L_sw_106_ok:
    s_sub_u32 s43, s38, 1
    s_lshl_b32 s43, s43, 13
    s_add_u32 s71, s71, s43
    s_add_u32 s70, s70, s43
    s_mov_b32 s25, s71
    s_mov_b32 s24, s70
    s_cmp_lg_u32 s19, 3
    s_cbranch_scc1 L_st_107
    s_mov_b32 s37, 0
    s_lshr_b32 s38, s37, 2
    s_lshl_b32 s38, s38, 5
    s_add_u32 s38, s38, s17
    s_lshl_b32 s38, s38, 2
    s_add_u32 s38, s38, 102760448
    v_mov_b32 v17, s38
L_sw_108:
    buffer_load_dword v2, v17, s[8:11], 0 offen sc1
    s_waitcnt vmcnt(0)
    v_readfirstlane_b32 s38, v2
    s_cmp_ge_u32 s38, 2
    s_cbranch_scc1 L_sw_108_ok
    s_sleep 4
    s_sub_u32 s27, s27, 1
    s_cbranch_scc0 L_sw_108
    s_branch L_chain_abort
L_sw_108_ok:
    s_mov_b32 s37, 0
    s_mov_b32 s36, 16384
    s_lshl_b32 s38, s37, 5
    s_add_u32 s38, s38, s17
    s_lshl_b32 s38, s38, 13
    s_add_u32 s72, s38, 0
    s_add_u32 s73, s38, 4096
    s_add_u32 s74, s38, 16777216
    s_add_u32 s75, s38, 16781312
    s_add_u32 m0, s36, 0
    s_nop 0
    buffer_load_dwordx4 v1, s[8:11], s72 offen sc1 lds
    buffer_load_dwordx4 v1, s[8:11], s72 offen offset:1024 sc1 lds
    buffer_load_dwordx4 v1, s[8:11], s72 offen offset:2048 sc1 lds
    buffer_load_dwordx4 v1, s[8:11], s72 offen offset:3072 sc1 lds
    s_add_u32 m0, s36, 4096
    s_nop 0
    buffer_load_dwordx4 v1, s[8:11], s73 offen sc1 lds
    buffer_load_dwordx4 v1, s[8:11], s73 offen offset:1024 sc1 lds
    buffer_load_dwordx4 v1, s[8:11], s73 offen offset:2048 sc1 lds
    buffer_load_dwordx4 v1, s[8:11], s73 offen offset:3072 sc1 lds
    s_add_u32 m0, s36, 8192
    s_nop 0
    buffer_load_dwordx4 v1, s[8:11], s74 offen sc1 lds
    buffer_load_dwordx4 v1, s[8:11], s74 offen offset:1024 sc1 lds
    buffer_load_dwordx4 v1, s[8:11], s74 offen offset:2048 sc1 lds
    buffer_load_dwordx4 v1, s[8:11], s74 offen offset:3072 sc1 lds
    s_add_u32 m0, s36, 12288
    s_nop 0
    buffer_load_dwordx4 v1, s[8:11], s75 offen sc1 lds
    buffer_load_dwordx4 v1, s[8:11], s75 offen offset:1024 sc1 lds
    buffer_load_dwordx4 v1, s[8:11], s75 offen offset:2048 sc1 lds
    buffer_load_dwordx4 v1, s[8:11], s75 offen offset:3072 sc1 lds
    s_waitcnt vmcnt(0)
    s_mov_b32 s37, 1
    s_mov_b32 s36, 32768
    s_lshl_b32 s38, s37, 5
    s_add_u32 s38, s38, s17
    s_lshl_b32 s38, s38, 13
    s_add_u32 s72, s38, 0
    s_add_u32 s73, s38, 4096
    s_add_u32 s74, s38, 16777216
    s_add_u32 s75, s38, 16781312
    s_add_u32 m0, s36, 0
    s_nop 0
    buffer_load_dwordx4 v1, s[8:11], s72 offen sc1 lds
    buffer_load_dwordx4 v1, s[8:11], s72 offen offset:1024 sc1 lds
    buffer_load_dwordx4 v1, s[8:11], s72 offen offset:2048 sc1 lds
    buffer_load_dwordx4 v1, s[8:11], s72 offen offset:3072 sc1 lds
    s_add_u32 m0, s36, 4096
    s_nop 0
    buffer_load_dwordx4 v1, s[8:11], s73 offen sc1 lds
    buffer_load_dwordx4 v1, s[8:11], s73 offen offset:1024 sc1 lds
    buffer_load_dwordx4 v1, s[8:11], s73 offen offset:2048 sc1 lds
    buffer_load_dwordx4 v1, s[8:11], s73 offen offset:3072 sc1 lds
    s_add_u32 m0, s36, 8192
    s_nop 0
    buffer_load_dwordx4 v1, s[8:11], s74 offen sc1 lds
    buffer_load_dwordx4 v1, s[8:11], s74 offen offset:1024 sc1 lds
    buffer_load_dwordx4 v1, s[8:11], s74 offen offset:2048 sc1 lds
    buffer_load_dwordx4 v1, s[8:11], s74 offen offset:3072 sc1 lds
    s_add_u32 m0, s36, 12288
    s_nop 0
    buffer_load_dwordx4 v1, s[8:11], s75 offen sc1 lds
    buffer_load_dwordx4 v1, s[8:11], s75 offen offset:1024 sc1 lds
    buffer_load_dwordx4 v1, s[8:11], s75 offen offset:2048 sc1 lds
    buffer_load_dwordx4 v1, s[8:11], s75 offen offset:3072 sc1 lds
    s_waitcnt vmcnt(0)
    v_mov_b32 v13, 2
L_st_107:
    s_barrier
    s_mov_b32 s16, 0
    s_mov_b32 s20, s44
    s_add_u32 s22, s44, 8192
    s_add_u32 s23, s44, 16384
    s_mov_b32 s35, 16384
    s_mov_b32 s36, 32768
    s_mov_b32 s26, 0
    s_lshl_b32 s38, s17, 1
    s_add_u32 s38, s38, s18
    s_lshl_b32 s38, s38, 6
    s_add_u32 s47, s38, 102764544
    s_lshl_b32 s38, s17, 12
    s_add_u32 s45, s38, 50331648
    s_lshl_b32 s38, s17, 11
    s_add_u32 s46, s38, 58720256
    s_setprio 3
    s_cmp_lg_u32 s19, 0
    s_cbranch_scc1 L_chain_w1
L_step_w0_109:
    s_add_u32 s78, s20, 2048
    buffer_load_dwordx4 v[144:147], v1, s[8:11], s78 offen sc1
    v_mov_b32 v60, 0
    v_mov_b32 v61, 0
    v_mov_b32 v62, 0
    v_mov_b32 v63, 0
    v_mov_b32 v64, 0
    v_mov_b32 v65, 0
    v_mov_b32 v66, 0
    v_mov_b32 v67, 0
    v_mov_b32 v68, 0
    v_mov_b32 v69, 0
    v_mov_b32 v70, 0
    v_mov_b32 v71, 0
    v_and_b32 v15, 7, v0
    v_mul_u32_u24 v15, 672, v15
    v_bfe_u32 v17, v0, 4, 2
    v_lshl_add_u32 v16, v17, 4, v15
L_ag_110:
    s_waitcnt vmcnt(0)
    v_cmp_eq_u32 vcc, -1, v144
    s_cbranch_vccnz L_ag_110_f0
    ds_write_b128 v99, v[144:147]
L_ag_110_w:
    s_waitcnt lgkmcnt(0)
    s_barrier
    ds_read_b128 v[20:23], v16 offset:8704
    ds_read_b128 v[24:27], v16 offset:8768
    ds_read_b128 v[28:31], v16 offset:8832
    s_waitcnt lgkmcnt(2)
    v_smfmac_f32_16x16x64_bf16 v[60:63], v[20:23], a[80:87], v3
    ds_read_b128 v[32:35], v16 offset:8896
    v_smfmac_f32_16x16x64_bf16 v[64:67], v[20:23], a[0:7], v3
    s_waitcnt lgkmcnt(2)
    v_smfmac_f32_16x16x64_bf16 v[60:63], v[24:27], a[88:95], v3
    ds_read_b128 v[36:39], v16 offset:8960
    v_smfmac_f32_16x16x64_bf16 v[64:67], v[24:27], a[8:15], v3
    s_waitcnt lgkmcnt(2)
    v_smfmac_f32_16x16x64_bf16 v[60:63], v[28:31], a[96:103], v3
    ds_read_b128 v[40:43], v16 offset:9024
    v_smfmac_f32_16x16x64_bf16 v[64:67], v[28:31], a[16:23], v3
    s_waitcnt lgkmcnt(2)
    v_smfmac_f32_16x16x64_bf16 v[60:63], v[32:35], a[104:111], v3
    ds_read_b128 v[44:47], v16 offset:9088
    v_smfmac_f32_16x16x64_bf16 v[64:67], v[32:35], a[24:31], v3
    s_waitcnt lgkmcnt(2)
    v_smfmac_f32_16x16x64_bf16 v[60:63], v[36:39], a[112:119], v3
    ds_read_b128 v[48:51], v16 offset:9152
    v_smfmac_f32_16x16x64_bf16 v[64:67], v[36:39], a[32:39], v3
    s_waitcnt lgkmcnt(2)
    v_smfmac_f32_16x16x64_bf16 v[60:63], v[40:43], a[120:127], v3
    ds_read_b128 v[52:55], v16 offset:9216
    v_smfmac_f32_16x16x64_bf16 v[64:67], v[40:43], a[40:47], v3
    s_waitcnt lgkmcnt(2)
    v_smfmac_f32_16x16x64_bf16 v[60:63], v[44:47], a[128:135], v3
    ds_read_b128 v[56:59], v16 offset:9280
    v_smfmac_f32_16x16x64_bf16 v[64:67], v[44:47], a[48:55], v3
    s_waitcnt lgkmcnt(2)
    v_smfmac_f32_16x16x64_bf16 v[60:63], v[48:51], a[136:143], v3
    v_smfmac_f32_16x16x64_bf16 v[64:67], v[48:51], a[56:63], v3
    s_waitcnt lgkmcnt(1)
    v_smfmac_f32_16x16x64_bf16 v[60:63], v[52:55], a[144:151], v3
    v_smfmac_f32_16x16x64_bf16 v[64:67], v[52:55], a[64:71], v3
    s_waitcnt lgkmcnt(0)
    v_smfmac_f32_16x16x64_bf16 v[60:63], v[56:59], a[152:159], v3
    v_smfmac_f32_16x16x64_bf16 v[64:67], v[56:59], a[72:79], v3
    v_smfmac_f32_16x16x64_bf16 v[68:71], v[20:23], a[160:167], v3
    v_cvt_pk_bf16_f32 v84, v60, v61
    v_cvt_pk_bf16_f32 v86, v62, v63
    s_nop 1
    v_cvt_pk_bf16_f32 v85, v64, v65
    v_cvt_pk_bf16_f32 v87, v66, v67
    s_waitcnt vmcnt(0)
    buffer_store_dwordx4 v[84:87], v90, s[8:11], s24 offen sc1
    v_smfmac_f32_16x16x64_bf16 v[68:71], v[24:27], a[168:175], v3
    v_add_u32 v11, s35, v1
    v_smfmac_f32_16x16x64_bf16 v[68:71], v[28:31], a[176:183], v3
    ds_read_b128 v[112:115], v11 offset:0
    v_smfmac_f32_16x16x64_bf16 v[68:71], v[32:35], a[184:191], v3
    ds_read_b128 v[116:119], v11 offset:1024
    v_smfmac_f32_16x16x64_bf16 v[68:71], v[36:39], a[192:199], v3
    ds_read_b128 v[120:123], v11 offset:2048
    v_smfmac_f32_16x16x64_bf16 v[68:71], v[40:43], a[200:207], v3
    ds_read_b128 v[124:127], v11 offset:3072
    v_smfmac_f32_16x16x64_bf16 v[68:71], v[44:47], a[208:215], v3
    ds_read_b128 v[128:131], v11 offset:4096
    v_smfmac_f32_16x16x64_bf16 v[68:71], v[48:51], a[216:223], v3
    ds_read_b128 v[132:135], v11 offset:5120
    v_smfmac_f32_16x16x64_bf16 v[68:71], v[52:55], a[224:231], v3
    ds_read_b128 v[136:139], v11 offset:6144
    v_smfmac_f32_16x16x64_bf16 v[68:71], v[56:59], a[232:239], v3
    ds_read_b128 v[140:143], v11 offset:7168
    s_lshl_b32 s38, s19, 11
    v_add_u32 v12, s38, v11
    ds_read_b128 v[144:147], v12 offset:8192
    ds_read_b128 v[148:151], v12 offset:9216
    s_nop 2
    v_cvt_pk_bf16_f32 v88, v68, v69
    v_cvt_pk_bf16_f32 v89, v70, v71
    buffer_store_dwordx2 v[88:89], v91, s[8:11], s24 offen sc1
    s_nop 3
    s_nop 3
    s_nop 3
    s_nop 3
    s_nop 3
    s_nop 3
    s_nop 3
    s_nop 3
    buffer_load_dwordx4 v[92:95], v90, s[8:11], s25 offen sc1
    v_mov_b32 v72, 0
    v_mov_b32 v73, 0
    v_mov_b32 v74, 0
    v_mov_b32 v75, 0
    v_mov_b32 v76, 0
    v_mov_b32 v77, 0
    v_mov_b32 v78, 0
    v_mov_b32 v79, 0
    v_mov_b32 v80, 0
    v_mov_b32 v81, 0
    v_mov_b32 v82, 0
    v_mov_b32 v83, 0
    s_waitcnt vmcnt(0)
    v_cmp_eq_u32 vcc, -1, v92
    s_cbranch_vccnz R_x_112
L_x_111_first:
    buffer_load_dwordx2 v[96:97], v91, s[8:11], s25 offen sc1
L_x_111:
    v_dot2c_f32_bf16 v60, v92, v18
    v_dot2c_f32_bf16 v61, v92, v19
    v_dot2c_f32_bf16 v64, v93, v18
    v_dot2c_f32_bf16 v65, v93, v19
    v_dot2c_f32_bf16 v62, v94, v18
    v_dot2c_f32_bf16 v63, v94, v19
    v_dot2c_f32_bf16 v66, v95, v18
    v_dot2c_f32_bf16 v67, v95, v19
    v_cvt_pk_bf16_f32 v84, v60, v61
    v_cvt_pk_bf16_f32 v85, v64, v65
    v_cvt_pk_bf16_f32 v86, v62, v63
    v_cvt_pk_bf16_f32 v87, v66, v67
    ds_write_b128 v7, v[84:87] offset:0
    buffer_store_dwordx4 v[100:103], v90, s[8:11], s25 offen sc1
    s_waitcnt lgkmcnt(0)
    s_barrier
    ds_read_b64_tr_b16 v[20:21], v8 offset:0
    ds_read_b64_tr_b16 v[22:23], v8 offset:512
    ds_read_b64_tr_b16 v[24:25], v8 offset:1024
    ds_read_b64_tr_b16 v[26:27], v8 offset:1536
    ds_read_b64_tr_b16 v[28:29], v8 offset:2048
    ds_read_b64_tr_b16 v[30:31], v8 offset:2560
    ds_read_b64_tr_b16 v[32:33], v8 offset:3072
    ds_read_b64_tr_b16 v[34:35], v8 offset:3584
    s_waitcnt lgkmcnt(6)
    v_mfma_f32_16x16x32_bf16 v[156:159], v[112:115], v[20:23], 0
    v_mfma_f32_16x16x32_bf16 v[160:163], v[128:131], v[20:23], 0
    v_mfma_f32_16x16x32_bf16 v[152:155], v[20:23], v[20:23], 0
    s_waitcnt lgkmcnt(4)
    v_mfma_f32_16x16x32_bf16 v[156:159], v[116:119], v[24:27], v[156:159]
    v_mfma_f32_16x16x32_bf16 v[160:163], v[132:135], v[24:27], v[160:163]
    v_mfma_f32_16x16x32_bf16 v[152:155], v[24:27], v[24:27], v[152:155]
    s_waitcnt lgkmcnt(2)
    v_mfma_f32_16x16x32_bf16 v[156:159], v[120:123], v[28:31], v[156:159]
    v_mfma_f32_16x16x32_bf16 v[160:163], v[136:139], v[28:31], v[160:163]
    v_mfma_f32_16x16x32_bf16 v[152:155], v[28:31], v[28:31], v[152:155]
    s_waitcnt lgkmcnt(0)
    v_mfma_f32_16x16x32_bf16 v[156:159], v[124:127], v[32:35], v[156:159]
    v_mfma_f32_16x16x32_bf16 v[160:163], v[140:143], v[32:35], v[160:163]
    v_mfma_f32_16x16x32_bf16 v[152:155], v[32:35], v[32:35], v[152:155]
    v_max3_f32 v174, v156, v157, v158
    s_nop 2
    v_max3_f32 v14, v159, v160, v161
    v_max3_f32 v174, v174, v162, v163
    s_nop 1
    v_max3_f32 v14, v14, v152, v153
    v_max_f32 v174, v174, v14
    v_max_f32 v15, v174, v174
    s_nop 1
    v_permlane16_swap_b32 v174, v15
    v_max_f32 v174, v174, v15
    v_mov_b32 v15, v174
    s_nop 1
    v_permlane32_swap_b32 v174, v15
    v_max_f32 v174, v174, v15
    v_mul_f32 v174, s32, v174
    v_pk_fma_f32 v[156:157], v[156:157], s[32:33], v[174:175] op_sel_hi:[1,1,0] neg_lo:[0,0,1] neg_hi:[0,0,1]
    v_pk_fma_f32 v[158:159], v[158:159], s[32:33], v[174:175] op_sel_hi:[1,1,0] neg_lo:[0,0,1] neg_hi:[0,0,1]
    v_pk_fma_f32 v[160:161], v[160:161], s[32:33], v[174:175] op_sel_hi:[1,1,0] neg_lo:[0,0,1] neg_hi:[0,0,1]
    v_pk_fma_f32 v[162:163], v[162:163], s[32:33], v[174:175] op_sel_hi:[1,1,0] neg_lo:[0,0,1] neg_hi:[0,0,1]
    v_pk_fma_f32 v[152:153], v[152:153], s[32:33], v[174:175] op_sel_hi:[1,1,0] neg_lo:[0,0,1] neg_hi:[0,0,1]
    v_exp_f32 v156, v156
    v_exp_f32 v157, v157
    v_exp_f32 v158, v158
    v_exp_f32 v159, v159
    v_cvt_pk_bf16_f32 v164, v156, v157
    v_exp_f32 v160, v160
    v_exp_f32 v161, v161
    v_cvt_pk_bf16_f32 v165, v158, v159
    v_exp_f32 v162, v162
    v_exp_f32 v163, v163
    v_cvt_pk_bf16_f32 v166, v160, v161
    v_exp_f32 v152, v152
    v_cvt_pk_bf16_f32 v167, v162, v163
    v_exp_f32 v153, v153
    s_waitcnt vmcnt(1)
    v_cmp_eq_u32 vcc, -1, v96
    v_pk_add_f32 v[14:15], v[156:157], v[158:159]
    v_mfma_f32_16x16x32_bf16 v[112:115], v[144:147], v[164:167], 0
    s_cbranch_vccnz R_xv_114
L_xv_113:
    v_dot2c_f32_bf16 v68, v96, v18
    v_dot2c_f32_bf16 v69, v96, v19
    v_mfma_f32_16x16x32_bf16 v[116:119], v[148:151], v[164:167], 0
    v_dot2c_f32_bf16 v70, v97, v18
    v_dot2c_f32_bf16 v71, v97, v19
    v_cvt_pk_bf16_f32 v168, v152, v153
    v_cvt_pk_bf16_f32 v170, v68, v69
    v_pk_add_f32 v[16:17], v[160:161], v[162:163]
    v_cvt_pk_bf16_f32 v172, v70, v71
    v_pk_add_f32 v[14:15], v[14:15], v[152:153]
    buffer_store_dwordx2 v[100:101], v91, s[8:11], s25 offen sc1
    v_permlane16_swap_b32 v170, v172
    v_pk_add_f32 v[14:15], v[14:15], v[16:17]
    s_nop 0
    v_permlane32_swap_b32 v170, v172
    v_add_f32 v175, v14, v15
    v_add_f32 v16, v14, v15
    v_mfma_f32_16x16x16_bf16 v[112:115], v[170:171], v[168:169], v[112:115]
    s_nop 0
    v_permlane16_swap_b32 v175, v16
    v_mfma_f32_16x16x16_bf16 v[116:119], v[172:173], v[168:169], v[116:119]
    v_add_f32 v175, v175, v16
    v_mov_b32 v16, v175
    v_mov_b32 v88, v170
    v_mov_b32 v89, v172
    v_permlane32_swap_b32 v175, v16
    v_add_f32 v174, v175, v16
    v_rcp_f32 v174, v174
    s_nop 0
    v_pk_mul_f32 v[112:113], v[112:113], v[174:175] op_sel_hi:[1,0]
    v_pk_mul_f32 v[114:115], v[114:115], v[174:175] op_sel_hi:[1,0]
    v_cvt_pk_bf16_f32 v112, v112, v113
    v_cvt_pk_bf16_f32 v113, v114, v115
    v_pk_mul_f32 v[116:117], v[116:117], v[174:175] op_sel_hi:[1,0]
    v_pk_mul_f32 v[118:119], v[118:119], v[174:175] op_sel_hi:[1,0]
    v_cvt_pk_bf16_f32 v116, v116, v117
    v_cvt_pk_bf16_f32 v117, v118, v119
    s_mov_b64 exec, s[28:29]
    ds_write_b64 v9, v[112:113] offset:0
    ds_write_b64 v9, v[116:117] offset:32
    s_mov_b64 exec, -1
    ds_write_b64 v98, v[88:89]
    s_cmp_eq_u32 s48, 0
    s_cbranch_scc1 L_nrst_115
    s_mov_b64 exec, s[30:31]
    buffer_store_dword v100, v6, s[8:11], s23 offen
    buffer_store_dword v100, v6, s[8:11], s23 offen offset:640
    s_mov_b64 exec, -1
L_nrst_115:
    s_waitcnt lgkmcnt(0)
    s_barrier
    ds_read_b128 v[120:123], v10 offset:0
    ds_read_b128 v[124:127], v10 offset:64
    ds_read_b128 v[128:131], v10 offset:128
    ds_read_b128 v[132:135], v10 offset:192
    s_cmp_eq_u32 s16, 63
    s_cbranch_scc1 L_chain_done_w0
    s_waitcnt lgkmcnt(3)
    v_smfmac_f32_16x16x64_bf16 v[72:75], v[120:123], a[240:247], v3
    s_waitcnt lgkmcnt(2)
    v_smfmac_f32_16x16x64_bf16 v[72:75], v[124:127], a[248:255], v3
    s_waitcnt lgkmcnt(1)
    v_smfmac_f32_16x16x64_bf16 v[72:75], v[128:131], v[176:183], v3
    s_waitcnt lgkmcnt(0)
    v_smfmac_f32_16x16x64_bf16 v[72:75], v[132:135], v[184:191], v3
    v_smfmac_f32_16x16x64_bf16 v[76:79], v[120:123], v[192:199], v3
    v_smfmac_f32_16x16x64_bf16 v[76:79], v[124:127], v[200:207], v3
    v_cvt_pk_bf16_f32 v72, v72, v73
    v_cvt_pk_bf16_f32 v73, v74, v75
    v_and_or_b32 v72, v72, -2, s26
    buffer_store_dwordx2 v[72:73], v4, s[8:11], 0 offen
    v_smfmac_f32_16x16x64_bf16 v[76:79], v[128:131], v[208:215], v3
    v_smfmac_f32_16x16x64_bf16 v[76:79], v[132:135], v[216:223], v3
    v_smfmac_f32_16x16x64_bf16 v[80:83], v[120:123], v[224:231], v3
    v_smfmac_f32_16x16x64_bf16 v[80:83], v[124:127], v[232:239], v3
    v_cvt_pk_bf16_f32 v76, v76, v77
    v_cvt_pk_bf16_f32 v77, v78, v79
    v_and_or_b32 v76, v76, -2, s26
    buffer_store_dwordx2 v[76:77], v4, s[8:11], s50 offen
    v_smfmac_f32_16x16x64_bf16 v[80:83], v[128:131], v[240:247], v3
    v_smfmac_f32_16x16x64_bf16 v[80:83], v[132:135], v[248:255], v3
    s_nop 7
    v_cvt_pk_bf16_f32 v80, v80, v81
    v_cvt_pk_bf16_f32 v81, v82, v83
    v_and_or_b32 v80, v80, -2, s26
    buffer_store_dwordx2 v[80:81], v4, s[8:11], s51 offen
    s_cmp_eq_u32 s48, 0
    s_cbranch_scc1 L_nors_116
    s_nop 3
    s_nop 3
    s_nop 3
    s_nop 3
    s_nop 3
    s_nop 3
    s_nop 3
    s_nop 3
    s_nop 3
    s_nop 3
    s_nop 3
    s_nop 3
    s_nop 3
    s_nop 3
    s_nop 3
    s_nop 3
    s_nop 3
    s_nop 3
    s_nop 3
    s_nop 3
    s_nop 3
    s_nop 3
    s_nop 3
    s_nop 3
    v_mov_b32 v17, s26
    buffer_load_dwordx4 v[20:23], v5, s[8:11], 0 offen offset:0 sc1
    buffer_load_dwordx4 v[24:27], v5, s[8:11], 0 offen offset:1024 sc1
    buffer_load_dwordx4 v[28:31], v5, s[8:11], 0 offen offset:2048 sc1
    buffer_load_dwordx4 v[32:35], v5, s[8:11], 0 offen offset:3072 sc1
    s_waitcnt vmcnt(3)
    v_mfma_f32_16x16x32_bf16 v[108:111], v[104:107], v[20:23], 0
    s_waitcnt vmcnt(2)
    v_mfma_f32_16x16x32_bf16 v[108:111], v[104:107], v[24:27], v[108:111]
    v_bitop3_b32 v14, v20, v24, v17 bitop3:0x7e
    s_waitcnt vmcnt(1)
    v_mfma_f32_16x16x32_bf16 v[108:111], v[104:107], v[28:31], v[108:111]
    s_waitcnt vmcnt(0)
    v_bitop3_b32 v15, v28, v32, v17 bitop3:0x7e
    v_mfma_f32_16x16x32_bf16 v[108:111], v[104:107], v[32:35], v[108:111]
    v_bitop3_b32 v14, v14, v15, 1 bitop3:0xa8
    v_cmp_ne_u32 vcc, 0, v14
    s_cbranch_vccnz R_rs_118_0
L_rs_117:
    s_nop 4
    v_add_f32_dpp v108, v108, v108 row_ror:8 row_mask:0xf bank_mask:0xf
    v_add_f32_dpp v109, v109, v109 row_ror:8 row_mask:0xf bank_mask:0xf
    s_nop 0
    v_mov_b32_dpp v110, v108 quad_perm:[1,0,3,2] row_mask:0xf bank_mask:0xf
    v_mov_b32_dpp v111, v109 quad_perm:[1,0,3,2] row_mask:0xf bank_mask:0xf
    v_cvt_pk_bf16_f32 v108, v108, v110
    v_cvt_pk_bf16_f32 v109, v109, v111
    v_min_u32 v108, -2, v108
    v_min_u32 v109, -2, v109
    s_mov_b64 exec, s[30:31]
    buffer_store_dword v108, v6, s[8:11], s22 offen
    buffer_store_dword v109, v6, s[8:11], s22 offen offset:640
    s_mov_b64 exec, -1
    s_branch L_rsj_119
L_nors_116:
    s_nop 3
    s_nop 3
    s_nop 3
    s_nop 3
    s_nop 3
    s_nop 3
    s_nop 3
    s_nop 3
    s_nop 3
    s_nop 3
    s_nop 3
    s_nop 3
    s_nop 3
    s_nop 3
    s_nop 3
    s_nop 3
    s_nop 3
    s_nop 3
    s_nop 3
    s_nop 3
    s_nop 3
    s_nop 3
    s_nop 3
    s_nop 3
    s_nop 3
    s_nop 3
    s_nop 3
    s_nop 3
    s_nop 3
    s_nop 3
    s_nop 3
    s_nop 3
    s_nop 3
    s_nop 3
    s_nop 3
    s_nop 3
    s_nop 3
    s_nop 3
    s_nop 3
    s_nop 3
    s_nop 3
    s_nop 3
    s_nop 3
    s_nop 3
    s_nop 3
    s_nop 3
    s_nop 3
    s_nop 3
    s_nop 3
    s_nop 3
    s_nop 3
    s_nop 3
    s_nop 3
    s_nop 3
    s_nop 3
    s_nop 3
    s_nop 3
    s_nop 3
    s_nop 3
    s_nop 3
    s_nop 3
    s_nop 3
    s_nop 3
    s_nop 3
    s_nop 3
    s_nop 3
    s_nop 3
    s_nop 3
L_rsj_119:
    s_add_u32 s16, s16, 1
    s_xor_b32 s26, s26, 1
    s_lshl_b32 s38, s26, 11
    s_add_u32 s24, s70, s38
    s_add_u32 s25, s71, s38
    s_mov_b32 s38, s20
    s_mov_b32 s20, s22
    s_mov_b32 s22, s23
    s_mov_b32 s23, s38
    s_add_u32 s35, s35, 16384
    s_cmp_ge_u32 s35, 65536
    s_cselect_b32 s35, 16384, s35
    s_nop 3
    s_nop 3
    s_nop 3
    s_nop 3
    s_nop 3
    s_nop 3
    s_nop 3
    s_nop 3
    s_branch L_step_w0_109
L_ag_110_f0:
    s_sub_u32 s27, s27, 1
    s_cbranch_scc1 L_chain_abort
    buffer_load_dwordx4 v[144:147], v1, s[8:11], s78 offen sc1
    s_waitcnt vmcnt(0)
    v_cmp_eq_u32 vcc, -1, v144
    s_cbranch_vccnz L_ag_110_f0
    ds_write_b128 v99, v[144:147]
    s_branch L_ag_110_w
R_x_112:
    s_sub_u32 s27, s27, 1
    s_cbranch_scc1 L_chain_abort
    buffer_load_dwordx4 v[92:95], v90, s[8:11], s25 offen sc1
    s_waitcnt vmcnt(0)
    v_cmp_eq_u32 vcc, -1, v92
    s_cbranch_vccnz R_x_112
    buffer_load_dwordx2 v[96:97], v91, s[8:11], s25 offen sc1
    s_branch L_x_111
R_xv_114:
    s_sub_u32 s27, s27, 1
    s_cbranch_scc1 L_chain_abort
    buffer_load_dwordx2 v[96:97], v91, s[8:11], s25 offen sc1
    s_waitcnt vmcnt(0)
    v_cmp_eq_u32 vcc, -1, v96
    s_cbranch_vccnz R_xv_114
    s_branch L_xv_113
R_rs_118_0:
    s_sub_u32 s27, s27, 1
    s_cbranch_scc1 L_chain_abort
    s_nop 3
    buffer_load_dwordx4 v[20:23], v5, s[8:11], 0 offen offset:0 sc1
    buffer_load_dwordx4 v[24:27], v5, s[8:11], 0 offen offset:1024 sc1
    buffer_load_dwordx4 v[28:31], v5, s[8:11], 0 offen offset:2048 sc1
    buffer_load_dwordx4 v[32:35], v5, s[8:11], 0 offen offset:3072 sc1
    s_waitcnt vmcnt(3)
    v_mfma_f32_16x16x32_bf16 v[108:111], v[104:107], v[20:23], 0
    s_waitcnt vmcnt(2)
    v_mfma_f32_16x16x32_bf16 v[108:111], v[104:107], v[24:27], v[108:111]
    v_bitop3_b32 v14, v20, v24, v17 bitop3:0x7e
    s_waitcnt vmcnt(1)
    v_mfma_f32_16x16x32_bf16 v[108:111], v[104:107], v[28:31], v[108:111]
    s_waitcnt vmcnt(0)
    v_bitop3_b32 v15, v28, v32, v17 bitop3:0x7e
    v_mfma_f32_16x16x32_bf16 v[108:111], v[104:107], v[32:35], v[108:111]
    v_bitop3_b32 v14, v14, v15, 1 bitop3:0xa8
    v_cmp_ne_u32 vcc, 0, v14
    s_cbranch_vccnz R_rs_118_0
    s_branch L_rs_117
L_chain_done_w0:
    s_branch L_chain_done
L_chain_w1:
    s_cmp_lg_u32 s19, 1
    s_cbranch_scc1 L_chain_w2
L_step_w1_120:
    s_add_u32 s78, s20, 0
    s_add_u32 s79, s20, 1024
    s_add_u32 s80, s20, 4096
    buffer_load_dwordx4 v[144:147], v1, s[8:11], s78 offen sc1
    buffer_load_dwordx4 v[148:151], v1, s[8:11], s79 offen sc1
    buffer_load_dwordx4 v[152:155], v1, s[8:11], s80 offen sc1
    v_mov_b32 v60, 0
    v_mov_b32 v61, 0
    v_mov_b32 v62, 0
    v_mov_b32 v63, 0
    v_mov_b32 v64, 0
    v_mov_b32 v65, 0
    v_mov_b32 v66, 0
    v_mov_b32 v67, 0
    v_mov_b32 v68, 0
    v_mov_b32 v69, 0
    v_mov_b32 v70, 0
    v_mov_b32 v71, 0
    v_and_b32 v15, 7, v0
    v_mul_u32_u24 v15, 672, v15
    v_bfe_u32 v17, v0, 4, 2
    v_lshl_add_u32 v16, v17, 4, v15
L_ag_121:
    s_waitcnt vmcnt(0)
    v_max3_u32 v14, v144, v148, v152
    v_cmp_eq_u32 vcc, -1, v14
    s_cbranch_vccnz L_ag_121_f0
    ds_write_b128 v99, v[144:147]
    ds_write_b128 v5, v[148:151]
    ds_write_b128 v6, v[152:155]
L_ag_121_w:
    s_waitcnt lgkmcnt(0)
    s_barrier
    ds_read_b128 v[20:23], v16 offset:8704
    ds_read_b128 v[24:27], v16 offset:8768
    ds_read_b128 v[28:31], v16 offset:8832
    s_waitcnt lgkmcnt(2)
    v_smfmac_f32_16x16x64_bf16 v[60:63], v[20:23], a[80:87], v3
    ds_read_b128 v[32:35], v16 offset:8896
    v_smfmac_f32_16x16x64_bf16 v[64:67], v[20:23], a[0:7], v3
    s_waitcnt lgkmcnt(2)
    v_smfmac_f32_16x16x64_bf16 v[60:63], v[24:27], a[88:95], v3
    ds_read_b128 v[36:39], v16 offset:8960
    v_smfmac_f32_16x16x64_bf16 v[64:67], v[24:27], a[8:15], v3
    s_waitcnt lgkmcnt(2)
    v_smfmac_f32_16x16x64_bf16 v[60:63], v[28:31], a[96:103], v3
    ds_read_b128 v[40:43], v16 offset:9024
    v_smfmac_f32_16x16x64_bf16 v[64:67], v[28:31], a[16:23], v3
    s_waitcnt lgkmcnt(2)
    v_smfmac_f32_16x16x64_bf16 v[60:63], v[32:35], a[104:111], v3
    ds_read_b128 v[44:47], v16 offset:9088
    v_smfmac_f32_16x16x64_bf16 v[64:67], v[32:35], a[24:31], v3
    s_waitcnt lgkmcnt(2)
    v_smfmac_f32_16x16x64_bf16 v[60:63], v[36:39], a[112:119], v3
    ds_read_b128 v[48:51], v16 offset:9152
    v_smfmac_f32_16x16x64_bf16 v[64:67], v[36:39], a[32:39], v3
    s_waitcnt lgkmcnt(2)
    v_smfmac_f32_16x16x64_bf16 v[60:63], v[40:43], a[120:127], v3
    ds_read_b128 v[52:55], v16 offset:9216
    v_smfmac_f32_16x16x64_bf16 v[64:67], v[40:43], a[40:47], v3
    s_waitcnt lgkmcnt(2)
    v_smfmac_f32_16x16x64_bf16 v[60:63], v[44:47], a[128:135], v3
    ds_read_b128 v[56:59], v16 offset:9280
    v_smfmac_f32_16x16x64_bf16 v[64:67], v[44:47], a[48:55], v3
    s_waitcnt lgkmcnt(2)
    v_smfmac_f32_16x16x64_bf16 v[60:63], v[48:51], a[136:143], v3
    v_smfmac_f32_16x16x64_bf16 v[64:67], v[48:51], a[56:63], v3
    s_waitcnt lgkmcnt(1)
    v_smfmac_f32_16x16x64_bf16 v[60:63], v[52:55], a[144:151], v3
    v_smfmac_f32_16x16x64_bf16 v[64:67], v[52:55], a[64:71], v3
    s_waitcnt lgkmcnt(0)
    v_smfmac_f32_16x16x64_bf16 v[60:63], v[56:59], a[152:159], v3
    v_smfmac_f32_16x16x64_bf16 v[64:67], v[56:59], a[72:79], v3
    v_smfmac_f32_16x16x64_bf16 v[68:71], v[20:23], a[160:167], v3
    v_cvt_pk_bf16_f32 v84, v60, v61
    v_cvt_pk_bf16_f32 v86, v62, v63
    s_nop 1
    v_cvt_pk_bf16_f32 v85, v64, v65
    v_cvt_pk_bf16_f32 v87, v66, v67
    s_waitcnt vmcnt(0)
    buffer_store_dwordx4 v[84:87], v90, s[8:11], s24 offen sc1
    v_smfmac_f32_16x16x64_bf16 v[68:71], v[24:27], a[168:175], v3
    v_add_u32 v11, s35, v1
    v_smfmac_f32_16x16x64_bf16 v[68:71], v[28:31], a[176:183], v3
    ds_read_b128 v[112:115], v11 offset:0
    v_smfmac_f32_16x16x64_bf16 v[68:71], v[32:35], a[184:191], v3
    ds_read_b128 v[116:119], v11 offset:1024
    v_smfmac_f32_16x16x64_bf16 v[68:71], v[36:39], a[192:199], v3
    ds_read_b128 v[120:123], v11 offset:2048
    v_smfmac_f32_16x16x64_bf16 v[68:71], v[40:43], a[200:207], v3
    ds_read_b128 v[124:127], v11 offset:3072
    v_smfmac_f32_16x16x64_bf16 v[68:71], v[44:47], a[208:215], v3
    ds_read_b128 v[128:131], v11 offset:4096
    v_smfmac_f32_16x16x64_bf16 v[68:71], v[48:51], a[216:223], v3
    ds_read_b128 v[132:135], v11 offset:5120
    v_smfmac_f32_16x16x64_bf16 v[68:71], v[52:55], a[224:231], v3
    ds_read_b128 v[136:139], v11 offset:6144
    v_smfmac_f32_16x16x64_bf16 v[68:71], v[56:59], a[232:239], v3
    ds_read_b128 v[140:143], v11 offset:7168
    s_lshl_b32 s38, s19, 11
    v_add_u32 v12, s38, v11
    ds_read_b128 v[144:147], v12 offset:8192
    ds_read_b128 v[148:151], v12 offset:9216
    s_nop 2
    v_cvt_pk_bf16_f32 v88, v68, v69
    v_cvt_pk_bf16_f32 v89, v70, v71
    buffer_store_dwordx2 v[88:89], v91, s[8:11], s24 offen sc1
    s_nop 3
    s_nop 3
    s_nop 3
    s_nop 3
    s_nop 3
    s_nop 3
    s_nop 3
    s_nop 3
    buffer_load_dwordx4 v[92:95], v90, s[8:11], s25 offen sc1
    v_mov_b32 v72, 0
    v_mov_b32 v73, 0
    v_mov_b32 v74, 0
    v_mov_b32 v75, 0
    v_mov_b32 v76, 0
    v_mov_b32 v77, 0
    v_mov_b32 v78, 0
    v_mov_b32 v79, 0
    v_mov_b32 v80, 0
    v_mov_b32 v81, 0
    v_mov_b32 v82, 0
    v_mov_b32 v83, 0
    s_waitcnt vmcnt(0)
    v_cmp_eq_u32 vcc, -1, v92
    s_cbranch_vccnz R_x_123
L_x_122_first:
    buffer_load_dwordx2 v[96:97], v91, s[8:11], s25 offen sc1
L_x_122:
    v_dot2c_f32_bf16 v60, v92, v18
    v_dot2c_f32_bf16 v61, v92, v19
    v_dot2c_f32_bf16 v64, v93, v18
    v_dot2c_f32_bf16 v65, v93, v19
    v_dot2c_f32_bf16 v62, v94, v18
    v_dot2c_f32_bf16 v63, v94, v19
    v_dot2c_f32_bf16 v66, v95, v18
    v_dot2c_f32_bf16 v67, v95, v19
    v_cvt_pk_bf16_f32 v84, v60, v61
    v_cvt_pk_bf16_f32 v85, v64, v65
    v_cvt_pk_bf16_f32 v86, v62, v63
    v_cvt_pk_bf16_f32 v87, v66, v67
    ds_write_b128 v7, v[84:87] offset:0
    buffer_store_dwordx4 v[100:103], v90, s[8:11], s25 offen sc1
    s_waitcnt lgkmcnt(0)
    s_barrier
    ds_read_b64_tr_b16 v[20:21], v8 offset:0
    ds_read_b64_tr_b16 v[22:23], v8 offset:512
    ds_read_b64_tr_b16 v[24:25], v8 offset:1024
    ds_read_b64_tr_b16 v[26:27], v8 offset:1536
    ds_read_b64_tr_b16 v[28:29], v8 offset:2048
    ds_read_b64_tr_b16 v[30:31], v8 offset:2560
    ds_read_b64_tr_b16 v[32:33], v8 offset:3072
    ds_read_b64_tr_b16 v[34:35], v8 offset:3584
    s_waitcnt lgkmcnt(6)
    v_mfma_f32_16x16x32_bf16 v[156:159], v[112:115], v[20:23], 0
    v_mfma_f32_16x16x32_bf16 v[160:163], v[128:131], v[20:23], 0
    v_mfma_f32_16x16x32_bf16 v[152:155], v[20:23], v[20:23], 0
    s_waitcnt lgkmcnt(4)
    v_mfma_f32_16x16x32_bf16 v[156:159], v[116:119], v[24:27], v[156:159]
    v_mfma_f32_16x16x32_bf16 v[160:163], v[132:135], v[24:27], v[160:163]
    v_mfma_f32_16x16x32_bf16 v[152:155], v[24:27], v[24:27], v[152:155]
    s_waitcnt lgkmcnt(2)
    v_mfma_f32_16x16x32_bf16 v[156:159], v[120:123], v[28:31], v[156:159]
    v_mfma_f32_16x16x32_bf16 v[160:163], v[136:139], v[28:31], v[160:163]
    v_mfma_f32_16x16x32_bf16 v[152:155], v[28:31], v[28:31], v[152:155]
    s_waitcnt lgkmcnt(0)
    v_mfma_f32_16x16x32_bf16 v[156:159], v[124:127], v[32:35], v[156:159]
    v_mfma_f32_16x16x32_bf16 v[160:163], v[140:143], v[32:35], v[160:163]
    v_mfma_f32_16x16x32_bf16 v[152:155], v[32:35], v[32:35], v[152:155]
    v_max3_f32 v174, v156, v157, v158
    s_nop 2
    v_max3_f32 v14, v159, v160, v161
    v_max3_f32 v174, v174, v162, v163
    s_nop 1
    v_max3_f32 v14, v14, v152, v153
    v_max_f32 v174, v174, v14
    v_max_f32 v15, v174, v174
    s_nop 1
    v_permlane16_swap_b32 v174, v15
    v_max_f32 v174, v174, v15
    v_mov_b32 v15, v174
    s_nop 1
    v_permlane32_swap_b32 v174, v15
    v_max_f32 v174, v174, v15
    v_mul_f32 v174, s32, v174
    v_pk_fma_f32 v[156:157], v[156:157], s[32:33], v[174:175] op_sel_hi:[1,1,0] neg_lo:[0,0,1] neg_hi:[0,0,1]
    v_pk_fma_f32 v[158:159], v[158:159], s[32:33], v[174:175] op_sel_hi:[1,1,0] neg_lo:[0,0,1] neg_hi:[0,0,1]
    v_pk_fma_f32 v[160:161], v[160:161], s[32:33], v[174:175] op_sel_hi:[1,1,0] neg_lo:[0,0,1] neg_hi:[0,0,1]
    v_pk_fma_f32 v[162:163], v[162:163], s[32:33], v[174:175] op_sel_hi:[1,1,0] neg_lo:[0,0,1] neg_hi:[0,0,1]
    v_pk_fma_f32 v[152:153], v[152:153], s[32:33], v[174:175] op_sel_hi:[1,1,0] neg_lo:[0,0,1] neg_hi:[0,0,1]
    v_exp_f32 v156, v156
    v_exp_f32 v157, v157
    v_exp_f32 v158, v158
    v_exp_f32 v159, v159
    v_cvt_pk_bf16_f32 v164, v156, v157
    v_exp_f32 v160, v160
    v_exp_f32 v161, v161
    v_cvt_pk_bf16_f32 v165, v158, v159
    v_exp_f32 v162, v162
    v_exp_f32 v163, v163
    v_cvt_pk_bf16_f32 v166, v160, v161
    v_exp_f32 v152, v152
    v_cvt_pk_bf16_f32 v167, v162, v163
    v_exp_f32 v153, v153
    s_waitcnt vmcnt(1)
    v_cmp_eq_u32 vcc, -1, v96
    v_pk_add_f32 v[14:15], v[156:157], v[158:159]
    v_mfma_f32_16x16x32_bf16 v[112:115], v[144:147], v[164:167], 0
    s_cbranch_vccnz R_xv_125
L_xv_124:
    v_dot2c_f32_bf16 v68, v96, v18
    v_dot2c_f32_bf16 v69, v96, v19
    v_mfma_f32_16x16x32_bf16 v[116:119], v[148:151], v[164:167], 0
    v_dot2c_f32_bf16 v70, v97, v18
    v_dot2c_f32_bf16 v71, v97, v19
    v_cvt_pk_bf16_f32 v168, v152, v153
    v_cvt_pk_bf16_f32 v170, v68, v69
    v_pk_add_f32 v[16:17], v[160:161], v[162:163]
    v_cvt_pk_bf16_f32 v172, v70, v71
    v_pk_add_f32 v[14:15], v[14:15], v[152:153]
    buffer_store_dwordx2 v[100:101], v91, s[8:11], s25 offen sc1
    v_permlane16_swap_b32 v170, v172
    v_pk_add_f32 v[14:15], v[14:15], v[16:17]
    s_nop 0
    v_permlane32_swap_b32 v170, v172
    v_add_f32 v175, v14, v15
    v_add_f32 v16, v14, v15
    v_mfma_f32_16x16x16_bf16 v[112:115], v[170:171], v[168:169], v[112:115]
    s_nop 0
    v_permlane16_swap_b32 v175, v16
    v_mfma_f32_16x16x16_bf16 v[116:119], v[172:173], v[168:169], v[116:119]
    v_add_f32 v175, v175, v16
    v_mov_b32 v16, v175
    v_mov_b32 v88, v170
    v_mov_b32 v89, v172
    v_permlane32_swap_b32 v175, v16
    v_add_f32 v174, v175, v16
    v_rcp_f32 v174, v174
    s_nop 0
    v_pk_mul_f32 v[112:113], v[112:113], v[174:175] op_sel_hi:[1,0]
    v_pk_mul_f32 v[114:115], v[114:115], v[174:175] op_sel_hi:[1,0]
    v_cvt_pk_bf16_f32 v112, v112, v113
    v_cvt_pk_bf16_f32 v113, v114, v115
    v_pk_mul_f32 v[116:117], v[116:117], v[174:175] op_sel_hi:[1,0]
    v_pk_mul_f32 v[118:119], v[118:119], v[174:175] op_sel_hi:[1,0]
    v_cvt_pk_bf16_f32 v116, v116, v117
    v_cvt_pk_bf16_f32 v117, v118, v119
    s_mov_b64 exec, s[28:29]
    ds_write_b64 v9, v[112:113] offset:0
    ds_write_b64 v9, v[116:117] offset:32
    s_mov_b64 exec, -1
    ds_write_b64 v98, v[88:89]
    s_waitcnt lgkmcnt(0)
    s_barrier
    ds_read_b128 v[120:123], v10 offset:0
    ds_read_b128 v[124:127], v10 offset:64
    ds_read_b128 v[128:131], v10 offset:128
    ds_read_b128 v[132:135], v10 offset:192
    s_cmp_eq_u32 s16, 63
    s_cbranch_scc1 L_chain_done_w1
    s_waitcnt lgkmcnt(3)
    v_smfmac_f32_16x16x64_bf16 v[72:75], v[120:123], a[240:247], v3
    s_waitcnt lgkmcnt(2)
    v_smfmac_f32_16x16x64_bf16 v[72:75], v[124:127], a[248:255], v3
    s_waitcnt lgkmcnt(1)
    v_smfmac_f32_16x16x64_bf16 v[72:75], v[128:131], v[176:183], v3
    s_waitcnt lgkmcnt(0)
    v_smfmac_f32_16x16x64_bf16 v[72:75], v[132:135], v[184:191], v3
    v_smfmac_f32_16x16x64_bf16 v[76:79], v[120:123], v[192:199], v3
    v_smfmac_f32_16x16x64_bf16 v[76:79], v[124:127], v[200:207], v3
    v_cvt_pk_bf16_f32 v72, v72, v73
    v_cvt_pk_bf16_f32 v73, v74, v75
    v_and_or_b32 v72, v72, -2, s26
    buffer_store_dwordx2 v[72:73], v4, s[8:11], 0 offen
    v_smfmac_f32_16x16x64_bf16 v[76:79], v[128:131], v[208:215], v3
    v_smfmac_f32_16x16x64_bf16 v[76:79], v[132:135], v[216:223], v3
    v_smfmac_f32_16x16x64_bf16 v[80:83], v[120:123], v[224:231], v3
    v_smfmac_f32_16x16x64_bf16 v[80:83], v[124:127], v[232:239], v3
    v_cvt_pk_bf16_f32 v76, v76, v77
    v_cvt_pk_bf16_f32 v77, v78, v79
    v_and_or_b32 v76, v76, -2, s26
    buffer_store_dwordx2 v[76:77], v4, s[8:11], s50 offen
    v_smfmac_f32_16x16x64_bf16 v[80:83], v[128:131], v[240:247], v3
    v_smfmac_f32_16x16x64_bf16 v[80:83], v[132:135], v[248:255], v3
    s_nop 7
    v_cvt_pk_bf16_f32 v80, v80, v81
    v_cvt_pk_bf16_f32 v81, v82, v83
    v_and_or_b32 v80, v80, -2, s26
    buffer_store_dwordx2 v[80:81], v4, s[8:11], s51 offen
    s_nop 3
    s_nop 3
    s_nop 3
    s_nop 3
    s_nop 3
    s_nop 3
    s_nop 3
    s_nop 3
    s_nop 3
    s_nop 3
    s_nop 3
    s_nop 3
    s_nop 3
    s_nop 3
    s_nop 3
    s_nop 3
    s_nop 3
    s_nop 3
    s_nop 3
    s_nop 3
    s_nop 3
    s_nop 3
    s_nop 3
    s_nop 3
    s_nop 3
    s_nop 3
    s_nop 3
    s_nop 3
    s_nop 3
    s_nop 3
    s_nop 3
    s_nop 3
    s_nop 3
    s_nop 3
    s_nop 3
    s_nop 3
    s_nop 3
    s_nop 3
    s_nop 3
    s_nop 3
    s_nop 3
    s_nop 3
    s_nop 3
    s_nop 3
    s_nop 3
    s_nop 3
    s_nop 3
    s_nop 3
    s_nop 3
    s_nop 3
    s_nop 3
    s_nop 3
    s_nop 3
    s_nop 3
    s_nop 3
    s_nop 3
    s_nop 3
    s_nop 3
    s_nop 3
    s_nop 3
    s_nop 3
    s_nop 3
    s_nop 3
    s_nop 3
    s_nop 3
    s_nop 3
    s_nop 3
    s_nop 3
    s_add_u32 s16, s16, 1
    s_xor_b32 s26, s26, 1
    s_lshl_b32 s38, s26, 11
    s_add_u32 s24, s70, s38
    s_add_u32 s25, s71, s38
    s_mov_b32 s38, s20
    s_mov_b32 s20, s22
    s_mov_b32 s22, s23
    s_mov_b32 s23, s38
    s_add_u32 s35, s35, 16384
    s_cmp_ge_u32 s35, 65536
    s_cselect_b32 s35, 16384, s35
    s_nop 3
    s_nop 3
    s_nop 3
    s_nop 3
    s_nop 3
    s_nop 3
    s_nop 3
    s_nop 3
    s_branch L_step_w1_120
L_ag_121_f0:
    s_sub_u32 s27, s27, 1
    s_cbranch_scc1 L_chain_abort
    buffer_load_dwordx4 v[144:147], v1, s[8:11], s78 offen sc1
    buffer_load_dwordx4 v[148:151], v1, s[8:11], s79 offen sc1
    buffer_load_dwordx4 v[152:155], v1, s[8:11], s80 offen sc1
    s_waitcnt vmcnt(0)
    v_max3_u32 v14, v144, v148, v152
    v_cmp_eq_u32 vcc, -1, v14
    s_cbranch_vccnz L_ag_121_f0
    ds_write_b128 v99, v[144:147]
    ds_write_b128 v5, v[148:151]
    ds_write_b128 v6, v[152:155]
    s_branch L_ag_121_w
R_x_123:
    s_sub_u32 s27, s27, 1
    s_cbranch_scc1 L_chain_abort
    buffer_load_dwordx4 v[92:95], v90, s[8:11], s25 offen sc1
    s_waitcnt vmcnt(0)
    v_cmp_eq_u32 vcc, -1, v92
    s_cbranch_vccnz R_x_123
    buffer_load_dwordx2 v[96:97], v91, s[8:11], s25 offen sc1
    s_branch L_x_122
R_xv_125:
    s_sub_u32 s27, s27, 1
    s_cbranch_scc1 L_chain_abort
    buffer_load_dwordx2 v[96:97], v91, s[8:11], s25 offen sc1
    s_waitcnt vmcnt(0)
    v_cmp_eq_u32 vcc, -1, v96
    s_cbranch_vccnz R_xv_125
    s_branch L_xv_124
L_chain_done_w1:
    s_branch L_chain_done
L_chain_w2:
    s_cmp_lg_u32 s19, 2
    s_cbranch_scc1 L_chain_w3
L_step_w2_126:
    s_add_u32 s78, s20, 3072
    buffer_load_dwordx4 v[144:147], v1, s[8:11], s78 offen sc1
    v_mov_b32 v60, 0
    v_mov_b32 v61, 0
    v_mov_b32 v62, 0
    v_mov_b32 v63, 0
    v_mov_b32 v64, 0
    v_mov_b32 v65, 0
    v_mov_b32 v66, 0
    v_mov_b32 v67, 0
    v_mov_b32 v68, 0
    v_mov_b32 v69, 0
    v_mov_b32 v70, 0
    v_mov_b32 v71, 0
    v_and_b32 v15, 7, v0
    v_mul_u32_u24 v15, 672, v15
    v_bfe_u32 v17, v0, 4, 2
    v_lshl_add_u32 v16, v17, 4, v15
L_ag_127:
    s_waitcnt vmcnt(0)
    v_cmp_eq_u32 vcc, -1, v144
    s_cbranch_vccnz L_ag_127_f0
    ds_write_b128 v99, v[144:147]
L_ag_127_w:
    s_waitcnt lgkmcnt(0)
    s_barrier
    ds_read_b128 v[20:23], v16 offset:8704
    ds_read_b128 v[24:27], v16 offset:8768
    ds_read_b128 v[28:31], v16 offset:8832
    s_waitcnt lgkmcnt(2)
    v_smfmac_f32_16x16x64_bf16 v[60:63], v[20:23], a[80:87], v3
    ds_read_b128 v[32:35], v16 offset:8896
    v_smfmac_f32_16x16x64_bf16 v[64:67], v[20:23], a[0:7], v3
    s_waitcnt lgkmcnt(2)
    v_smfmac_f32_16x16x64_bf16 v[60:63], v[24:27], a[88:95], v3
    ds_read_b128 v[36:39], v16 offset:8960
    v_smfmac_f32_16x16x64_bf16 v[64:67], v[24:27], a[8:15], v3
    s_waitcnt lgkmcnt(2)
    v_smfmac_f32_16x16x64_bf16 v[60:63], v[28:31], a[96:103], v3
    ds_read_b128 v[40:43], v16 offset:9024
    v_smfmac_f32_16x16x64_bf16 v[64:67], v[28:31], a[16:23], v3
    s_waitcnt lgkmcnt(2)
    v_smfmac_f32_16x16x64_bf16 v[60:63], v[32:35], a[104:111], v3
    ds_read_b128 v[44:47], v16 offset:9088
    v_smfmac_f32_16x16x64_bf16 v[64:67], v[32:35], a[24:31], v3
    s_waitcnt lgkmcnt(2)
    v_smfmac_f32_16x16x64_bf16 v[60:63], v[36:39], a[112:119], v3
    ds_read_b128 v[48:51], v16 offset:9152
    v_smfmac_f32_16x16x64_bf16 v[64:67], v[36:39], a[32:39], v3
    s_waitcnt lgkmcnt(2)
    v_smfmac_f32_16x16x64_bf16 v[60:63], v[40:43], a[120:127], v3
    ds_read_b128 v[52:55], v16 offset:9216
    v_smfmac_f32_16x16x64_bf16 v[64:67], v[40:43], a[40:47], v3
    s_waitcnt lgkmcnt(2)
    v_smfmac_f32_16x16x64_bf16 v[60:63], v[44:47], a[128:135], v3
    ds_read_b128 v[56:59], v16 offset:9280
    v_smfmac_f32_16x16x64_bf16 v[64:67], v[44:47], a[48:55], v3
    s_waitcnt lgkmcnt(2)
    v_smfmac_f32_16x16x64_bf16 v[60:63], v[48:51], a[136:143], v3
    v_smfmac_f32_16x16x64_bf16 v[64:67], v[48:51], a[56:63], v3
    s_waitcnt lgkmcnt(1)
    v_smfmac_f32_16x16x64_bf16 v[60:63], v[52:55], a[144:151], v3
    v_smfmac_f32_16x16x64_bf16 v[64:67], v[52:55], a[64:71], v3
    s_waitcnt lgkmcnt(0)
    v_smfmac_f32_16x16x64_bf16 v[60:63], v[56:59], a[152:159], v3
    v_smfmac_f32_16x16x64_bf16 v[64:67], v[56:59], a[72:79], v3
    v_smfmac_f32_16x16x64_bf16 v[68:71], v[20:23], a[160:167], v3
    v_cvt_pk_bf16_f32 v84, v60, v61
    v_cvt_pk_bf16_f32 v86, v62, v63
    s_nop 1
    v_cvt_pk_bf16_f32 v85, v64, v65
    v_cvt_pk_bf16_f32 v87, v66, v67
    s_waitcnt vmcnt(0)
    buffer_store_dwordx4 v[84:87], v90, s[8:11], s24 offen sc1
    v_smfmac_f32_16x16x64_bf16 v[68:71], v[24:27], a[168:175], v3
    v_add_u32 v11, s35, v1
    v_smfmac_f32_16x16x64_bf16 v[68:71], v[28:31], a[176:183], v3
    ds_read_b128 v[112:115], v11 offset:0
    v_smfmac_f32_16x16x64_bf16 v[68:71], v[32:35], a[184:191], v3
    ds_read_b128 v[116:119], v11 offset:1024
    v_smfmac_f32_16x16x64_bf16 v[68:71], v[36:39], a[192:199], v3
    ds_read_b128 v[120:123], v11 offset:2048
    v_smfmac_f32_16x16x64_bf16 v[68:71], v[40:43], a[200:207], v3
    ds_read_b128 v[124:127], v11 offset:3072
    v_smfmac_f32_16x16x64_bf16 v[68:71], v[44:47], a[208:215], v3
    ds_read_b128 v[128:131], v11 offset:4096
    v_smfmac_f32_16x16x64_bf16 v[68:71], v[48:51], a[216:223], v3
    ds_read_b128 v[132:135], v11 offset:5120
    v_smfmac_f32_16x16x64_bf16 v[68:71], v[52:55], a[224:231], v3
    ds_read_b128 v[136:139], v11 offset:6144
    v_smfmac_f32_16x16x64_bf16 v[68:71], v[56:59], a[232:239], v3
    ds_read_b128 v[140:143], v11 offset:7168
    s_lshl_b32 s38, s19, 11
    v_add_u32 v12, s38, v11
    ds_read_b128 v[144:147], v12 offset:8192
    ds_read_b128 v[148:151], v12 offset:9216
    s_nop 2
    v_cvt_pk_bf16_f32 v88, v68, v69
    v_cvt_pk_bf16_f32 v89, v70, v71
    buffer_store_dwordx2 v[88:89], v91, s[8:11], s24 offen sc1
    s_nop 3
    s_nop 3
    s_nop 3
    s_nop 3
    s_nop 3
    s_nop 3
    s_nop 3
    s_nop 3
    buffer_load_dwordx4 v[92:95], v90, s[8:11], s25 offen sc1
    v_mov_b32 v72, 0
    v_mov_b32 v73, 0
    v_mov_b32 v74, 0
    v_mov_b32 v75, 0
    v_mov_b32 v76, 0
    v_mov_b32 v77, 0
    v_mov_b32 v78, 0
    v_mov_b32 v79, 0
    s_add_u32 s37, s16, 2
    s_min_u32 s37, s37, 63
    s_add_u32 s36, s36, 16384
    s_cmp_ge_u32 s36, 65536
    s_cselect_b32 s36, 16384, s36
    s_lshl_b32 s38, s37, 5
    s_add_u32 s38, s38, s17
    s_lshl_b32 s38, s38, 13
    s_add_u32 s72, s38, 0
    s_add_u32 s73, s38, 4096
    s_add_u32 s74, s38, 16777216
    s_add_u32 s75, s38, 16781312
    s_waitcnt vmcnt(0)
    v_cmp_eq_u32 vcc, -1, v92
    s_cbranch_vccnz R_x_129
L_x_128_first:
    buffer_load_dwordx2 v[96:97], v91, s[8:11], s25 offen sc1
L_x_128:
    v_dot2c_f32_bf16 v60, v92, v18
    v_dot2c_f32_bf16 v61, v92, v19
    v_dot2c_f32_bf16 v64, v93, v18
    v_dot2c_f32_bf16 v65, v93, v19
    v_dot2c_f32_bf16 v62, v94, v18
    v_dot2c_f32_bf16 v63, v94, v19
    v_dot2c_f32_bf16 v66, v95, v18
    v_dot2c_f32_bf16 v67, v95, v19
    v_cvt_pk_bf16_f32 v84, v60, v61
    v_cvt_pk_bf16_f32 v85, v64, v65
    v_cvt_pk_bf16_f32 v86, v62, v63
    v_cvt_pk_bf16_f32 v87, v66, v67
    ds_write_b128 v7, v[84:87] offset:0
    buffer_store_dwordx4 v[100:103], v90, s[8:11], s25 offen sc1
    s_waitcnt lgkmcnt(0)
    s_barrier
    ds_read_b64_tr_b16 v[20:21], v8 offset:0
    ds_read_b64_tr_b16 v[22:23], v8 offset:512
    ds_read_b64_tr_b16 v[24:25], v8 offset:1024
    ds_read_b64_tr_b16 v[26:27], v8 offset:1536
    ds_read_b64_tr_b16 v[28:29], v8 offset:2048
    ds_read_b64_tr_b16 v[30:31], v8 offset:2560
    ds_read_b64_tr_b16 v[32:33], v8 offset:3072
    ds_read_b64_tr_b16 v[34:35], v8 offset:3584
    s_waitcnt lgkmcnt(6)
    v_mfma_f32_16x16x32_bf16 v[156:159], v[112:115], v[20:23], 0
    v_mfma_f32_16x16x32_bf16 v[160:163], v[128:131], v[20:23], 0
    v_mfma_f32_16x16x32_bf16 v[152:155], v[20:23], v[20:23], 0
    s_waitcnt lgkmcnt(4)
    v_mfma_f32_16x16x32_bf16 v[156:159], v[116:119], v[24:27], v[156:159]
    v_mfma_f32_16x16x32_bf16 v[160:163], v[132:135], v[24:27], v[160:163]
    v_mfma_f32_16x16x32_bf16 v[152:155], v[24:27], v[24:27], v[152:155]
    s_waitcnt lgkmcnt(2)
    v_mfma_f32_16x16x32_bf16 v[156:159], v[120:123], v[28:31], v[156:159]
    v_mfma_f32_16x16x32_bf16 v[160:163], v[136:139], v[28:31], v[160:163]
    v_mfma_f32_16x16x32_bf16 v[152:155], v[28:31], v[28:31], v[152:155]
    s_waitcnt lgkmcnt(0)
    v_mfma_f32_16x16x32_bf16 v[156:159], v[124:127], v[32:35], v[156:159]
    v_mfma_f32_16x16x32_bf16 v[160:163], v[140:143], v[32:35], v[160:163]
    v_mfma_f32_16x16x32_bf16 v[152:155], v[32:35], v[32:35], v[152:155]
    v_max3_f32 v174, v156, v157, v158
    s_nop 2
    v_max3_f32 v14, v159, v160, v161
    v_max3_f32 v174, v174, v162, v163
    s_nop 1
    v_max3_f32 v14, v14, v152, v153
    v_max_f32 v174, v174, v14
    v_max_f32 v15, v174, v174
    s_nop 1
    v_permlane16_swap_b32 v174, v15
    v_max_f32 v174, v174, v15
    v_mov_b32 v15, v174
    s_nop 1
    v_permlane32_swap_b32 v174, v15
    v_max_f32 v174, v174, v15
    v_mul_f32 v174, s32, v174
    v_pk_fma_f32 v[156:157], v[156:157], s[32:33], v[174:175] op_sel_hi:[1,1,0] neg_lo:[0,0,1] neg_hi:[0,0,1]
    v_pk_fma_f32 v[158:159], v[158:159], s[32:33], v[174:175] op_sel_hi:[1,1,0] neg_lo:[0,0,1] neg_hi:[0,0,1]
    v_pk_fma_f32 v[160:161], v[160:161], s[32:33], v[174:175] op_sel_hi:[1,1,0] neg_lo:[0,0,1] neg_hi:[0,0,1]
    v_pk_fma_f32 v[162:163], v[162:163], s[32:33], v[174:175] op_sel_hi:[1,1,0] neg_lo:[0,0,1] neg_hi:[0,0,1]
    v_pk_fma_f32 v[152:153], v[152:153], s[32:33], v[174:175] op_sel_hi:[1,1,0] neg_lo:[0,0,1] neg_hi:[0,0,1]
    v_exp_f32 v156, v156
    v_exp_f32 v157, v157
    v_exp_f32 v158, v158
    v_exp_f32 v159, v159
    v_cvt_pk_bf16_f32 v164, v156, v157
    v_exp_f32 v160, v160
    v_exp_f32 v161, v161
    v_cvt_pk_bf16_f32 v165, v158, v159
    v_exp_f32 v162, v162
    v_exp_f32 v163, v163
    v_cvt_pk_bf16_f32 v166, v160, v161
    v_exp_f32 v152, v152
    v_cvt_pk_bf16_f32 v167, v162, v163
    v_exp_f32 v153, v153
    s_waitcnt vmcnt(1)
    v_cmp_eq_u32 vcc, -1, v96
    v_pk_add_f32 v[14:15], v[156:157], v[158:159]
    v_mfma_f32_16x16x32_bf16 v[112:115], v[144:147], v[164:167], 0
    s_cbranch_vccnz R_xv_131
L_xv_130:
    v_dot2c_f32_bf16 v68, v96, v18
    v_dot2c_f32_bf16 v69, v96, v19
    v_mfma_f32_16x16x32_bf16 v[116:119], v[148:151], v[164:167], 0
    v_dot2c_f32_bf16 v70, v97, v18
    v_dot2c_f32_bf16 v71, v97, v19
    v_cvt_pk_bf16_f32 v168, v152, v153
    v_cvt_pk_bf16_f32 v170, v68, v69
    v_pk_add_f32 v[16:17], v[160:161], v[162:163]
    v_cvt_pk_bf16_f32 v172, v70, v71
    v_pk_add_f32 v[14:15], v[14:15], v[152:153]
    buffer_store_dwordx2 v[100:101], v91, s[8:11], s25 offen sc1
    v_permlane16_swap_b32 v170, v172
    v_pk_add_f32 v[14:15], v[14:15], v[16:17]
    s_nop 0
    v_permlane32_swap_b32 v170, v172
    v_add_f32 v175, v14, v15
    v_add_f32 v16, v14, v15
    v_mfma_f32_16x16x16_bf16 v[112:115], v[170:171], v[168:169], v[112:115]
    s_nop 0
    v_permlane16_swap_b32 v175, v16
    v_mfma_f32_16x16x16_bf16 v[116:119], v[172:173], v[168:169], v[116:119]
    v_add_f32 v175, v175, v16
    v_mov_b32 v16, v175
    v_mov_b32 v88, v170
    v_mov_b32 v89, v172
    v_permlane32_swap_b32 v175, v16
    v_add_f32 v174, v175, v16
    v_rcp_f32 v174, v174
    s_nop 0
    v_pk_mul_f32 v[112:113], v[112:113], v[174:175] op_sel_hi:[1,0]
    v_pk_mul_f32 v[114:115], v[114:115], v[174:175] op_sel_hi:[1,0]
    v_cvt_pk_bf16_f32 v112, v112, v113
    v_cvt_pk_bf16_f32 v113, v114, v115
    v_pk_mul_f32 v[116:117], v[116:117], v[174:175] op_sel_hi:[1,0]
    v_pk_mul_f32 v[118:119], v[118:119], v[174:175] op_sel_hi:[1,0]
    v_cvt_pk_bf16_f32 v116, v116, v117
    v_cvt_pk_bf16_f32 v117, v118, v119
    s_mov_b64 exec, s[28:29]
    ds_write_b64 v9, v[112:113] offset:0
    ds_write_b64 v9, v[116:117] offset:32
    s_mov_b64 exec, -1
    ds_write_b64 v98, v[88:89]
    s_mov_b64 exec, s[30:31]
    buffer_store_dword v100, v6, s[8:11], s23 offen
    buffer_store_dword v100, v6, s[8:11], s23 offen offset:640
    s_mov_b64 exec, -1
L_nrst_132:
    s_waitcnt lgkmcnt(0)
    s_barrier
    ds_read_b128 v[120:123], v10 offset:0
    ds_read_b128 v[124:127], v10 offset:64
    ds_read_b128 v[128:131], v10 offset:128
    ds_read_b128 v[132:135], v10 offset:192
    s_cmp_eq_u32 s16, 63
    s_cbranch_scc1 L_chain_done_w2
    s_waitcnt lgkmcnt(3)
    v_smfmac_f32_16x16x64_bf16 v[72:75], v[120:123], a[240:247], v3
    s_waitcnt lgkmcnt(2)
    v_smfmac_f32_16x16x64_bf16 v[72:75], v[124:127], a[248:255], v3
    s_waitcnt lgkmcnt(1)
    v_smfmac_f32_16x16x64_bf16 v[72:75], v[128:131], v[176:183], v3
    s_waitcnt lgkmcnt(0)
    v_smfmac_f32_16x16x64_bf16 v[72:75], v[132:135], v[184:191], v3
    v_smfmac_f32_16x16x64_bf16 v[76:79], v[120:123], v[192:199], v3
    v_smfmac_f32_16x16x64_bf16 v[76:79], v[124:127], v[200:207], v3
    v_cvt_pk_bf16_f32 v72, v72, v73
    v_cvt_pk_bf16_f32 v73, v74, v75
    v_and_or_b32 v72, v72, -2, s26
    buffer_store_dwordx2 v[72:73], v4, s[8:11], 0 offen
    v_smfmac_f32_16x16x64_bf16 v[76:79], v[128:131], v[208:215], v3
    v_smfmac_f32_16x16x64_bf16 v[76:79], v[132:135], v[216:223], v3
    s_nop 7
    v_cvt_pk_bf16_f32 v76, v76, v77
    v_cvt_pk_bf16_f32 v77, v78, v79
    v_and_or_b32 v76, v76, -2, s26
    buffer_store_dwordx2 v[76:77], v4, s[8:11], s50 offen
    s_nop 3
    s_nop 3
    s_nop 3
    s_nop 3
    s_nop 3
    s_nop 3
    s_nop 3
    s_nop 3
    s_nop 3
    s_nop 3
    s_nop 3
    s_nop 3
    s_nop 3
    s_nop 3
    s_nop 3
    s_nop 3
    s_nop 3
    s_nop 3
    s_nop 3
    s_nop 3
    s_nop 3
    s_nop 3
    s_nop 3
    s_nop 3
    v_mov_b32 v17, s26
    buffer_load_dwordx4 v[20:23], v5, s[8:11], 0 offen offset:0 sc1
    buffer_load_dwordx4 v[24:27], v5, s[8:11], 0 offen offset:1024 sc1
    buffer_load_dwordx4 v[28:31], v5, s[8:11], 0 offen offset:2048 sc1
    buffer_load_dwordx4 v[32:35], v5, s[8:11], 0 offen offset:3072 sc1
    s_waitcnt vmcnt(3)
    v_mfma_f32_16x16x32_bf16 v[108:111], v[104:107], v[20:23], 0
    s_waitcnt vmcnt(2)
    v_mfma_f32_16x16x32_bf16 v[108:111], v[104:107], v[24:27], v[108:111]
    v_bitop3_b32 v14, v20, v24, v17 bitop3:0x7e
    s_waitcnt vmcnt(1)
    v_mfma_f32_16x16x32_bf16 v[108:111], v[104:107], v[28:31], v[108:111]
    s_waitcnt vmcnt(0)
    v_bitop3_b32 v15, v28, v32, v17 bitop3:0x7e
    v_mfma_f32_16x16x32_bf16 v[108:111], v[104:107], v[32:35], v[108:111]
    v_bitop3_b32 v14, v14, v15, 1 bitop3:0xa8
    v_cmp_ne_u32 vcc, 0, v14
    s_cbranch_vccnz R_rs_135_0
L_rs_134:
    s_nop 4
    v_add_f32_dpp v108, v108, v108 row_ror:8 row_mask:0xf bank_mask:0xf
    v_add_f32_dpp v109, v109, v109 row_ror:8 row_mask:0xf bank_mask:0xf
    s_nop 0
    v_mov_b32_dpp v110, v108 quad_perm:[1,0,3,2] row_mask:0xf bank_mask:0xf
    v_mov_b32_dpp v111, v109 quad_perm:[1,0,3,2] row_mask:0xf bank_mask:0xf
    v_cvt_pk_bf16_f32 v108, v108, v110
    v_cvt_pk_bf16_f32 v109, v109, v111
    v_min_u32 v108, -2, v108
    v_min_u32 v109, -2, v109
    s_mov_b64 exec, s[30:31]
    buffer_store_dword v108, v6, s[8:11], s22 offen
    buffer_store_dword v109, v6, s[8:11], s22 offen offset:640
    s_mov_b64 exec, -1
    s_add_u32 s16, s16, 1
    s_xor_b32 s26, s26, 1
    s_lshl_b32 s38, s26, 11
    s_add_u32 s24, s70, s38
    s_add_u32 s25, s71, s38
    s_mov_b32 s38, s20
    s_mov_b32 s20, s22
    s_mov_b32 s22, s23
    s_mov_b32 s23, s38
    s_add_u32 s35, s35, 16384
    s_cmp_ge_u32 s35, 65536
    s_cselect_b32 s35, 16384, s35
    s_nop 3
    s_nop 3
    s_nop 3
    s_nop 3
    s_nop 3
    s_nop 3
    s_nop 3
    s_nop 3
    s_branch L_step_w2_126
L_ag_127_f0:
    s_sub_u32 s27, s27, 1
    s_cbranch_scc1 L_chain_abort
    buffer_load_dwordx4 v[144:147], v1, s[8:11], s78 offen sc1
    s_waitcnt vmcnt(0)
    v_cmp_eq_u32 vcc, -1, v144
    s_cbranch_vccnz L_ag_127_f0
    ds_write_b128 v99, v[144:147]
    s_branch L_ag_127_w
R_x_129:
    s_sub_u32 s27, s27, 1
    s_cbranch_scc1 L_chain_abort
    buffer_load_dwordx4 v[92:95], v90, s[8:11], s25 offen sc1
    s_waitcnt vmcnt(0)
    v_cmp_eq_u32 vcc, -1, v92
    s_cbranch_vccnz R_x_129
    buffer_load_dwordx2 v[96:97], v91, s[8:11], s25 offen sc1
    s_branch L_x_128
R_xv_131:
    s_sub_u32 s27, s27, 1
    s_cbranch_scc1 L_chain_abort
    buffer_load_dwordx2 v[96:97], v91, s[8:11], s25 offen sc1
    s_waitcnt vmcnt(0)
    v_cmp_eq_u32 vcc, -1, v96
    s_cbranch_vccnz R_xv_131
    s_branch L_xv_130
R_rs_135_0:
    s_sub_u32 s27, s27, 1
    s_cbranch_scc1 L_chain_abort
    s_nop 3
    buffer_load_dwordx4 v[20:23], v5, s[8:11], 0 offen offset:0 sc1
    buffer_load_dwordx4 v[24:27], v5, s[8:11], 0 offen offset:1024 sc1
    buffer_load_dwordx4 v[28:31], v5, s[8:11], 0 offen offset:2048 sc1
    buffer_load_dwordx4 v[32:35], v5, s[8:11], 0 offen offset:3072 sc1
    s_waitcnt vmcnt(3)
    v_mfma_f32_16x16x32_bf16 v[108:111], v[104:107], v[20:23], 0
    s_waitcnt vmcnt(2)
    v_mfma_f32_16x16x32_bf16 v[108:111], v[104:107], v[24:27], v[108:111]
    v_bitop3_b32 v14, v20, v24, v17 bitop3:0x7e
    s_waitcnt vmcnt(1)
    v_mfma_f32_16x16x32_bf16 v[108:111], v[104:107], v[28:31], v[108:111]
    s_waitcnt vmcnt(0)
    v_bitop3_b32 v15, v28, v32, v17 bitop3:0x7e
    v_mfma_f32_16x16x32_bf16 v[108:111], v[104:107], v[32:35], v[108:111]
    v_bitop3_b32 v14, v14, v15, 1 bitop3:0xa8
    v_cmp_ne_u32 vcc, 0, v14
    s_cbranch_vccnz R_rs_135_0
    s_branch L_rs_134
L_chain_done_w2:
    s_branch L_chain_done
L_chain_w3:
    s_cmp_lg_u32 s18, 0
    s_cbranch_scc1 L_chain_w3x1
L_step_w3x0_137:
    v_mov_b32 v60, 0
    v_mov_b32 v61, 0
    v_mov_b32 v62, 0
    v_mov_b32 v63, 0
    v_mov_b32 v64, 0
    v_mov_b32 v65, 0
    v_mov_b32 v66, 0
    v_mov_b32 v67, 0
    v_mov_b32 v68, 0
    v_mov_b32 v69, 0
    v_mov_b32 v70, 0
    v_mov_b32 v71, 0
    v_and_b32 v15, 7, v0
    v_mul_u32_u24 v15, 672, v15
    v_bfe_u32 v17, v0, 4, 2
    v_lshl_add_u32 v16, v17, 4, v15
    s_barrier
    ds_read_b128 v[20:23], v16 offset:8704
    ds_read_b128 v[24:27], v16 offset:8768
    ds_read_b128 v[28:31], v16 offset:8832
    s_waitcnt lgkmcnt(2)
    v_smfmac_f32_16x16x64_bf16 v[60:63], v[20:23], a[80:87], v3
    ds_read_b128 v[32:35], v16 offset:8896
    v_smfmac_f32_16x16x64_bf16 v[64:67], v[20:23], a[0:7], v3
    s_waitcnt lgkmcnt(2)
    v_smfmac_f32_16x16x64_bf16 v[60:63], v[24:27], a[88:95], v3
    ds_read_b128 v[36:39], v16 offset:8960
    v_smfmac_f32_16x16x64_bf16 v[64:67], v[24:27], a[8:15], v3
    s_waitcnt lgkmcnt(2)
    v_smfmac_f32_16x16x64_bf16 v[60:63], v[28:31], a[96:103], v3
    ds_read_b128 v[40:43], v16 offset:9024
    v_smfmac_f32_16x16x64_bf16 v[64:67], v[28:31], a[16:23], v3
    s_waitcnt lgkmcnt(2)
    v_smfmac_f32_16x16x64_bf16 v[60:63], v[32:35], a[104:111], v3
    ds_read_b128 v[44:47], v16 offset:9088
    v_smfmac_f32_16x16x64_bf16 v[64:67], v[32:35], a[24:31], v3
    s_waitcnt lgkmcnt(2)
    v_smfmac_f32_16x16x64_bf16 v[60:63], v[36:39], a[112:119], v3
    ds_read_b128 v[48:51], v16 offset:9152
    v_smfmac_f32_16x16x64_bf16 v[64:67], v[36:39], a[32:39], v3
    s_waitcnt lgkmcnt(2)
    v_smfmac_f32_16x16x64_bf16 v[60:63], v[40:43], a[120:127], v3
    ds_read_b128 v[52:55], v16 offset:9216
    v_smfmac_f32_16x16x64_bf16 v[64:67], v[40:43], a[40:47], v3
    s_waitcnt lgkmcnt(2)
    v_smfmac_f32_16x16x64_bf16 v[60:63], v[44:47], a[128:135], v3
    ds_read_b128 v[56:59], v16 offset:9280
    v_smfmac_f32_16x16x64_bf16 v[64:67], v[44:47], a[48:55], v3
    s_waitcnt lgkmcnt(2)
    v_smfmac_f32_16x16x64_bf16 v[60:63], v[48:51], a[136:143], v3
    v_smfmac_f32_16x16x64_bf16 v[64:67], v[48:51], a[56:63], v3
    s_waitcnt lgkmcnt(1)
    v_smfmac_f32_16x16x64_bf16 v[60:63], v[52:55], a[144:151], v3
    v_smfmac_f32_16x16x64_bf16 v[64:67], v[52:55], a[64:71], v3
    s_waitcnt lgkmcnt(0)
    v_smfmac_f32_16x16x64_bf16 v[60:63], v[56:59], a[152:159], v3
    v_smfmac_f32_16x16x64_bf16 v[64:67], v[56:59], a[72:79], v3
    v_smfmac_f32_16x16x64_bf16 v[68:71], v[20:23], a[160:167], v3
    v_cvt_pk_bf16_f32 v84, v60, v61
    v_cvt_pk_bf16_f32 v86, v62, v63
    s_nop 1
    v_cvt_pk_bf16_f32 v85, v64, v65
    v_cvt_pk_bf16_f32 v87, v66, v67
    buffer_store_dwordx4 v[84:87], v90, s[8:11], s24 offen sc1
    v_smfmac_f32_16x16x64_bf16 v[68:71], v[24:27], a[168:175], v3
    v_add_u32 v11, s35, v1
    v_smfmac_f32_16x16x64_bf16 v[68:71], v[28:31], a[176:183], v3
    ds_read_b128 v[112:115], v11 offset:0
    v_smfmac_f32_16x16x64_bf16 v[68:71], v[32:35], a[184:191], v3
    ds_read_b128 v[116:119], v11 offset:1024
    v_smfmac_f32_16x16x64_bf16 v[68:71], v[36:39], a[192:199], v3
    ds_read_b128 v[120:123], v11 offset:2048
    v_smfmac_f32_16x16x64_bf16 v[68:71], v[40:43], a[200:207], v3
    ds_read_b128 v[124:127], v11 offset:3072
    v_smfmac_f32_16x16x64_bf16 v[68:71], v[44:47], a[208:215], v3
    ds_read_b128 v[128:131], v11 offset:4096
    v_smfmac_f32_16x16x64_bf16 v[68:71], v[48:51], a[216:223], v3
    ds_read_b128 v[132:135], v11 offset:5120
    v_smfmac_f32_16x16x64_bf16 v[68:71], v[52:55], a[224:231], v3
    ds_read_b128 v[136:139], v11 offset:6144
    v_smfmac_f32_16x16x64_bf16 v[68:71], v[56:59], a[232:239], v3
    ds_read_b128 v[140:143], v11 offset:7168
    s_lshl_b32 s38, s19, 11
    v_add_u32 v12, s38, v11
    ds_read_b128 v[144:147], v12 offset:8192
    ds_read_b128 v[148:151], v12 offset:9216
    s_nop 2
    v_cvt_pk_bf16_f32 v88, v68, v69
    v_cvt_pk_bf16_f32 v89, v70, v71
    buffer_store_dwordx2 v[88:89], v91, s[8:11], s24 offen sc1
    s_nop 3
    s_nop 3
    s_nop 3
    s_nop 3
    s_nop 3
    s_nop 3
    s_nop 3
    s_nop 3
    buffer_load_dwordx4 v[92:95], v90, s[8:11], s25 offen sc1
    v_mov_b32 v72, 0
    v_mov_b32 v73, 0
    v_mov_b32 v74, 0
    v_mov_b32 v75, 0
    v_mov_b32 v76, 0
    v_mov_b32 v77, 0
    v_mov_b32 v78, 0
    v_mov_b32 v79, 0
    s_add_u32 s37, s16, 2
    s_min_u32 s37, s37, 63
    s_add_u32 s36, s36, 16384
    s_cmp_ge_u32 s36, 65536
    s_cselect_b32 s36, 16384, s36
    s_lshl_b32 s38, s37, 5
    s_add_u32 s38, s38, s17
    s_lshl_b32 s38, s38, 13
    s_add_u32 s72, s38, 0
    s_add_u32 s73, s38, 4096
    s_add_u32 s74, s38, 16777216
    s_add_u32 s75, s38, 16781312
    s_add_u32 s37, s16, 3
    s_min_u32 s37, s37, 63
    s_lshr_b32 s38, s37, 2
    s_lshl_b32 s38, s38, 5
    s_add_u32 s38, s38, s17
    s_lshl_b32 s38, s38, 2
    s_add_u32 s38, s38, 102760448
    v_mov_b32 v16, s38
    s_add_u32 s37, s16, 4
    s_min_u32 s37, s37, 63
    s_lshr_b32 s38, s37, 2
    s_lshl_b32 s38, s38, 5
    s_add_u32 s38, s38, s17
    s_lshl_b32 s38, s38, 2
    s_add_u32 s38, s38, 102760448
    v_mov_b32 v12, s38
    s_lshl_b32 s38, s16, 17
    s_add_u32 s76, s38, s45
    s_sub_u32 s39, s16, 1
    s_max_i32 s39, s39, 0
    s_lshl_b32 s38, s39, 16
    s_add_u32 s77, s38, s46
    v_add_u32 v14, 6400, v1
    ds_read_b128 v[164:167], v14
    v_mov_b32 v99, s47
    v_mov_b32 v2, s39
    s_waitcnt vmcnt(0)
    v_cmp_eq_u32 vcc, -1, v92
    s_cbranch_vccnz R_x_140
L_x_139_first:
    buffer_load_dwordx2 v[96:97], v91, s[8:11], s25 offen sc1
L_x_139:
    v_dot2c_f32_bf16 v60, v92, v18
    v_dot2c_f32_bf16 v61, v92, v19
    v_dot2c_f32_bf16 v64, v93, v18
    v_dot2c_f32_bf16 v65, v93, v19
    v_dot2c_f32_bf16 v62, v94, v18
    v_dot2c_f32_bf16 v63, v94, v19
    v_dot2c_f32_bf16 v66, v95, v18
    v_dot2c_f32_bf16 v67, v95, v19
    v_cvt_pk_bf16_f32 v84, v60, v61
    v_cvt_pk_bf16_f32 v85, v64, v65
    v_cvt_pk_bf16_f32 v86, v62, v63
    v_cvt_pk_bf16_f32 v87, v66, v67
    ds_write_b128 v7, v[84:87] offset:0
    buffer_store_dwordx4 v[100:103], v90, s[8:11], s25 offen sc1
    s_waitcnt lgkmcnt(0)
    s_barrier
    ds_read_b64_tr_b16 v[20:21], v8 offset:0
    ds_read_b64_tr_b16 v[22:23], v8 offset:512
    ds_read_b64_tr_b16 v[24:25], v8 offset:1024
    ds_read_b64_tr_b16 v[26:27], v8 offset:1536
    ds_read_b64_tr_b16 v[28:29], v8 offset:2048
    ds_read_b64_tr_b16 v[30:31], v8 offset:2560
    ds_read_b64_tr_b16 v[32:33], v8 offset:3072
    ds_read_b64_tr_b16 v[34:35], v8 offset:3584
    s_waitcnt lgkmcnt(6)
    v_mfma_f32_16x16x32_bf16 v[156:159], v[112:115], v[20:23], 0
    buffer_store_dwordx4 v[20:23], v1, s[8:11], s76 offen offset:0 sc1
    s_add_u32 m0, s36, 0
    s_nop 0
    buffer_load_dwordx4 v1, s[8:11], s72 offen sc1 lds
    v_mfma_f32_16x16x32_bf16 v[160:163], v[128:131], v[20:23], 0
    v_readfirstlane_b32 s39, v13
    buffer_load_dwordx4 v1, s[8:11], s72 offen offset:1024 sc1 lds
    v_mfma_f32_16x16x32_bf16 v[152:155], v[20:23], v[20:23], 0
    s_cmp_lt_u32 s39, 2
    buffer_load_dwordx4 v1, s[8:11], s72 offen offset:2048 sc1 lds
    s_waitcnt lgkmcnt(4)
    v_mfma_f32_16x16x32_bf16 v[156:159], v[116:119], v[24:27], v[156:159]
    buffer_store_dwordx4 v[24:27], v1, s[8:11], s76 offen offset:1024 sc1
    buffer_load_dwordx4 v1, s[8:11], s72 offen offset:3072 sc1 lds
    v_mfma_f32_16x16x32_bf16 v[160:163], v[132:135], v[24:27], v[160:163]
    s_cbranch_scc1 L_kvsp_142
L_kvok_141:
    s_add_u32 m0, s36, 4096
    s_nop 0
    buffer_load_dwordx4 v1, s[8:11], s73 offen sc1 lds
    v_mfma_f32_16x16x32_bf16 v[152:155], v[24:27], v[24:27], v[152:155]
    buffer_store_dwordx4 v[164:167], v1, s[8:11], s77 offen offset:0 sc1
    buffer_load_dwordx4 v1, s[8:11], s73 offen offset:1024 sc1 lds
    s_waitcnt lgkmcnt(2)
    v_mfma_f32_16x16x32_bf16 v[156:159], v[120:123], v[28:31], v[156:159]
    s_mov_b64 exec, 1
    buffer_store_dword v2, v99, s[8:11], 0 offen sc1
    s_mov_b64 exec, -1
    buffer_load_dwordx4 v1, s[8:11], s73 offen offset:2048 sc1 lds
    buffer_load_dwordx4 v1, s[8:11], s73 offen offset:3072 sc1 lds
    v_mfma_f32_16x16x32_bf16 v[160:163], v[136:139], v[28:31], v[160:163]
    buffer_load_dword v13, v12, s[8:11], 0 offen sc1
    s_add_u32 m0, s36, 8192
    s_nop 0
    buffer_load_dwordx4 v1, s[8:11], s74 offen sc1 lds
    buffer_load_dwordx4 v1, s[8:11], s74 offen offset:1024 sc1 lds
    v_mfma_f32_16x16x32_bf16 v[152:155], v[28:31], v[28:31], v[152:155]
    buffer_load_dwordx4 v1, s[8:11], s74 offen offset:2048 sc1 lds
    buffer_load_dwordx4 v1, s[8:11], s74 offen offset:3072 sc1 lds
    s_waitcnt lgkmcnt(0)
    v_mfma_f32_16x16x32_bf16 v[156:159], v[124:127], v[32:35], v[156:159]
    s_add_u32 m0, s36, 12288
    s_nop 0
    buffer_load_dwordx4 v1, s[8:11], s75 offen sc1 lds
    buffer_load_dwordx4 v1, s[8:11], s75 offen offset:1024 sc1 lds
    v_mfma_f32_16x16x32_bf16 v[160:163], v[140:143], v[32:35], v[160:163]
    buffer_load_dwordx4 v1, s[8:11], s75 offen offset:2048 sc1 lds
    buffer_load_dwordx4 v1, s[8:11], s75 offen offset:3072 sc1 lds
    v_mfma_f32_16x16x32_bf16 v[152:155], v[32:35], v[32:35], v[152:155]
    v_max3_f32 v174, v156, v157, v158
    s_nop 2
    v_max3_f32 v14, v159, v160, v161
    v_max3_f32 v174, v174, v162, v163
    s_nop 1
    v_max3_f32 v14, v14, v152, v153
    v_max_f32 v174, v174, v14
    v_max_f32 v15, v174, v174
    s_nop 1
    v_permlane16_swap_b32 v174, v15
    v_max_f32 v174, v174, v15
    v_mov_b32 v15, v174
    s_nop 1
    v_permlane32_swap_b32 v174, v15
    v_max_f32 v174, v174, v15
    v_mul_f32 v174, s32, v174
    v_pk_fma_f32 v[156:157], v[156:157], s[32:33], v[174:175] op_sel_hi:[1,1,0] neg_lo:[0,0,1] neg_hi:[0,0,1]
    v_pk_fma_f32 v[158:159], v[158:159], s[32:33], v[174:175] op_sel_hi:[1,1,0] neg_lo:[0,0,1] neg_hi:[0,0,1]
    v_pk_fma_f32 v[160:161], v[160:161], s[32:33], v[174:175] op_sel_hi:[1,1,0] neg_lo:[0,0,1] neg_hi:[0,0,1]
    v_pk_fma_f32 v[162:163], v[162:163], s[32:33], v[174:175] op_sel_hi:[1,1,0] neg_lo:[0,0,1] neg_hi:[0,0,1]
    v_pk_fma_f32 v[152:153], v[152:153], s[32:33], v[174:175] op_sel_hi:[1,1,0] neg_lo:[0,0,1] neg_hi:[0,0,1]
    v_exp_f32 v156, v156
    v_exp_f32 v157, v157
    v_exp_f32 v158, v158
    v_exp_f32 v159, v159
    v_cvt_pk_bf16_f32 v164, v156, v157
    v_exp_f32 v160, v160
    v_exp_f32 v161, v161
    v_cvt_pk_bf16_f32 v165, v158, v159
    v_exp_f32 v162, v162
    v_exp_f32 v163, v163
    v_cvt_pk_bf16_f32 v166, v160, v161
    v_exp_f32 v152, v152
    v_cvt_pk_bf16_f32 v167, v162, v163
    v_exp_f32 v153, v153
    s_waitcnt vmcnt(22)
    v_cmp_eq_u32 vcc, -1, v96
    v_pk_add_f32 v[14:15], v[156:157], v[158:159]
    v_mfma_f32_16x16x32_bf16 v[112:115], v[144:147], v[164:167], 0
    s_cbranch_vccnz R_xv_144
L_xv_143:
    v_dot2c_f32_bf16 v68, v96, v18
    v_dot2c_f32_bf16 v69, v96, v19
    v_mfma_f32_16x16x32_bf16 v[116:119], v[148:151], v[164:167], 0
    v_dot2c_f32_bf16 v70, v97, v18
    v_dot2c_f32_bf16 v71, v97, v19
    v_cvt_pk_bf16_f32 v168, v152, v153
    v_cvt_pk_bf16_f32 v170, v68, v69
    v_pk_add_f32 v[16:17], v[160:161], v[162:163]
    v_cvt_pk_bf16_f32 v172, v70, v71
    v_pk_add_f32 v[14:15], v[14:15], v[152:153]
    buffer_store_dwordx2 v[100:101], v91, s[8:11], s25 offen sc1
    v_permlane16_swap_b32 v170, v172
    v_pk_add_f32 v[14:15], v[14:15], v[16:17]
    s_nop 0
    v_permlane32_swap_b32 v170, v172
    v_add_f32 v175, v14, v15
    v_add_f32 v16, v14, v15
    v_mfma_f32_16x16x16_bf16 v[112:115], v[170:171], v[168:169], v[112:115]
    s_nop 0
    v_permlane16_swap_b32 v175, v16
    v_mfma_f32_16x16x16_bf16 v[116:119], v[172:173], v[168:169], v[116:119]
    v_add_f32 v175, v175, v16
    v_mov_b32 v16, v175
    v_mov_b32 v88, v170
    v_mov_b32 v89, v172
    v_permlane32_swap_b32 v175, v16
    v_add_f32 v174, v175, v16
    v_rcp_f32 v174, v174
    s_nop 0
    v_pk_mul_f32 v[112:113], v[112:113], v[174:175] op_sel_hi:[1,0]
    v_pk_mul_f32 v[114:115], v[114:115], v[174:175] op_sel_hi:[1,0]
    v_cvt_pk_bf16_f32 v112, v112, v113
    v_cvt_pk_bf16_f32 v113, v114, v115
    v_pk_mul_f32 v[116:117], v[116:117], v[174:175] op_sel_hi:[1,0]
    v_pk_mul_f32 v[118:119], v[118:119], v[174:175] op_sel_hi:[1,0]
    v_cvt_pk_bf16_f32 v116, v116, v117
    v_cvt_pk_bf16_f32 v117, v118, v119
    s_mov_b64 exec, s[28:29]
    ds_write_b64 v9, v[112:113] offset:0
    ds_write_b64 v9, v[116:117] offset:32
    s_mov_b64 exec, -1
    ds_write_b64 v98, v[88:89]
    s_waitcnt lgkmcnt(0)
    s_barrier
    ds_read_b128 v[120:123], v10 offset:0
    ds_read_b128 v[124:127], v10 offset:64
    ds_read_b128 v[128:131], v10 offset:128
    ds_read_b128 v[132:135], v10 offset:192
    s_cmp_eq_u32 s16, 63
    s_cbranch_scc1 L_chain_done_w3x0
    s_waitcnt lgkmcnt(3)
    v_smfmac_f32_16x16x64_bf16 v[72:75], v[120:123], a[240:247], v3
    s_waitcnt lgkmcnt(2)
    v_smfmac_f32_16x16x64_bf16 v[72:75], v[124:127], a[248:255], v3
    s_waitcnt lgkmcnt(1)
    v_smfmac_f32_16x16x64_bf16 v[72:75], v[128:131], v[176:183], v3
    s_waitcnt lgkmcnt(0)
    v_smfmac_f32_16x16x64_bf16 v[72:75], v[132:135], v[184:191], v3
    v_smfmac_f32_16x16x64_bf16 v[76:79], v[120:123], v[192:199], v3
    v_smfmac_f32_16x16x64_bf16 v[76:79], v[124:127], v[200:207], v3
    v_cvt_pk_bf16_f32 v72, v72, v73
    v_cvt_pk_bf16_f32 v73, v74, v75
    v_and_or_b32 v72, v72, -2, s26
    buffer_store_dwordx2 v[72:73], v4, s[8:11], 0 offen
    v_smfmac_f32_16x16x64_bf16 v[76:79], v[128:131], v[208:215], v3
    v_smfmac_f32_16x16x64_bf16 v[76:79], v[132:135], v[216:223], v3
    s_nop 7
    v_cvt_pk_bf16_f32 v76, v76, v77
    v_cvt_pk_bf16_f32 v77, v78, v79
    v_and_or_b32 v76, v76, -2, s26
    buffer_store_dwordx2 v[76:77], v4, s[8:11], s50 offen
    s_add_u32 s16, s16, 1
    s_xor_b32 s26, s26, 1
    s_lshl_b32 s38, s26, 11
    s_add_u32 s24, s70, s38
    s_add_u32 s25, s71, s38
    s_mov_b32 s38, s20
    s_mov_b32 s20, s22
    s_mov_b32 s22, s23
    s_mov_b32 s23, s38
    s_add_u32 s35, s35, 16384
    s_cmp_ge_u32 s35, 65536
    s_cselect_b32 s35, 16384, s35
    s_branch L_step_w3x0_137
R_x_140:
    s_sub_u32 s27, s27, 1
    s_cbranch_scc1 L_chain_abort
    buffer_load_dwordx4 v[92:95], v90, s[8:11], s25 offen sc1
    s_waitcnt vmcnt(0)
    v_cmp_eq_u32 vcc, -1, v92
    s_cbranch_vccnz R_x_140
    buffer_load_dwordx2 v[96:97], v91, s[8:11], s25 offen sc1
    s_branch L_x_139
R_xv_144:
    s_sub_u32 s27, s27, 1
    s_cbranch_scc1 L_chain_abort
    buffer_load_dwordx2 v[96:97], v91, s[8:11], s25 offen sc1
    s_waitcnt vmcnt(0)
    v_cmp_eq_u32 vcc, -1, v96
    s_cbranch_vccnz R_xv_144
    s_branch L_xv_143
L_kvsp_142:
    buffer_load_dword v13, v16, s[8:11], 0 offen sc1
    s_waitcnt vmcnt(0)
    v_readfirstlane_b32 s39, v13
    s_cmp_ge_u32 s39, 2
    s_cbranch_scc1 L_kvok_141
    s_sleep 2
    s_sub_u32 s27, s27, 1
    s_cbranch_scc0 L_kvsp_142
    s_branch L_chain_abort
L_chain_done_w3x0:
    s_lshl_b32 s38, s16, 16
    s_add_u32 s77, s38, s46
    v_add_u32 v14, 6400, v1
    ds_read_b128 v[20:23], v14
    s_waitcnt lgkmcnt(0)
    buffer_store_dwordx4 v[20:23], v1, s[8:11], s77 offen offset:0 sc1
    s_branch L_chain_done
L_chain_w3x1:
L_step_w3x1_145:
    v_mov_b32 v60, 0
    v_mov_b32 v61, 0
    v_mov_b32 v62, 0
    v_mov_b32 v63, 0
    v_mov_b32 v64, 0
    v_mov_b32 v65, 0
    v_mov_b32 v66, 0
    v_mov_b32 v67, 0
    v_mov_b32 v68, 0
    v_mov_b32 v69, 0
    v_mov_b32 v70, 0
    v_mov_b32 v71, 0
    v_and_b32 v15, 7, v0
    v_mul_u32_u24 v15, 672, v15
    v_bfe_u32 v17, v0, 4, 2
    v_lshl_add_u32 v16, v17, 4, v15
    s_barrier
    ds_read_b128 v[20:23], v16 offset:8704
    ds_read_b128 v[24:27], v16 offset:8768
    ds_read_b128 v[28:31], v16 offset:8832
    s_waitcnt lgkmcnt(2)
    v_smfmac_f32_16x16x64_bf16 v[60:63], v[20:23], a[80:87], v3
    ds_read_b128 v[32:35], v16 offset:8896
    v_smfmac_f32_16x16x64_bf16 v[64:67], v[20:23], a[0:7], v3
    s_waitcnt lgkmcnt(2)
    v_smfmac_f32_16x16x64_bf16 v[60:63], v[24:27], a[88:95], v3
    ds_read_b128 v[36:39], v16 offset:8960
    v_smfmac_f32_16x16x64_bf16 v[64:67], v[24:27], a[8:15], v3
    s_waitcnt lgkmcnt(2)
    v_smfmac_f32_16x16x64_bf16 v[60:63], v[28:31], a[96:103], v3
    ds_read_b128 v[40:43], v16 offset:9024
    v_smfmac_f32_16x16x64_bf16 v[64:67], v[28:31], a[16:23], v3
    s_waitcnt lgkmcnt(2)
    v_smfmac_f32_16x16x64_bf16 v[60:63], v[32:35], a[104:111], v3
    ds_read_b128 v[44:47], v16 offset:9088
    v_smfmac_f32_16x16x64_bf16 v[64:67], v[32:35], a[24:31], v3
    s_waitcnt lgkmcnt(2)
    v_smfmac_f32_16x16x64_bf16 v[60:63], v[36:39], a[112:119], v3
    ds_read_b128 v[48:51], v16 offset:9152
    v_smfmac_f32_16x16x64_bf16 v[64:67], v[36:39], a[32:39], v3
    s_waitcnt lgkmcnt(2)
    v_smfmac_f32_16x16x64_bf16 v[60:63], v[40:43], a[120:127], v3
    ds_read_b128 v[52:55], v16 offset:9216
    v_smfmac_f32_16x16x64_bf16 v[64:67], v[40:43], a[40:47], v3
    s_waitcnt lgkmcnt(2)
    v_smfmac_f32_16x16x64_bf16 v[60:63], v[44:47], a[128:135], v3
    ds_read_b128 v[56:59], v16 offset:9280
    v_smfmac_f32_16x16x64_bf16 v[64:67], v[44:47], a[48:55], v3
    s_waitcnt lgkmcnt(2)
    v_smfmac_f32_16x16x64_bf16 v[60:63], v[48:51], a[136:143], v3
    v_smfmac_f32_16x16x64_bf16 v[64:67], v[48:51], a[56:63], v3
    s_waitcnt lgkmcnt(1)
    v_smfmac_f32_16x16x64_bf16 v[60:63], v[52:55], a[144:151], v3
    v_smfmac_f32_16x16x64_bf16 v[64:67], v[52:55], a[64:71], v3
    s_waitcnt lgkmcnt(0)
    v_smfmac_f32_16x16x64_bf16 v[60:63], v[56:59], a[152:159], v3
    v_smfmac_f32_16x16x64_bf16 v[64:67], v[56:59], a[72:79], v3
    v_smfmac_f32_16x16x64_bf16 v[68:71], v[20:23], a[160:167], v3
    v_cvt_pk_bf16_f32 v84, v60, v61
    v_cvt_pk_bf16_f32 v86, v62, v63
    s_nop 1
    v_cvt_pk_bf16_f32 v85, v64, v65
    v_cvt_pk_bf16_f32 v87, v66, v67
    buffer_store_dwordx4 v[84:87], v90, s[8:11], s24 offen sc1
    v_smfmac_f32_16x16x64_bf16 v[68:71], v[24:27], a[168:175], v3
    v_add_u32 v11, s35, v1
    v_smfmac_f32_16x16x64_bf16 v[68:71], v[28:31], a[176:183], v3
    ds_read_b128 v[112:115], v11 offset:0
    v_smfmac_f32_16x16x64_bf16 v[68:71], v[32:35], a[184:191], v3
    ds_read_b128 v[116:119], v11 offset:1024
    v_smfmac_f32_16x16x64_bf16 v[68:71], v[36:39], a[192:199], v3
    ds_read_b128 v[120:123], v11 offset:2048
    v_smfmac_f32_16x16x64_bf16 v[68:71], v[40:43], a[200:207], v3
    ds_read_b128 v[124:127], v11 offset:3072
    v_smfmac_f32_16x16x64_bf16 v[68:71], v[44:47], a[208:215], v3
    ds_read_b128 v[128:131], v11 offset:4096
    v_smfmac_f32_16x16x64_bf16 v[68:71], v[48:51], a[216:223], v3
    ds_read_b128 v[132:135], v11 offset:5120
    v_smfmac_f32_16x16x64_bf16 v[68:71], v[52:55], a[224:231], v3
    ds_read_b128 v[136:139], v11 offset:6144
    v_smfmac_f32_16x16x64_bf16 v[68:71], v[56:59], a[232:239], v3
    ds_read_b128 v[140:143], v11 offset:7168
    s_lshl_b32 s38, s19, 11
    v_add_u32 v12, s38, v11
    ds_read_b128 v[144:147], v12 offset:8192
    ds_read_b128 v[148:151], v12 offset:9216
    s_nop 2
    v_cvt_pk_bf16_f32 v88, v68, v69
    v_cvt_pk_bf16_f32 v89, v70, v71
    buffer_store_dwordx2 v[88:89], v91, s[8:11], s24 offen sc1
    s_nop 3
    s_nop 3
    s_nop 3
    s_nop 3
    s_nop 3
    s_nop 3
    s_nop 3
    s_nop 3
    buffer_load_dwordx4 v[92:95], v90, s[8:11], s25 offen sc1
    v_mov_b32 v72, 0
    v_mov_b32 v73, 0
    v_mov_b32 v74, 0
    v_mov_b32 v75, 0
    v_mov_b32 v76, 0
    v_mov_b32 v77, 0
    v_mov_b32 v78, 0
    v_mov_b32 v79, 0
    s_add_u32 s37, s16, 2
    s_min_u32 s37, s37, 63
    s_add_u32 s36, s36, 16384
    s_cmp_ge_u32 s36, 65536
    s_cselect_b32 s36, 16384, s36
    s_lshl_b32 s38, s37, 5
    s_add_u32 s38, s38, s17
    s_lshl_b32 s38, s38, 13
    s_add_u32 s72, s38, 0
    s_add_u32 s73, s38, 4096
    s_add_u32 s74, s38, 16777216
    s_add_u32 s75, s38, 16781312
    s_add_u32 s37, s16, 3
    s_min_u32 s37, s37, 63
    s_lshr_b32 s38, s37, 2
    s_lshl_b32 s38, s38, 5
    s_add_u32 s38, s38, s17
    s_lshl_b32 s38, s38, 2
    s_add_u32 s38, s38, 102760448
    v_mov_b32 v16, s38
    s_add_u32 s37, s16, 4
    s_min_u32 s37, s37, 63
    s_lshr_b32 s38, s37, 2
    s_lshl_b32 s38, s38, 5
    s_add_u32 s38, s38, s17
    s_lshl_b32 s38, s38, 2
    s_add_u32 s38, s38, 102760448
    v_mov_b32 v12, s38
    s_lshl_b32 s38, s16, 17
    s_add_u32 s76, s38, s45
    s_sub_u32 s39, s16, 1
    s_max_i32 s39, s39, 0
    s_lshl_b32 s38, s39, 16
    s_add_u32 s77, s38, s46
    v_add_u32 v14, 7424, v1
    ds_read_b128 v[164:167], v14
    v_mov_b32 v99, s47
    v_mov_b32 v2, s39
    s_waitcnt vmcnt(0)
    v_cmp_eq_u32 vcc, -1, v92
    s_cbranch_vccnz R_x_148
L_x_147_first:
    buffer_load_dwordx2 v[96:97], v91, s[8:11], s25 offen sc1
L_x_147:
    v_dot2c_f32_bf16 v60, v92, v18
    v_dot2c_f32_bf16 v61, v92, v19
    v_dot2c_f32_bf16 v64, v93, v18
    v_dot2c_f32_bf16 v65, v93, v19
    v_dot2c_f32_bf16 v62, v94, v18
    v_dot2c_f32_bf16 v63, v94, v19
    v_dot2c_f32_bf16 v66, v95, v18
    v_dot2c_f32_bf16 v67, v95, v19
    v_cvt_pk_bf16_f32 v84, v60, v61
    v_cvt_pk_bf16_f32 v85, v64, v65
    v_cvt_pk_bf16_f32 v86, v62, v63
    v_cvt_pk_bf16_f32 v87, v66, v67
    ds_write_b128 v7, v[84:87] offset:0
    buffer_store_dwordx4 v[100:103], v90, s[8:11], s25 offen sc1
    s_waitcnt lgkmcnt(0)
    s_barrier
    ds_read_b64_tr_b16 v[20:21], v8 offset:0
    ds_read_b64_tr_b16 v[22:23], v8 offset:512
    ds_read_b64_tr_b16 v[24:25], v8 offset:1024
    ds_read_b64_tr_b16 v[26:27], v8 offset:1536
    ds_read_b64_tr_b16 v[28:29], v8 offset:2048
    ds_read_b64_tr_b16 v[30:31], v8 offset:2560
    ds_read_b64_tr_b16 v[32:33], v8 offset:3072
    ds_read_b64_tr_b16 v[34:35], v8 offset:3584
    s_waitcnt lgkmcnt(6)
    v_mfma_f32_16x16x32_bf16 v[156:159], v[112:115], v[20:23], 0
    v_readfirstlane_b32 s39, v13
    s_add_u32 m0, s36, 0
    s_nop 0
    buffer_load_dwordx4 v1, s[8:11], s72 offen sc1 lds
    v_mfma_f32_16x16x32_bf16 v[160:163], v[128:131], v[20:23], 0
    s_cmp_lt_u32 s39, 2
    buffer_load_dwordx4 v1, s[8:11], s72 offen offset:1024 sc1 lds
    v_mfma_f32_16x16x32_bf16 v[152:155], v[20:23], v[20:23], 0
    s_cbranch_scc1 L_kvsp_150
L_kvok_149:
    buffer_load_dwordx4 v1, s[8:11], s72 offen offset:2048 sc1 lds
    s_waitcnt lgkmcnt(4)
    v_mfma_f32_16x16x32_bf16 v[156:159], v[116:119], v[24:27], v[156:159]
    buffer_store_dwordx4 v[164:167], v1, s[8:11], s77 offen offset:1024 sc1
    buffer_load_dwordx4 v1, s[8:11], s72 offen offset:3072 sc1 lds
    v_mfma_f32_16x16x32_bf16 v[160:163], v[132:135], v[24:27], v[160:163]
    s_mov_b64 exec, 1
    buffer_store_dword v2, v99, s[8:11], 0 offen sc1
    s_mov_b64 exec, -1
    s_add_u32 m0, s36, 4096
    s_nop 0
    buffer_load_dwordx4 v1, s[8:11], s73 offen sc1 lds
    v_mfma_f32_16x16x32_bf16 v[152:155], v[24:27], v[24:27], v[152:155]
    buffer_load_dword v13, v12, s[8:11], 0 offen sc1
    buffer_load_dwordx4 v1, s[8:11], s73 offen offset:1024 sc1 lds
    s_waitcnt lgkmcnt(2)
    v_mfma_f32_16x16x32_bf16 v[156:159], v[120:123], v[28:31], v[156:159]
    buffer_store_dwordx4 v[28:31], v1, s[8:11], s76 offen offset:2048 sc1
    buffer_load_dwordx4 v1, s[8:11], s73 offen offset:2048 sc1 lds
    buffer_load_dwordx4 v1, s[8:11], s73 offen offset:3072 sc1 lds
    v_mfma_f32_16x16x32_bf16 v[160:163], v[136:139], v[28:31], v[160:163]
    s_add_u32 m0, s36, 8192
    s_nop 0
    buffer_load_dwordx4 v1, s[8:11], s74 offen sc1 lds
    buffer_load_dwordx4 v1, s[8:11], s74 offen offset:1024 sc1 lds
    v_mfma_f32_16x16x32_bf16 v[152:155], v[28:31], v[28:31], v[152:155]
    buffer_load_dwordx4 v1, s[8:11], s74 offen offset:2048 sc1 lds
    buffer_load_dwordx4 v1, s[8:11], s74 offen offset:3072 sc1 lds
    s_waitcnt lgkmcnt(0)
    v_mfma_f32_16x16x32_bf16 v[156:159], v[124:127], v[32:35], v[156:159]
    buffer_store_dwordx4 v[32:35], v1, s[8:11], s76 offen offset:3072 sc1
    s_add_u32 m0, s36, 12288
    s_nop 0
    buffer_load_dwordx4 v1, s[8:11], s75 offen sc1 lds
    buffer_load_dwordx4 v1, s[8:11], s75 offen offset:1024 sc1 lds
    v_mfma_f32_16x16x32_bf16 v[160:163], v[140:143], v[32:35], v[160:163]
    buffer_load_dwordx4 v1, s[8:11], s75 offen offset:2048 sc1 lds
    buffer_load_dwordx4 v1, s[8:11], s75 offen offset:3072 sc1 lds
    v_mfma_f32_16x16x32_bf16 v[152:155], v[32:35], v[32:35], v[152:155]
    v_max3_f32 v174, v156, v157, v158
    s_nop 2
    v_max3_f32 v14, v159, v160, v161
    v_max3_f32 v174, v174, v162, v163
    s_nop 1
    v_max3_f32 v14, v14, v152, v153
    v_max_f32 v174, v174, v14
    v_max_f32 v15, v174, v174
    s_nop 1
    v_permlane16_swap_b32 v174, v15
    v_max_f32 v174, v174, v15
    v_mov_b32 v15, v174
    s_nop 1
    v_permlane32_swap_b32 v174, v15
    v_max_f32 v174, v174, v15
    v_mul_f32 v174, s32, v174
    v_pk_fma_f32 v[156:157], v[156:157], s[32:33], v[174:175] op_sel_hi:[1,1,0] neg_lo:[0,0,1] neg_hi:[0,0,1]
    v_pk_fma_f32 v[158:159], v[158:159], s[32:33], v[174:175] op_sel_hi:[1,1,0] neg_lo:[0,0,1] neg_hi:[0,0,1]
    v_pk_fma_f32 v[160:161], v[160:161], s[32:33], v[174:175] op_sel_hi:[1,1,0] neg_lo:[0,0,1] neg_hi:[0,0,1]
    v_pk_fma_f32 v[162:163], v[162:163], s[32:33], v[174:175] op_sel_hi:[1,1,0] neg_lo:[0,0,1] neg_hi:[0,0,1]
    v_pk_fma_f32 v[152:153], v[152:153], s[32:33], v[174:175] op_sel_hi:[1,1,0] neg_lo:[0,0,1] neg_hi:[0,0,1]
    v_exp_f32 v156, v156
    v_exp_f32 v157, v157
    v_exp_f32 v158, v158
    v_exp_f32 v159, v159
    v_cvt_pk_bf16_f32 v164, v156, v157
    v_exp_f32 v160, v160
    v_exp_f32 v161, v161
    v_cvt_pk_bf16_f32 v165, v158, v159
    v_exp_f32 v162, v162
    v_exp_f32 v163, v163
    v_cvt_pk_bf16_f32 v166, v160, v161
    v_exp_f32 v152, v152
    v_cvt_pk_bf16_f32 v167, v162, v163
    v_exp_f32 v153, v153
    s_waitcnt vmcnt(22)
    v_cmp_eq_u32 vcc, -1, v96
    v_pk_add_f32 v[14:15], v[156:157], v[158:159]
    v_mfma_f32_16x16x32_bf16 v[112:115], v[144:147], v[164:167], 0
    s_cbranch_vccnz R_xv_152
L_xv_151:
    v_dot2c_f32_bf16 v68, v96, v18
    v_dot2c_f32_bf16 v69, v96, v19
    v_mfma_f32_16x16x32_bf16 v[116:119], v[148:151], v[164:167], 0
    v_dot2c_f32_bf16 v70, v97, v18
    v_dot2c_f32_bf16 v71, v97, v19
    v_cvt_pk_bf16_f32 v168, v152, v153
    v_cvt_pk_bf16_f32 v170, v68, v69
    v_pk_add_f32 v[16:17], v[160:161], v[162:163]
    v_cvt_pk_bf16_f32 v172, v70, v71
    v_pk_add_f32 v[14:15], v[14:15], v[152:153]
    buffer_store_dwordx2 v[100:101], v91, s[8:11], s25 offen sc1
    v_permlane16_swap_b32 v170, v172
    v_pk_add_f32 v[14:15], v[14:15], v[16:17]
    s_nop 0
    v_permlane32_swap_b32 v170, v172
    v_add_f32 v175, v14, v15
    v_add_f32 v16, v14, v15
    v_mfma_f32_16x16x16_bf16 v[112:115], v[170:171], v[168:169], v[112:115]
    s_nop 0
    v_permlane16_swap_b32 v175, v16
    v_mfma_f32_16x16x16_bf16 v[116:119], v[172:173], v[168:169], v[116:119]
    v_add_f32 v175, v175, v16
    v_mov_b32 v16, v175
    v_mov_b32 v88, v170
    v_mov_b32 v89, v172
    v_permlane32_swap_b32 v175, v16
    v_add_f32 v174, v175, v16
    v_rcp_f32 v174, v174
    s_nop 0
    v_pk_mul_f32 v[112:113], v[112:113], v[174:175] op_sel_hi:[1,0]
    v_pk_mul_f32 v[114:115], v[114:115], v[174:175] op_sel_hi:[1,0]
    v_cvt_pk_bf16_f32 v112, v112, v113
    v_cvt_pk_bf16_f32 v113, v114, v115
    v_pk_mul_f32 v[116:117], v[116:117], v[174:175] op_sel_hi:[1,0]
    v_pk_mul_f32 v[118:119], v[118:119], v[174:175] op_sel_hi:[1,0]
    v_cvt_pk_bf16_f32 v116, v116, v117
    v_cvt_pk_bf16_f32 v117, v118, v119
    s_mov_b64 exec, s[28:29]
    ds_write_b64 v9, v[112:113] offset:0
    ds_write_b64 v9, v[116:117] offset:32
    s_mov_b64 exec, -1
    ds_write_b64 v98, v[88:89]
    s_waitcnt lgkmcnt(0)
    s_barrier
    ds_read_b128 v[120:123], v10 offset:0
    ds_read_b128 v[124:127], v10 offset:64
    ds_read_b128 v[128:131], v10 offset:128
    ds_read_b128 v[132:135], v10 offset:192
    s_cmp_eq_u32 s16, 63
    s_cbranch_scc1 L_chain_done_w3x1
    s_waitcnt lgkmcnt(3)
    v_smfmac_f32_16x16x64_bf16 v[72:75], v[120:123], a[240:247], v3
    s_waitcnt lgkmcnt(2)
    v_smfmac_f32_16x16x64_bf16 v[72:75], v[124:127], a[248:255], v3
    s_waitcnt lgkmcnt(1)
    v_smfmac_f32_16x16x64_bf16 v[72:75], v[128:131], v[176:183], v3
    s_waitcnt lgkmcnt(0)
    v_smfmac_f32_16x16x64_bf16 v[72:75], v[132:135], v[184:191], v3
    v_smfmac_f32_16x16x64_bf16 v[76:79], v[120:123], v[192:199], v3
    v_smfmac_f32_16x16x64_bf16 v[76:79], v[124:127], v[200:207], v3
    v_cvt_pk_bf16_f32 v72, v72, v73
    v_cvt_pk_bf16_f32 v73, v74, v75
    v_and_or_b32 v72, v72, -2, s26
    buffer_store_dwordx2 v[72:73], v4, s[8:11], 0 offen
    v_smfmac_f32_16x16x64_bf16 v[76:79], v[128:131], v[208:215], v3
    v_smfmac_f32_16x16x64_bf16 v[76:79], v[132:135], v[216:223], v3
    s_nop 7
    v_cvt_pk_bf16_f32 v76, v76, v77
    v_cvt_pk_bf16_f32 v77, v78, v79
    v_and_or_b32 v76, v76, -2, s26
    buffer_store_dwordx2 v[76:77], v4, s[8:11], s50 offen
    s_add_u32 s16, s16, 1
    s_xor_b32 s26, s26, 1
    s_lshl_b32 s38, s26, 11
    s_add_u32 s24, s70, s38
    s_add_u32 s25, s71, s38
    s_mov_b32 s38, s20
    s_mov_b32 s20, s22
    s_mov_b32 s22, s23
    s_mov_b32 s23, s38
    s_add_u32 s35, s35, 16384
    s_cmp_ge_u32 s35, 65536
    s_cselect_b32 s35, 16384, s35
    s_branch L_step_w3x1_145
R_x_148:
    s_sub_u32 s27, s27, 1
    s_cbranch_scc1 L_chain_abort
    buffer_load_dwordx4 v[92:95], v90, s[8:11], s25 offen sc1
    s_waitcnt vmcnt(0)
    v_cmp_eq_u32 vcc, -1, v92
    s_cbranch_vccnz R_x_148
    buffer_load_dwordx2 v[96:97], v91, s[8:11], s25 offen sc1
    s_branch L_x_147
R_xv_152:
    s_sub_u32 s27, s27, 1
    s_cbranch_scc1 L_chain_abort
    buffer_load_dwordx2 v[96:97], v91, s[8:11], s25 offen sc1
    s_waitcnt vmcnt(0)
    v_cmp_eq_u32 vcc, -1, v96
    s_cbranch_vccnz R_xv_152
    s_branch L_xv_151
L_kvsp_150:
    buffer_load_dword v13, v16, s[8:11], 0 offen sc1
    s_waitcnt vmcnt(0)
    v_readfirstlane_b32 s39, v13
    s_cmp_ge_u32 s39, 2
    s_cbranch_scc1 L_kvok_149
    s_sleep 2
    s_sub_u32 s27, s27, 1
    s_cbranch_scc0 L_kvsp_150
    s_branch L_chain_abort
L_chain_done_w3x1:
    s_lshl_b32 s38, s16, 16
    s_add_u32 s77, s38, s46
    v_add_u32 v14, 7424, v1
    ds_read_b128 v[20:23], v14
    s_waitcnt lgkmcnt(0)
    buffer_store_dwordx4 v[20:23], v1, s[8:11], s77 offen offset:1024 sc1
    s_branch L_chain_done
L_chain_done:
    s_waitcnt vmcnt(0)
    s_cmp_lg_u32 s19, 3
    s_cbranch_scc1 L_fin_153
    v_mov_b32 v14, s47
    v_mov_b32 v15, 64
    s_mov_b64 exec, 1
    buffer_store_dword v15, v14, s[8:11], 0 offen sc1
    s_mov_b64 exec, -1
L_fin_153:
    s_branch L_exit
L_chain_abort:
    v_mov_b32 v14, 36
    v_mov_b32 v15, 1
    s_mov_b64 exec, 1
    buffer_atomic_add v15, v14, s[52:55], 0 offen
    s_waitcnt vmcnt(0)
    s_branch L_exit
L_exit:
    s_endpgm
.section .rodata,"a"
.p2align 6
.amdhsa_kernel concat_heads__memory_aug_recurrent_mem_tr__ssm_conv_s5__prompt_kernel
  .amdhsa_next_free_vgpr 512
  .amdhsa_next_free_sgpr 100
  .amdhsa_accum_offset 256
  .amdhsa_group_segment_fixed_size 0
  .amdhsa_kernarg_size 152
  .amdhsa_user_sgpr_count 2
  .amdhsa_user_sgpr_kernarg_segment_ptr 1
  .amdhsa_system_sgpr_workgroup_id_x 1
.end_amdhsa_kernel
```
